```python
import torch

def _softmax(x, axis=-1):
    return torch.softmax(x, dim=axis)
def _gelu(x):
    return torch.nn.functional.gelu(x, approximate="tanh")
def _silu(x):
    return torch.nn.functional.silu(x)
def _sigmoid(x):
    return torch.sigmoid(x)
def _layernorm(x, axis=-1, eps=1e-5):
    m = x.mean(dim=axis, keepdim=True)
    v = x.var(dim=axis, keepdim=True, unbiased=False)
    return (x - m) / torch.sqrt(v + eps)
def _scatter_add(tgt, idx, src, axis=0):
    return tgt.clone().index_add_(axis, idx, src)
def _segment_sum(src, seg, n):
    out = torch.zeros((n,) + src.shape[1:], dtype=src.dtype)
    return out.index_add_(0, seg, src)
def _pad(x, pw):
    flat = tuple(v for pair in reversed(pw) for v in pair)
    return torch.nn.functional.pad(x, flat)

kernel_name = 'recurrent_scan__linear_attn_block__dense_activation_squared_relu__prompt'

def setup_inputs():

    _w = (lambda a: (lambda t: t.to(torch.bfloat16) if t.is_floating_point() else t)(torch.as_tensor(a)))
    def _A_setup():
        B, S, D = 1, 2048, 448
        return {
            "x": _w((lambda *s: torch.randn(*s, dtype=torch.bfloat16) * 0.05)(B, S, D)),
            "wqkv": _w((lambda *s: torch.randn(*s, dtype=torch.bfloat16) * 0.1)(D, 3 * D)),
            "wo": _w((lambda *s: torch.randn(*s, dtype=torch.bfloat16) * 0.05)(D, D)),
        }
    _A_in = _A_setup()

    def _B_setup():
        B, S, D, F = 1, 2048, 448, 1792
        return {
            "x": _w((lambda *s: torch.randn(*s, dtype=torch.bfloat16) * 0.05)(B, S, D)),
            "w1": _w((lambda *s: torch.randn(*s, dtype=torch.bfloat16) * 0.05)(D, F)),
            "b1": _w((lambda *s: torch.randn(*s, dtype=torch.bfloat16) * 0.2)(F)),
            "w2": _w((lambda *s: torch.randn(*s, dtype=torch.bfloat16) * 0.05)(F, D)),
            "b2": _w((lambda *s: torch.randn(*s, dtype=torch.bfloat16) * 0.8)(D)),
        }
    _B_in = _B_setup()

    return {
        "A_x": _A_in["x"],
        "A_wqkv": _A_in["wqkv"],
        "A_wo": _A_in["wo"],
        "B_x": _B_in["x"],
        "B_w1": _B_in["w1"],
        "B_b1": _B_in["b1"],
        "B_w2": _B_in["w2"],
        "B_b2": _B_in["b2"],
    }

def reference(A_x, A_wqkv, A_wo, B_x, B_w1, B_b1, B_w2, B_b2):
    def _A_ref(x, wqkv, wo):
        B, S, D = x.shape
        H = 16; Dh = D // H
        qkv = (lambda x, *d: x.permute(*d))((x @ wqkv).reshape(B, S, 3, H, Dh), 2, 0, 3, 1, 4)
        q, k, v = qkv[0], qkv[1], qkv[2]
        phi = lambda t: torch.where(t > 0, t + 1, torch.exp(t)) + 1e-6
        pq, pk = phi(q), phi(k)
        kv = torch.einsum("bhsd,bhse->bhde", pk, v)
        z = torch.einsum("bhsd->bhd", pk)
        num = torch.einsum("bhqd,bhde->bhqe", pq, kv)
        den = torch.einsum("bhqd,bhd->bhq", pq, z)[..., None] + 1e-6
        o = num / den
        return (lambda x, *d: x.permute(*d))(o, 0, 2, 1, 3).reshape(B, S, D) @ wo

    def _B_ref(x, w1, b1, w2, b2):
        h = torch.einsum("bsd,df->bsf", x, w1) + b1
        zero = torch.zeros_like(h)
        r = torch.where(h > zero, h, zero)
        h = r * r
        out = torch.einsum("bsf,fd->bsd", h, w2) + b2
        return out

    x = A_x
    xn = _layernorm(x, axis=-1)
    s = _A_ref(xn, A_wqkv, A_wo)
    g = _silu(_B_ref(xn, B_w1, B_b1, B_w2, B_b2))
    return x + s * g
```

```asm
; @launch grid=(256,1,1) block=(256,1,1) lds=147968
.amdgcn_target "amdgcn-amd-amdhsa--gfx950"
.text
.globl recurrent_scan__linear_attn_block__dense_activation_squared_relu__prompt_kernel
.p2align 8
.type recurrent_scan__linear_attn_block__dense_activation_squared_relu__prompt_kernel,@function
recurrent_scan__linear_attn_block__dense_activation_squared_relu__prompt_kernel:
  s_load_dwordx16 s[4:19], s[0:1], 0
  s_load_dwordx4 s[20:23], s[0:1], 64
  s_load_dwordx2 s[24:25], s[0:1], 80
  s_cmp_ge_u32 s2, 256
  s_cbranch_scc1 k1_exit
  v_lshrrev_b32 v1, 6, v0
  v_and_b32 v0, 63, v0
  v_readfirstlane_b32 s97, v1
  s_mov_b32 s70, 0x05040100
  s_mov_b32 s71, 0x07060302
  s_mov_b32 s72, 0x00ff00ff
  s_mov_b32 s73, 0x00ff00ff
  s_mov_b32 s74, 0x0f0f0f0f
  s_mov_b32 s75, 0x0f0f0f0f
  v_lshlrev_b32 v13, 4, v0
  s_getpc_b64 s[76:77]
k_pc:
  s_lshr_b32 s78, s2, 3
  s_lshl_b32 s78, s78, 2
  s_add_u32 s78, s78, s97
  s_lshl_b32 s78, s78, 9
  v_lshl_add_u32 v2, v0, 3, s78
  v_min_u32 v2, k_end-k_pc-64, v2
  global_load_dwordx2 v[254:255], v2, s[76:77]
  s_sub_u32 s76, s2, 32
  s_lshr_b32 s76, s76, 3
  s_and_b32 s77, s2, 7
  s_lshl_b32 s77, s77, 2
  s_and_b32 s100, s76, 3
  s_add_u32 s100, s100, s77
  s_lshr_b32 s101, s76, 2
  s_mul_i32 s99, s101, 56
  s_mul_i32 s76, s97, 14
  s_add_u32 s99, s99, s76
  s_lshl_b32 s99, s99, 12
  s_add_u32 s99, s99, 16777216
  s_cmp_eq_u32 s97, 0
  s_cselect_b32 s26, -1, 0
  s_cselect_b32 s27, 0xffff, 0
  s_and_b32 s55, s2, 7
  s_lshl_b32 s55, s55, 9
  s_add_u32 s55, s55, 15728640
  s_cmp_lt_u32 s2, 48
  s_cbranch_scc1 k1_prod
  s_sub_u32 s76, s2, 48
  s_and_b32 s77, s76, 7
  s_lshr_b32 s78, s76, 3
  s_and_b32 s79, s77, 1
  s_lshl_b32 s79, s79, 3
  s_lshr_b32 s80, s77, 1
  s_mul_i32 s81, s80, 14
  s_add_u32 s81, s81, s78
  s_sub_u32 s81, s81, 12
  s_lshr_b32 s95, s81, 3
  s_and_b32 s94, s81, 7
  s_mov_b32 s96, 2
  s_cmp_ge_u32 s78, 12
  s_cbranch_scc1 k1_dec
  s_mov_b32 s95, s80
  s_sub_u32 s94, s78, 4
  s_mov_b32 s96, 1
  s_cmp_ge_u32 s78, 4
  s_cbranch_scc1 k1_dec
  s_and_b32 s95, s80, 1
  s_lshr_b32 s94, s77, 2
  s_lshl_b32 s94, s94, 2
  s_add_u32 s94, s94, s78
  s_mov_b32 s96, 0
k1_dec:
  s_add_u32 s94, s94, s79
  s_cmp_eq_u32 s96, 0
  s_cselect_b32 s82, 7, 0
  s_add_u32 s82, s82, s95
  s_lshl_b32 s3, s94, 4
  s_add_u32 s3, s3, s82
  s_lshl_b32 s82, s95, 4
  s_add_u32 s82, s82, s94
  s_add_u32 s82, s82, 512
  s_cmp_eq_u32 s96, 1
  s_cselect_b32 s3, s82, s3
  s_lshl_b32 s3, s3, 3
  s_add_u32 s3, s3, 15732736
  s_mul_i32 s82, s96, 3
  s_add_u32 s82, s82, s94
  s_add_u32 s82, s82, s95
  s_mul_i32 s83, s82, 37
  s_lshr_b32 s83, s83, 8
  s_mul_i32 s83, s83, 7
  s_sub_u32 s82, s82, s83
  s_lshl_b32 s95, s95, 2
  s_add_u32 s95, s95, s97
  s_cmp_eq_u32 s96, 2
  s_mov_b32 s84, 2688
  s_cselect_b32 s84, 3584, s84
  s_mov_b32 s85, 112
  s_cselect_b32 s85, 128, s85
  s_cselect_b32 s86, 64, 56
  s_mov_b32 s87, 0
  s_cmp_eq_u32 s96, 1
  s_cselect_b32 s85, 56, s85
  s_cselect_b32 s86, 896, s86
  s_cselect_b32 s87, 896, 0
  s_mul_i32 s85, s85, s95
  s_add_u32 s85, s85, s87
  s_lshl_b32 s83, s84, 5
  s_lshl_b32 s48, s82, 7
  s_lshl_b32 s87, s82, 1
  s_mul_i32 s56, s87, s83
  s_add_u32 s57, s56, s83
  s_add_u32 s82, s82, 1
  s_cmp_eq_u32 s82, 7
  s_cselect_b32 s82, 0, s82
  s_lshl_b32 s49, s82, 7
  s_lshl_b32 s87, s82, 1
  s_mul_i32 s58, s87, s83
  s_add_u32 s59, s58, s83
  s_add_u32 s82, s82, 1
  s_cmp_eq_u32 s82, 7
  s_cselect_b32 s82, 0, s82
  s_lshl_b32 s50, s82, 7
  s_lshl_b32 s87, s82, 1
  s_mul_i32 s60, s87, s83
  s_add_u32 s61, s60, s83
  s_add_u32 s82, s82, 1
  s_cmp_eq_u32 s82, 7
  s_cselect_b32 s82, 0, s82
  s_lshl_b32 s51, s82, 7
  s_lshl_b32 s87, s82, 1
  s_mul_i32 s62, s87, s83
  s_add_u32 s63, s62, s83
  s_add_u32 s82, s82, 1
  s_cmp_eq_u32 s82, 7
  s_cselect_b32 s82, 0, s82
  s_lshl_b32 s52, s82, 7
  s_lshl_b32 s87, s82, 1
  s_mul_i32 s64, s87, s83
  s_add_u32 s65, s64, s83
  s_add_u32 s82, s82, 1
  s_cmp_eq_u32 s82, 7
  s_cselect_b32 s82, 0, s82
  s_lshl_b32 s53, s82, 7
  s_lshl_b32 s87, s82, 1
  s_mul_i32 s66, s87, s83
  s_add_u32 s67, s66, s83
  s_add_u32 s82, s82, 1
  s_cmp_eq_u32 s82, 7
  s_cselect_b32 s82, 0, s82
  s_lshl_b32 s54, s82, 7
  s_lshl_b32 s87, s82, 1
  s_mul_i32 s68, s87, s83
  s_add_u32 s69, s68, s83
  s_lshl_b32 s98, s97, 12
  v_lshrrev_b32 v14, 4, v0
  v_bfe_u32 v15, v0, 3, 1
  v_bfe_u32 v16, v0, 2, 1
  v_and_b32 v17, 3, v0
  v_lshl_add_u32 v18, v14, 3, v15
  v_mul_lo_u32 v18, v18, s84
  v_mul_lo_u32 v19, v16, s86
  v_lshl_add_u32 v19, v17, 4, v19
  v_add3_u32 v1, v18, v19, s85
  s_lshl_b32 s87, s84, 1
  v_add_u32 v2, s87, v1
  v_add_u32 v3, s87, v2
  v_add_u32 v4, s87, v3
  s_lshl_b32 s76, s94, 7
  s_lshl_b32 s77, s97, 5
  s_add_u32 s76, s76, s77
  v_lshrrev_b32 v18, 3, v0
  v_add_u32 v18, s76, v18
  v_mul_u32_u24 v18, 896, v18
  v_and_b32 v19, 7, v0
  v_xor_b32 v19, v19, v14
  v_lshl_add_u32 v9, v19, 4, v18
  v_xor_b32 v19, 4, v19
  v_lshl_add_u32 v10, v19, 4, v18
  v_add_u32 v10, 6144, v10
  v_add_u32 v11, 12288, v9
  v_add_u32 v12, 12288, v10
  v_and_b32 v18, 15, v0
  v_lshrrev_b32 v19, 1, v18
  v_xor_b32 v19, v19, v14
  v_lshlrev_b32 v18, 7, v18
  v_lshl_add_u32 v5, v19, 4, v18
  v_xor_b32 v6, 64, v5
  v_add_u32 v7, 0x10000, v5
  v_add_u32 v8, 0x10000, v6
  s_waitcnt lgkmcnt(0)
  s_mov_b32 s28, s4
  s_mov_b32 s29, s5
  s_mov_b32 s30, 1835008
  s_mov_b32 s31, 0x00020000
  s_cmp_eq_u32 s96, 2
  s_cselect_b32 s32, s12, s6
  s_cselect_b32 s33, s13, s7
  s_mov_b32 s34, 1204224
  s_cselect_b32 s34, 1605632, s34
  s_mov_b32 s35, 0x00020000
  s_mov_b32 s36, s24
  s_mov_b32 s37, s25
  s_mov_b32 s38, 268435456
  s_mov_b32 s39, 0x00020000
  s_mov_b32 s40, s22
  s_mov_b32 s41, s23
  s_mov_b32 s42, 256
  s_mov_b32 s43, 0x00020000
  s_mov_b32 s44, s14
  s_mov_b32 s45, s15
  s_mov_b32 s46, 3584
  s_mov_b32 s47, 0x00020000
  s_mov_b32 s88, 0x3f800008
  s_mov_b32 s89, 0x3f800008
  s_mov_b32 s90, 0x3fb8aa3b
  s_mov_b32 s91, 0x3fb8aa3b
  s_mov_b32 s92, 0x358637bd
  s_mov_b32 s93, 0x358637bd
  v_mov_b32 v24, 0x3f803f80
  v_mov_b32 v25, 0x3f803f80
  v_mov_b32 v26, 0x3f803f80
  v_mov_b32 v27, 0x3f803f80
  s_cmp_eq_u32 s96, 1
  s_cbranch_scc1 k1_kv
  s_add_u32 m0, s98, 0
  s_nop 0
  buffer_load_dwordx4 v9, s[28:31], s48 offen offset:0 lds
  buffer_load_dwordx4 v10, s[28:31], s48 offen offset:1024 lds
  buffer_load_dwordx4 v11, s[28:31], s48 offen offset:2048 lds
  buffer_load_dwordx4 v12, s[28:31], s48 offen offset:3072 lds
  buffer_load_dwordx4 v[48:51], v1, s[32:35], s56 offen
  buffer_load_dwordx4 v[52:55], v2, s[32:35], s56 offen
  buffer_load_dwordx4 v[56:59], v3, s[32:35], s56 offen
  buffer_load_dwordx4 v[60:63], v4, s[32:35], s56 offen
  buffer_load_dwordx4 v[64:67], v1, s[32:35], s57 offen
  buffer_load_dwordx4 v[68:71], v2, s[32:35], s57 offen
  buffer_load_dwordx4 v[72:75], v3, s[32:35], s57 offen
  buffer_load_dwordx4 v[76:79], v4, s[32:35], s57 offen
  s_add_u32 m0, s98, 16384
  s_nop 0
  buffer_load_dwordx4 v9, s[28:31], s49 offen offset:0 lds
  buffer_load_dwordx4 v10, s[28:31], s49 offen offset:1024 lds
  buffer_load_dwordx4 v11, s[28:31], s49 offen offset:2048 lds
  buffer_load_dwordx4 v12, s[28:31], s49 offen offset:3072 lds
  buffer_load_dwordx4 v[80:83], v1, s[32:35], s58 offen
  buffer_load_dwordx4 v[84:87], v2, s[32:35], s58 offen
  buffer_load_dwordx4 v[88:91], v3, s[32:35], s58 offen
  buffer_load_dwordx4 v[92:95], v4, s[32:35], s58 offen
  s_waitcnt vmcnt(16)
  s_barrier
  ds_read_b128 a[0:3], v5 offset:0
  ds_read_b128 a[4:7], v5 offset:2048
  ds_read_b128 a[8:11], v5 offset:4096
  ds_read_b128 a[12:15], v5 offset:6144
  ds_read_b128 a[16:19], v5 offset:8192
  ds_read_b128 a[20:23], v5 offset:10240
  ds_read_b128 a[24:27], v5 offset:12288
  ds_read_b128 a[28:31], v5 offset:14336
  s_mov_b64 vcc, s[72:73]
  s_waitcnt vmcnt(15)
  v_cndmask_b32_dpp v14, v50, v48, vcc row_ror:8 row_mask:0xf bank_mask:0xf
  v_mov_b32_dpp v50, v48 row_ror:8 row_mask:0xf bank_mask:0x3
  s_waitcnt vmcnt(14)
  v_cndmask_b32_dpp v15, v54, v52, vcc row_ror:8 row_mask:0xf bank_mask:0xf
  v_mov_b32_dpp v54, v52 row_ror:8 row_mask:0xf bank_mask:0x3
  s_waitcnt vmcnt(13)
  v_cndmask_b32_dpp v16, v58, v56, vcc row_ror:8 row_mask:0xf bank_mask:0xf
  v_mov_b32_dpp v58, v56 row_ror:8 row_mask:0xf bank_mask:0x3
  s_waitcnt vmcnt(12)
  v_cndmask_b32_dpp v17, v62, v60, vcc row_ror:8 row_mask:0xf bank_mask:0xf
  v_mov_b32_dpp v62, v60 row_ror:8 row_mask:0xf bank_mask:0x3
  v_perm_b32 v32, v50, v14, s70
  v_perm_b32 v36, v50, v14, s71
  v_perm_b32 v33, v54, v15, s70
  v_perm_b32 v37, v54, v15, s71
  v_perm_b32 v34, v58, v16, s70
  v_perm_b32 v38, v58, v16, s71
  v_perm_b32 v35, v62, v17, s70
  v_perm_b32 v39, v62, v17, s71
  s_waitcnt lgkmcnt(7)
  v_mfma_f32_16x16x32_bf16 v[128:131], v[32:35], a[0:3], 0
  v_cndmask_b32_dpp v14, v51, v49, vcc row_ror:8 row_mask:0xf bank_mask:0xf
  v_mov_b32_dpp v51, v49 row_ror:8 row_mask:0xf bank_mask:0x3
  buffer_load_dwordx4 v[96:99], v1, s[32:35], s59 offen
  v_mfma_f32_16x16x32_bf16 v[160:163], v[36:39], a[0:3], 0
  v_cndmask_b32_dpp v15, v55, v53, vcc row_ror:8 row_mask:0xf bank_mask:0xf
  buffer_load_dwordx4 v[100:103], v2, s[32:35], s59 offen
  s_waitcnt lgkmcnt(6)
  v_mfma_f32_16x16x32_bf16 v[132:135], v[32:35], a[4:7], 0
  v_mov_b32_dpp v55, v53 row_ror:8 row_mask:0xf bank_mask:0x3
  ds_read_b128 a[32:35], v6 offset:0
  v_mfma_f32_16x16x32_bf16 v[164:167], v[36:39], a[4:7], 0
  v_cndmask_b32_dpp v16, v59, v57, vcc row_ror:8 row_mask:0xf bank_mask:0xf
  buffer_load_dwordx4 v[104:107], v3, s[32:35], s59 offen
  s_waitcnt lgkmcnt(6)
  v_mfma_f32_16x16x32_bf16 v[136:139], v[32:35], a[8:11], 0
  v_mov_b32_dpp v59, v57 row_ror:8 row_mask:0xf bank_mask:0x3
  v_mfma_f32_16x16x32_bf16 v[168:171], v[36:39], a[8:11], 0
  v_cndmask_b32_dpp v17, v63, v61, vcc row_ror:8 row_mask:0xf bank_mask:0xf
  ds_read_b128 a[36:39], v6 offset:2048
  buffer_load_dwordx4 v[108:111], v4, s[32:35], s59 offen
  s_waitcnt lgkmcnt(6)
  v_mfma_f32_16x16x32_bf16 v[140:143], v[32:35], a[12:15], 0
  v_mov_b32_dpp v63, v61 row_ror:8 row_mask:0xf bank_mask:0x3
  v_mfma_f32_16x16x32_bf16 v[172:175], v[36:39], a[12:15], 0
  v_perm_b32 v40, v51, v14, s70
  s_add_u32 m0, s98, 32768
  s_waitcnt lgkmcnt(5)
  v_mfma_f32_16x16x32_bf16 v[144:147], v[32:35], a[16:19], 0
  v_perm_b32 v44, v51, v14, s71
  ds_read_b128 a[40:43], v6 offset:4096
  buffer_load_dwordx4 v9, s[28:31], s50 offen offset:0 lds
  v_mfma_f32_16x16x32_bf16 v[176:179], v[36:39], a[16:19], 0
  v_perm_b32 v41, v55, v15, s70
  s_waitcnt lgkmcnt(5)
  v_mfma_f32_16x16x32_bf16 v[148:151], v[32:35], a[20:23], 0
  v_perm_b32 v45, v55, v15, s71
  buffer_load_dwordx4 v10, s[28:31], s50 offen offset:1024 lds
  v_mfma_f32_16x16x32_bf16 v[180:183], v[36:39], a[20:23], 0
  v_perm_b32 v42, v59, v16, s70
  ds_read_b128 a[44:47], v6 offset:6144
  s_waitcnt lgkmcnt(5)
  v_mfma_f32_16x16x32_bf16 v[152:155], v[32:35], a[24:27], 0
  v_perm_b32 v46, v59, v16, s71
  buffer_load_dwordx4 v11, s[28:31], s50 offen offset:2048 lds
  v_mfma_f32_16x16x32_bf16 v[184:187], v[36:39], a[24:27], 0
  v_perm_b32 v43, v63, v17, s70
  s_waitcnt lgkmcnt(4)
  v_mfma_f32_16x16x32_bf16 v[156:159], v[32:35], a[28:31], 0
  v_perm_b32 v47, v63, v17, s71
  buffer_load_dwordx4 v12, s[28:31], s50 offen offset:3072 lds
  v_mfma_f32_16x16x32_bf16 v[188:191], v[36:39], a[28:31], 0
  v_mfma_f32_16x16x32_bf16 a[240:243], v[32:35], v[24:27], 0
  v_mfma_f32_16x16x32_bf16 a[244:247], v[36:39], v[24:27], 0
  v_mfma_f32_16x16x32_bf16 v[192:195], v[40:43], a[0:3], 0
  s_waitcnt vmcnt(19)
  v_cndmask_b32_dpp v14, v66, v64, vcc row_ror:8 row_mask:0xf bank_mask:0xf
  v_mov_b32_dpp v66, v64 row_ror:8 row_mask:0xf bank_mask:0x3
  buffer_load_dwordx4 v[112:115], v1, s[32:35], s60 offen
  v_mfma_f32_16x16x32_bf16 v[224:227], v[44:47], a[0:3], 0
  s_waitcnt vmcnt(19)
  v_cndmask_b32_dpp v15, v70, v68, vcc row_ror:8 row_mask:0xf bank_mask:0xf
  ds_read_b128 a[48:51], v6 offset:8192
  buffer_load_dwordx4 v[116:119], v2, s[32:35], s60 offen
  v_mfma_f32_16x16x32_bf16 v[196:199], v[40:43], a[4:7], 0
  v_mov_b32_dpp v70, v68 row_ror:8 row_mask:0xf bank_mask:0x3
  v_mfma_f32_16x16x32_bf16 v[228:231], v[44:47], a[4:7], 0
  s_waitcnt vmcnt(19)
  v_cndmask_b32_dpp v16, v74, v72, vcc row_ror:8 row_mask:0xf bank_mask:0xf
  ds_read_b128 a[52:55], v6 offset:10240
  buffer_load_dwordx4 v[120:123], v3, s[32:35], s60 offen
  v_mfma_f32_16x16x32_bf16 v[200:203], v[40:43], a[8:11], 0
  v_mov_b32_dpp v74, v72 row_ror:8 row_mask:0xf bank_mask:0x3
  buffer_load_dwordx4 v[124:127], v4, s[32:35], s60 offen
  v_mfma_f32_16x16x32_bf16 v[232:235], v[44:47], a[8:11], 0
  s_waitcnt vmcnt(20)
  v_cndmask_b32_dpp v17, v78, v76, vcc row_ror:8 row_mask:0xf bank_mask:0xf
  v_mfma_f32_16x16x32_bf16 v[204:207], v[40:43], a[12:15], 0
  v_mov_b32_dpp v78, v76 row_ror:8 row_mask:0xf bank_mask:0x3
  ds_read_b128 a[56:59], v6 offset:12288
  buffer_load_dwordx4 v[48:51], v1, s[32:35], s61 offen
  v_mfma_f32_16x16x32_bf16 v[236:239], v[44:47], a[12:15], 0
  v_perm_b32 v32, v66, v14, s70
  v_mfma_f32_16x16x32_bf16 v[208:211], v[40:43], a[16:19], 0
  v_perm_b32 v36, v66, v14, s71
  ds_read_b128 a[60:63], v6 offset:14336
  buffer_load_dwordx4 v[52:55], v2, s[32:35], s61 offen
  v_mfma_f32_16x16x32_bf16 v[240:243], v[44:47], a[16:19], 0
  v_perm_b32 v33, v70, v15, s70
  buffer_load_dwordx4 v[56:59], v3, s[32:35], s61 offen
  v_mfma_f32_16x16x32_bf16 v[212:215], v[40:43], a[20:23], 0
  v_perm_b32 v37, v70, v15, s71
  v_mfma_f32_16x16x32_bf16 v[244:247], v[44:47], a[20:23], 0
  v_perm_b32 v34, v74, v16, s70
  buffer_load_dwordx4 v[60:63], v4, s[32:35], s61 offen
  v_mfma_f32_16x16x32_bf16 v[216:219], v[40:43], a[24:27], 0
  v_perm_b32 v38, v74, v16, s71
  v_mfma_f32_16x16x32_bf16 v[248:251], v[44:47], a[24:27], 0
  v_perm_b32 v35, v78, v17, s70
  v_mfma_f32_16x16x32_bf16 v[220:223], v[40:43], a[28:31], 0
  v_perm_b32 v39, v78, v17, s71
  v_mfma_f32_16x16x32_bf16 v[252:255], v[44:47], a[28:31], 0
  v_mfma_f32_16x16x32_bf16 a[248:251], v[40:43], v[24:27], 0
  v_mfma_f32_16x16x32_bf16 a[252:255], v[44:47], v[24:27], 0
  s_waitcnt lgkmcnt(7)
  v_mfma_f32_16x16x32_bf16 v[128:131], v[32:35], a[32:35], v[128:131]
  v_cndmask_b32_dpp v14, v67, v65, vcc row_ror:8 row_mask:0xf bank_mask:0xf
  v_mov_b32_dpp v67, v65 row_ror:8 row_mask:0xf bank_mask:0x3
  s_add_u32 m0, s98, 49152
  v_mfma_f32_16x16x32_bf16 v[160:163], v[36:39], a[32:35], v[160:163]
  v_cndmask_b32_dpp v15, v71, v69, vcc row_ror:8 row_mask:0xf bank_mask:0xf
  s_waitcnt lgkmcnt(6)
  v_mfma_f32_16x16x32_bf16 v[132:135], v[32:35], a[36:39], v[132:135]
  v_mov_b32_dpp v71, v69 row_ror:8 row_mask:0xf bank_mask:0x3
  s_waitcnt vmcnt(20)
  s_barrier
  v_mfma_f32_16x16x32_bf16 v[164:167], v[36:39], a[36:39], v[164:167]
  v_cndmask_b32_dpp v16, v75, v73, vcc row_ror:8 row_mask:0xf bank_mask:0xf
  buffer_load_dwordx4 v9, s[28:31], s51 offen offset:0 lds
  s_waitcnt lgkmcnt(5)
  v_mfma_f32_16x16x32_bf16 v[136:139], v[32:35], a[40:43], v[136:139]
  v_mov_b32_dpp v75, v73 row_ror:8 row_mask:0xf bank_mask:0x3
  ds_read_b128 a[0:3], v5 offset:16384
  v_mfma_f32_16x16x32_bf16 v[168:171], v[36:39], a[40:43], v[168:171]
  v_cndmask_b32_dpp v17, v79, v77, vcc row_ror:8 row_mask:0xf bank_mask:0xf
  s_waitcnt lgkmcnt(5)
  v_mfma_f32_16x16x32_bf16 v[140:143], v[32:35], a[44:47], v[140:143]
  v_mov_b32_dpp v79, v77 row_ror:8 row_mask:0xf bank_mask:0x3
  ds_read_b128 a[4:7], v5 offset:18432
  buffer_load_dwordx4 v10, s[28:31], s51 offen offset:1024 lds
  v_mfma_f32_16x16x32_bf16 v[172:175], v[36:39], a[44:47], v[172:175]
  v_perm_b32 v40, v67, v14, s70
  s_waitcnt lgkmcnt(5)
  v_mfma_f32_16x16x32_bf16 v[144:147], v[32:35], a[48:51], v[144:147]
  v_perm_b32 v44, v67, v14, s71
  v_mfma_f32_16x16x32_bf16 v[176:179], v[36:39], a[48:51], v[176:179]
  v_perm_b32 v41, v71, v15, s70
  ds_read_b128 a[8:11], v5 offset:20480
  buffer_load_dwordx4 v11, s[28:31], s51 offen offset:2048 lds
  s_waitcnt lgkmcnt(5)
  v_mfma_f32_16x16x32_bf16 v[148:151], v[32:35], a[52:55], v[148:151]
  v_perm_b32 v45, v71, v15, s71
  v_mfma_f32_16x16x32_bf16 v[180:183], v[36:39], a[52:55], v[180:183]
  v_perm_b32 v42, v75, v16, s70
  ds_read_b128 a[12:15], v5 offset:22528
  s_waitcnt lgkmcnt(5)
  v_mfma_f32_16x16x32_bf16 v[152:155], v[32:35], a[56:59], v[152:155]
  v_perm_b32 v46, v75, v16, s71
  buffer_load_dwordx4 v12, s[28:31], s51 offen offset:3072 lds
  v_mfma_f32_16x16x32_bf16 v[184:187], v[36:39], a[56:59], v[184:187]
  v_perm_b32 v43, v79, v17, s70
  s_waitcnt lgkmcnt(4)
  v_mfma_f32_16x16x32_bf16 v[156:159], v[32:35], a[60:63], v[156:159]
  v_perm_b32 v47, v79, v17, s71
  v_mfma_f32_16x16x32_bf16 v[188:191], v[36:39], a[60:63], v[188:191]
  v_mfma_f32_16x16x32_bf16 a[240:243], v[32:35], v[24:27], a[240:243]
  v_mfma_f32_16x16x32_bf16 a[244:247], v[36:39], v[24:27], a[244:247]
  v_mfma_f32_16x16x32_bf16 v[192:195], v[40:43], a[32:35], v[192:195]
  s_waitcnt vmcnt(23)
  v_cndmask_b32_dpp v14, v82, v80, vcc row_ror:8 row_mask:0xf bank_mask:0xf
  v_mov_b32_dpp v82, v80 row_ror:8 row_mask:0xf bank_mask:0x3
  buffer_load_dwordx4 v[64:67], v1, s[32:35], s62 offen
  v_mfma_f32_16x16x32_bf16 v[224:227], v[44:47], a[32:35], v[224:227]
  s_waitcnt vmcnt(23)
  v_cndmask_b32_dpp v15, v86, v84, vcc row_ror:8 row_mask:0xf bank_mask:0xf
  ds_read_b128 a[16:19], v5 offset:24576
  buffer_load_dwordx4 v[68:71], v2, s[32:35], s62 offen
  v_mfma_f32_16x16x32_bf16 v[196:199], v[40:43], a[36:39], v[196:199]
  v_mov_b32_dpp v86, v84 row_ror:8 row_mask:0xf bank_mask:0x3
  v_mfma_f32_16x16x32_bf16 v[228:231], v[44:47], a[36:39], v[228:231]
  s_waitcnt vmcnt(23)
  v_cndmask_b32_dpp v16, v90, v88, vcc row_ror:8 row_mask:0xf bank_mask:0xf
  ds_read_b128 a[20:23], v5 offset:26624
  buffer_load_dwordx4 v[72:75], v3, s[32:35], s62 offen
  v_mfma_f32_16x16x32_bf16 v[200:203], v[40:43], a[40:43], v[200:203]
  v_mov_b32_dpp v90, v88 row_ror:8 row_mask:0xf bank_mask:0x3
  v_mfma_f32_16x16x32_bf16 v[232:235], v[44:47], a[40:43], v[232:235]
  s_waitcnt vmcnt(23)
  v_cndmask_b32_dpp v17, v94, v92, vcc row_ror:8 row_mask:0xf bank_mask:0xf
  buffer_load_dwordx4 v[76:79], v4, s[32:35], s62 offen
  v_mfma_f32_16x16x32_bf16 v[204:207], v[40:43], a[44:47], v[204:207]
  v_mov_b32_dpp v94, v92 row_ror:8 row_mask:0xf bank_mask:0x3
  ds_read_b128 a[24:27], v5 offset:28672
  v_mfma_f32_16x16x32_bf16 v[236:239], v[44:47], a[44:47], v[236:239]
  v_perm_b32 v32, v82, v14, s70
  v_mfma_f32_16x16x32_bf16 v[208:211], v[40:43], a[48:51], v[208:211]
  v_perm_b32 v36, v82, v14, s71
  ds_read_b128 a[28:31], v5 offset:30720
  v_mfma_f32_16x16x32_bf16 v[240:243], v[44:47], a[48:51], v[240:243]
  v_perm_b32 v33, v86, v15, s70
  s_mov_b64 exec, s[26:27]
  buffer_load_dwordx2 v[18:19], off, s[40:43], 0 sc1
  s_mov_b64 exec, -1
  v_mfma_f32_16x16x32_bf16 v[212:215], v[40:43], a[52:55], v[212:215]
  v_perm_b32 v37, v86, v15, s71
  v_mfma_f32_16x16x32_bf16 v[244:247], v[44:47], a[52:55], v[244:247]
  v_perm_b32 v34, v90, v16, s70
  v_mfma_f32_16x16x32_bf16 v[216:219], v[40:43], a[56:59], v[216:219]
  v_perm_b32 v38, v90, v16, s71
  v_mfma_f32_16x16x32_bf16 v[248:251], v[44:47], a[56:59], v[248:251]
  v_perm_b32 v35, v94, v17, s70
  v_mfma_f32_16x16x32_bf16 v[220:223], v[40:43], a[60:63], v[220:223]
  v_perm_b32 v39, v94, v17, s71
  v_mfma_f32_16x16x32_bf16 v[252:255], v[44:47], a[60:63], v[252:255]
  v_mfma_f32_16x16x32_bf16 a[248:251], v[40:43], v[24:27], a[248:251]
  v_mfma_f32_16x16x32_bf16 a[252:255], v[44:47], v[24:27], a[252:255]
  s_waitcnt lgkmcnt(7)
  v_mfma_f32_16x16x32_bf16 v[128:131], v[32:35], a[0:3], v[128:131]
  v_cndmask_b32_dpp v14, v83, v81, vcc row_ror:8 row_mask:0xf bank_mask:0xf
  v_mov_b32_dpp v83, v81 row_ror:8 row_mask:0xf bank_mask:0x3
  s_add_u32 m0, s98, 65536
  v_mfma_f32_16x16x32_bf16 v[160:163], v[36:39], a[0:3], v[160:163]
  v_cndmask_b32_dpp v15, v87, v85, vcc row_ror:8 row_mask:0xf bank_mask:0xf
  s_waitcnt lgkmcnt(6)
  v_mfma_f32_16x16x32_bf16 v[132:135], v[32:35], a[4:7], v[132:135]
  v_mov_b32_dpp v87, v85 row_ror:8 row_mask:0xf bank_mask:0x3
  ds_read_b128 a[32:35], v6 offset:16384
  v_mfma_f32_16x16x32_bf16 v[164:167], v[36:39], a[4:7], v[164:167]
  v_cndmask_b32_dpp v16, v91, v89, vcc row_ror:8 row_mask:0xf bank_mask:0xf
  buffer_load_dwordx4 v9, s[28:31], s52 offen offset:0 lds
  s_waitcnt lgkmcnt(6)
  v_mfma_f32_16x16x32_bf16 v[136:139], v[32:35], a[8:11], v[136:139]
  v_mov_b32_dpp v91, v89 row_ror:8 row_mask:0xf bank_mask:0x3
  v_mfma_f32_16x16x32_bf16 v[168:171], v[36:39], a[8:11], v[168:171]
  v_cndmask_b32_dpp v17, v95, v93, vcc row_ror:8 row_mask:0xf bank_mask:0xf
  ds_read_b128 a[36:39], v6 offset:18432
  s_waitcnt lgkmcnt(6)
  v_mfma_f32_16x16x32_bf16 v[140:143], v[32:35], a[12:15], v[140:143]
  v_mov_b32_dpp v95, v93 row_ror:8 row_mask:0xf bank_mask:0x3
  buffer_load_dwordx4 v10, s[28:31], s52 offen offset:1024 lds
  v_mfma_f32_16x16x32_bf16 v[172:175], v[36:39], a[12:15], v[172:175]
  v_perm_b32 v40, v83, v14, s70
  s_waitcnt lgkmcnt(5)
  v_mfma_f32_16x16x32_bf16 v[144:147], v[32:35], a[16:19], v[144:147]
  v_perm_b32 v44, v83, v14, s71
  ds_read_b128 a[40:43], v6 offset:20480
  v_mfma_f32_16x16x32_bf16 v[176:179], v[36:39], a[16:19], v[176:179]
  v_perm_b32 v41, v87, v15, s70
  buffer_load_dwordx4 v11, s[28:31], s52 offen offset:2048 lds
  s_waitcnt lgkmcnt(5)
  v_mfma_f32_16x16x32_bf16 v[148:151], v[32:35], a[20:23], v[148:151]
  v_perm_b32 v45, v87, v15, s71
  v_mfma_f32_16x16x32_bf16 v[180:183], v[36:39], a[20:23], v[180:183]
  v_perm_b32 v42, v91, v16, s70
  ds_read_b128 a[44:47], v6 offset:22528
  s_waitcnt lgkmcnt(5)
  v_mfma_f32_16x16x32_bf16 v[152:155], v[32:35], a[24:27], v[152:155]
  v_perm_b32 v46, v91, v16, s71
  buffer_load_dwordx4 v12, s[28:31], s52 offen offset:3072 lds
  v_mfma_f32_16x16x32_bf16 v[184:187], v[36:39], a[24:27], v[184:187]
  v_perm_b32 v43, v95, v17, s70
  s_waitcnt lgkmcnt(4)
  v_mfma_f32_16x16x32_bf16 v[156:159], v[32:35], a[28:31], v[156:159]
  v_perm_b32 v47, v95, v17, s71
  v_mfma_f32_16x16x32_bf16 v[188:191], v[36:39], a[28:31], v[188:191]
  v_mfma_f32_16x16x32_bf16 a[240:243], v[32:35], v[24:27], a[240:243]
  v_mfma_f32_16x16x32_bf16 a[244:247], v[36:39], v[24:27], a[244:247]
  v_mfma_f32_16x16x32_bf16 v[192:195], v[40:43], a[0:3], v[192:195]
  s_waitcnt vmcnt(28)
  v_cndmask_b32_dpp v14, v98, v96, vcc row_ror:8 row_mask:0xf bank_mask:0xf
  v_mov_b32_dpp v98, v96 row_ror:8 row_mask:0xf bank_mask:0x3
  buffer_load_dwordx4 v[80:83], v1, s[32:35], s63 offen
  v_mfma_f32_16x16x32_bf16 v[224:227], v[44:47], a[0:3], v[224:227]
  s_waitcnt vmcnt(28)
  v_cndmask_b32_dpp v15, v102, v100, vcc row_ror:8 row_mask:0xf bank_mask:0xf
  ds_read_b128 a[48:51], v6 offset:24576
  buffer_load_dwordx4 v[84:87], v2, s[32:35], s63 offen
  v_mfma_f32_16x16x32_bf16 v[196:199], v[40:43], a[4:7], v[196:199]
  v_mov_b32_dpp v102, v100 row_ror:8 row_mask:0xf bank_mask:0x3
  v_mfma_f32_16x16x32_bf16 v[228:231], v[44:47], a[4:7], v[228:231]
  s_waitcnt vmcnt(28)
  v_cndmask_b32_dpp v16, v106, v104, vcc row_ror:8 row_mask:0xf bank_mask:0xf
  ds_read_b128 a[52:55], v6 offset:26624
  buffer_load_dwordx4 v[88:91], v3, s[32:35], s63 offen
  v_mfma_f32_16x16x32_bf16 v[200:203], v[40:43], a[8:11], v[200:203]
  v_mov_b32_dpp v106, v104 row_ror:8 row_mask:0xf bank_mask:0x3
  v_mfma_f32_16x16x32_bf16 v[232:235], v[44:47], a[8:11], v[232:235]
  s_waitcnt vmcnt(28)
  v_cndmask_b32_dpp v17, v110, v108, vcc row_ror:8 row_mask:0xf bank_mask:0xf
  buffer_load_dwordx4 v[92:95], v4, s[32:35], s63 offen
  v_mfma_f32_16x16x32_bf16 v[204:207], v[40:43], a[12:15], v[204:207]
  v_mov_b32_dpp v110, v108 row_ror:8 row_mask:0xf bank_mask:0x3
  ds_read_b128 a[56:59], v6 offset:28672
  v_mfma_f32_16x16x32_bf16 v[236:239], v[44:47], a[12:15], v[236:239]
  v_perm_b32 v32, v98, v14, s70
  v_mfma_f32_16x16x32_bf16 v[208:211], v[40:43], a[16:19], v[208:211]
  v_perm_b32 v36, v98, v14, s71
  ds_read_b128 a[60:63], v6 offset:30720
  v_mfma_f32_16x16x32_bf16 v[240:243], v[44:47], a[16:19], v[240:243]
  v_perm_b32 v33, v102, v15, s70
  v_mfma_f32_16x16x32_bf16 v[212:215], v[40:43], a[20:23], v[212:215]
  v_perm_b32 v37, v102, v15, s71
  v_mfma_f32_16x16x32_bf16 v[244:247], v[44:47], a[20:23], v[244:247]
  v_perm_b32 v34, v106, v16, s70
  v_mfma_f32_16x16x32_bf16 v[216:219], v[40:43], a[24:27], v[216:219]
  v_perm_b32 v38, v106, v16, s71
  v_mfma_f32_16x16x32_bf16 v[248:251], v[44:47], a[24:27], v[248:251]
  v_perm_b32 v35, v110, v17, s70
  v_mfma_f32_16x16x32_bf16 v[220:223], v[40:43], a[28:31], v[220:223]
  v_perm_b32 v39, v110, v17, s71
  v_mfma_f32_16x16x32_bf16 v[252:255], v[44:47], a[28:31], v[252:255]
  v_mfma_f32_16x16x32_bf16 a[248:251], v[40:43], v[24:27], a[248:251]
  v_mfma_f32_16x16x32_bf16 a[252:255], v[44:47], v[24:27], a[252:255]
  s_waitcnt lgkmcnt(7)
  v_mfma_f32_16x16x32_bf16 v[128:131], v[32:35], a[32:35], v[128:131]
  v_cndmask_b32_dpp v14, v99, v97, vcc row_ror:8 row_mask:0xf bank_mask:0xf
  v_mov_b32_dpp v99, v97 row_ror:8 row_mask:0xf bank_mask:0x3
  s_add_u32 m0, s98, 81920
  v_mfma_f32_16x16x32_bf16 v[160:163], v[36:39], a[32:35], v[160:163]
  v_cndmask_b32_dpp v15, v103, v101, vcc row_ror:8 row_mask:0xf bank_mask:0xf
  s_waitcnt lgkmcnt(6)
  v_mfma_f32_16x16x32_bf16 v[132:135], v[32:35], a[36:39], v[132:135]
  v_mov_b32_dpp v103, v101 row_ror:8 row_mask:0xf bank_mask:0x3
  s_waitcnt vmcnt(25)
  s_barrier
  v_mfma_f32_16x16x32_bf16 v[164:167], v[36:39], a[36:39], v[164:167]
  v_cndmask_b32_dpp v16, v107, v105, vcc row_ror:8 row_mask:0xf bank_mask:0xf
  buffer_load_dwordx4 v9, s[28:31], s53 offen offset:0 lds
  s_waitcnt lgkmcnt(5)
  v_mfma_f32_16x16x32_bf16 v[136:139], v[32:35], a[40:43], v[136:139]
  v_mov_b32_dpp v107, v105 row_ror:8 row_mask:0xf bank_mask:0x3
  ds_read_b128 a[0:3], v5 offset:32768
  v_mfma_f32_16x16x32_bf16 v[168:171], v[36:39], a[40:43], v[168:171]
  v_cndmask_b32_dpp v17, v111, v109, vcc row_ror:8 row_mask:0xf bank_mask:0xf
  s_waitcnt lgkmcnt(5)
  v_mfma_f32_16x16x32_bf16 v[140:143], v[32:35], a[44:47], v[140:143]
  v_mov_b32_dpp v111, v109 row_ror:8 row_mask:0xf bank_mask:0x3
  ds_read_b128 a[4:7], v5 offset:34816
  buffer_load_dwordx4 v10, s[28:31], s53 offen offset:1024 lds
  v_mfma_f32_16x16x32_bf16 v[172:175], v[36:39], a[44:47], v[172:175]
  v_perm_b32 v40, v99, v14, s70
  s_waitcnt lgkmcnt(5)
  v_mfma_f32_16x16x32_bf16 v[144:147], v[32:35], a[48:51], v[144:147]
  v_perm_b32 v44, v99, v14, s71
  v_mfma_f32_16x16x32_bf16 v[176:179], v[36:39], a[48:51], v[176:179]
  v_perm_b32 v41, v103, v15, s70
  ds_read_b128 a[8:11], v5 offset:36864
  buffer_load_dwordx4 v11, s[28:31], s53 offen offset:2048 lds
  s_waitcnt lgkmcnt(5)
  v_mfma_f32_16x16x32_bf16 v[148:151], v[32:35], a[52:55], v[148:151]
  v_perm_b32 v45, v103, v15, s71
  v_mfma_f32_16x16x32_bf16 v[180:183], v[36:39], a[52:55], v[180:183]
  v_perm_b32 v42, v107, v16, s70
  ds_read_b128 a[12:15], v5 offset:38912
  s_waitcnt lgkmcnt(5)
  v_mfma_f32_16x16x32_bf16 v[152:155], v[32:35], a[56:59], v[152:155]
  v_perm_b32 v46, v107, v16, s71
  buffer_load_dwordx4 v12, s[28:31], s53 offen offset:3072 lds
  v_mfma_f32_16x16x32_bf16 v[184:187], v[36:39], a[56:59], v[184:187]
  v_perm_b32 v43, v111, v17, s70
  s_waitcnt lgkmcnt(4)
  v_mfma_f32_16x16x32_bf16 v[156:159], v[32:35], a[60:63], v[156:159]
  v_perm_b32 v47, v111, v17, s71
  v_mfma_f32_16x16x32_bf16 v[188:191], v[36:39], a[60:63], v[188:191]
  v_mfma_f32_16x16x32_bf16 a[240:243], v[32:35], v[24:27], a[240:243]
  v_mfma_f32_16x16x32_bf16 a[244:247], v[36:39], v[24:27], a[244:247]
  v_mfma_f32_16x16x32_bf16 v[192:195], v[40:43], a[32:35], v[192:195]
  s_waitcnt vmcnt(28)
  v_cndmask_b32_dpp v14, v114, v112, vcc row_ror:8 row_mask:0xf bank_mask:0xf
  v_mov_b32_dpp v114, v112 row_ror:8 row_mask:0xf bank_mask:0x3
  buffer_load_dwordx4 v[96:99], v1, s[32:35], s64 offen
  v_mfma_f32_16x16x32_bf16 v[224:227], v[44:47], a[32:35], v[224:227]
  s_waitcnt vmcnt(28)
  v_cndmask_b32_dpp v15, v118, v116, vcc row_ror:8 row_mask:0xf bank_mask:0xf
  ds_read_b128 a[16:19], v5 offset:40960
  buffer_load_dwordx4 v[100:103], v2, s[32:35], s64 offen
  v_mfma_f32_16x16x32_bf16 v[196:199], v[40:43], a[36:39], v[196:199]
  v_mov_b32_dpp v118, v116 row_ror:8 row_mask:0xf bank_mask:0x3
  v_mfma_f32_16x16x32_bf16 v[228:231], v[44:47], a[36:39], v[228:231]
  s_waitcnt vmcnt(28)
  v_cndmask_b32_dpp v16, v122, v120, vcc row_ror:8 row_mask:0xf bank_mask:0xf
  ds_read_b128 a[20:23], v5 offset:43008
  buffer_load_dwordx4 v[104:107], v3, s[32:35], s64 offen
  v_mfma_f32_16x16x32_bf16 v[200:203], v[40:43], a[40:43], v[200:203]
  v_mov_b32_dpp v122, v120 row_ror:8 row_mask:0xf bank_mask:0x3
  v_mfma_f32_16x16x32_bf16 v[232:235], v[44:47], a[40:43], v[232:235]
  s_waitcnt vmcnt(28)
  v_cndmask_b32_dpp v17, v126, v124, vcc row_ror:8 row_mask:0xf bank_mask:0xf
  buffer_load_dwordx4 v[108:111], v4, s[32:35], s64 offen
  v_mfma_f32_16x16x32_bf16 v[204:207], v[40:43], a[44:47], v[204:207]
  v_mov_b32_dpp v126, v124 row_ror:8 row_mask:0xf bank_mask:0x3
  ds_read_b128 a[24:27], v5 offset:45056
  v_mfma_f32_16x16x32_bf16 v[236:239], v[44:47], a[44:47], v[236:239]
  v_perm_b32 v32, v114, v14, s70
  v_mfma_f32_16x16x32_bf16 v[208:211], v[40:43], a[48:51], v[208:211]
  v_perm_b32 v36, v114, v14, s71
  ds_read_b128 a[28:31], v5 offset:47104
  v_mfma_f32_16x16x32_bf16 v[240:243], v[44:47], a[48:51], v[240:243]
  v_perm_b32 v33, v118, v15, s70
  v_mfma_f32_16x16x32_bf16 v[212:215], v[40:43], a[52:55], v[212:215]
  v_perm_b32 v37, v118, v15, s71
  v_mfma_f32_16x16x32_bf16 v[244:247], v[44:47], a[52:55], v[244:247]
  v_perm_b32 v34, v122, v16, s70
  v_mfma_f32_16x16x32_bf16 v[216:219], v[40:43], a[56:59], v[216:219]
  v_perm_b32 v38, v122, v16, s71
  v_mfma_f32_16x16x32_bf16 v[248:251], v[44:47], a[56:59], v[248:251]
  v_perm_b32 v35, v126, v17, s70
  v_mfma_f32_16x16x32_bf16 v[220:223], v[40:43], a[60:63], v[220:223]
  v_perm_b32 v39, v126, v17, s71
  v_mfma_f32_16x16x32_bf16 v[252:255], v[44:47], a[60:63], v[252:255]
  v_mfma_f32_16x16x32_bf16 a[248:251], v[40:43], v[24:27], a[248:251]
  v_mfma_f32_16x16x32_bf16 a[252:255], v[44:47], v[24:27], a[252:255]
  s_waitcnt lgkmcnt(7)
  v_mfma_f32_16x16x32_bf16 v[128:131], v[32:35], a[0:3], v[128:131]
  v_cndmask_b32_dpp v14, v115, v113, vcc row_ror:8 row_mask:0xf bank_mask:0xf
  v_mov_b32_dpp v115, v113 row_ror:8 row_mask:0xf bank_mask:0x3
  s_add_u32 m0, s98, 98304
  v_mfma_f32_16x16x32_bf16 v[160:163], v[36:39], a[0:3], v[160:163]
  v_cndmask_b32_dpp v15, v119, v117, vcc row_ror:8 row_mask:0xf bank_mask:0xf
  s_waitcnt lgkmcnt(6)
  v_mfma_f32_16x16x32_bf16 v[132:135], v[32:35], a[4:7], v[132:135]
  v_mov_b32_dpp v119, v117 row_ror:8 row_mask:0xf bank_mask:0x3
  ds_read_b128 a[32:35], v6 offset:32768
  v_mfma_f32_16x16x32_bf16 v[164:167], v[36:39], a[4:7], v[164:167]
  v_cndmask_b32_dpp v16, v123, v121, vcc row_ror:8 row_mask:0xf bank_mask:0xf
  buffer_load_dwordx4 v9, s[28:31], s54 offen offset:0 lds
  s_waitcnt lgkmcnt(6)
  v_mfma_f32_16x16x32_bf16 v[136:139], v[32:35], a[8:11], v[136:139]
  v_mov_b32_dpp v123, v121 row_ror:8 row_mask:0xf bank_mask:0x3
  v_mfma_f32_16x16x32_bf16 v[168:171], v[36:39], a[8:11], v[168:171]
  v_cndmask_b32_dpp v17, v127, v125, vcc row_ror:8 row_mask:0xf bank_mask:0xf
  ds_read_b128 a[36:39], v6 offset:34816
  s_waitcnt lgkmcnt(6)
  v_mfma_f32_16x16x32_bf16 v[140:143], v[32:35], a[12:15], v[140:143]
  v_mov_b32_dpp v127, v125 row_ror:8 row_mask:0xf bank_mask:0x3
  buffer_load_dwordx4 v10, s[28:31], s54 offen offset:1024 lds
  v_mfma_f32_16x16x32_bf16 v[172:175], v[36:39], a[12:15], v[172:175]
  v_perm_b32 v40, v115, v14, s70
  s_waitcnt lgkmcnt(5)
  v_mfma_f32_16x16x32_bf16 v[144:147], v[32:35], a[16:19], v[144:147]
  v_perm_b32 v44, v115, v14, s71
  ds_read_b128 a[40:43], v6 offset:36864
  v_mfma_f32_16x16x32_bf16 v[176:179], v[36:39], a[16:19], v[176:179]
  v_perm_b32 v41, v119, v15, s70
  buffer_load_dwordx4 v11, s[28:31], s54 offen offset:2048 lds
  s_waitcnt lgkmcnt(5)
  v_mfma_f32_16x16x32_bf16 v[148:151], v[32:35], a[20:23], v[148:151]
  v_perm_b32 v45, v119, v15, s71
  v_mfma_f32_16x16x32_bf16 v[180:183], v[36:39], a[20:23], v[180:183]
  v_perm_b32 v42, v123, v16, s70
  ds_read_b128 a[44:47], v6 offset:38912
  s_waitcnt lgkmcnt(5)
  v_mfma_f32_16x16x32_bf16 v[152:155], v[32:35], a[24:27], v[152:155]
  v_perm_b32 v46, v123, v16, s71
  buffer_load_dwordx4 v12, s[28:31], s54 offen offset:3072 lds
  v_mfma_f32_16x16x32_bf16 v[184:187], v[36:39], a[24:27], v[184:187]
  v_perm_b32 v43, v127, v17, s70
  s_waitcnt lgkmcnt(4)
  v_mfma_f32_16x16x32_bf16 v[156:159], v[32:35], a[28:31], v[156:159]
  v_perm_b32 v47, v127, v17, s71
  v_mfma_f32_16x16x32_bf16 v[188:191], v[36:39], a[28:31], v[188:191]
  v_mfma_f32_16x16x32_bf16 a[240:243], v[32:35], v[24:27], a[240:243]
  v_mfma_f32_16x16x32_bf16 a[244:247], v[36:39], v[24:27], a[244:247]
  v_mfma_f32_16x16x32_bf16 v[192:195], v[40:43], a[0:3], v[192:195]
  s_waitcnt vmcnt(32)
  v_cndmask_b32_dpp v14, v50, v48, vcc row_ror:8 row_mask:0xf bank_mask:0xf
  v_mov_b32_dpp v50, v48 row_ror:8 row_mask:0xf bank_mask:0x3
  buffer_load_dwordx4 v[112:115], v1, s[32:35], s65 offen
  v_mfma_f32_16x16x32_bf16 v[224:227], v[44:47], a[0:3], v[224:227]
  s_waitcnt vmcnt(32)
  v_cndmask_b32_dpp v15, v54, v52, vcc row_ror:8 row_mask:0xf bank_mask:0xf
  ds_read_b128 a[48:51], v6 offset:40960
  buffer_load_dwordx4 v[116:119], v2, s[32:35], s65 offen
  v_mfma_f32_16x16x32_bf16 v[196:199], v[40:43], a[4:7], v[196:199]
  v_mov_b32_dpp v54, v52 row_ror:8 row_mask:0xf bank_mask:0x3
  v_mfma_f32_16x16x32_bf16 v[228:231], v[44:47], a[4:7], v[228:231]
  s_waitcnt vmcnt(32)
  v_cndmask_b32_dpp v16, v58, v56, vcc row_ror:8 row_mask:0xf bank_mask:0xf
  ds_read_b128 a[52:55], v6 offset:43008
  buffer_load_dwordx4 v[120:123], v3, s[32:35], s65 offen
  v_mfma_f32_16x16x32_bf16 v[200:203], v[40:43], a[8:11], v[200:203]
  v_mov_b32_dpp v58, v56 row_ror:8 row_mask:0xf bank_mask:0x3
  v_mfma_f32_16x16x32_bf16 v[232:235], v[44:47], a[8:11], v[232:235]
  s_waitcnt vmcnt(32)
  v_cndmask_b32_dpp v17, v62, v60, vcc row_ror:8 row_mask:0xf bank_mask:0xf
  buffer_load_dwordx4 v[124:127], v4, s[32:35], s65 offen
  v_mfma_f32_16x16x32_bf16 v[204:207], v[40:43], a[12:15], v[204:207]
  v_mov_b32_dpp v62, v60 row_ror:8 row_mask:0xf bank_mask:0x3
  ds_read_b128 a[56:59], v6 offset:45056
  v_mfma_f32_16x16x32_bf16 v[236:239], v[44:47], a[12:15], v[236:239]
  v_perm_b32 v32, v50, v14, s70
  v_mfma_f32_16x16x32_bf16 v[208:211], v[40:43], a[16:19], v[208:211]
  v_perm_b32 v36, v50, v14, s71
  ds_read_b128 a[60:63], v6 offset:47104
  v_mfma_f32_16x16x32_bf16 v[240:243], v[44:47], a[16:19], v[240:243]
  v_perm_b32 v33, v54, v15, s70
  v_mfma_f32_16x16x32_bf16 v[212:215], v[40:43], a[20:23], v[212:215]
  v_perm_b32 v37, v54, v15, s71
  v_mfma_f32_16x16x32_bf16 v[244:247], v[44:47], a[20:23], v[244:247]
  v_perm_b32 v34, v58, v16, s70
  v_mfma_f32_16x16x32_bf16 v[216:219], v[40:43], a[24:27], v[216:219]
  v_perm_b32 v38, v58, v16, s71
  s_waitcnt vmcnt(24)
  v_cmp_ne_u32 s[76:77], 0, v18
  s_mov_b32 s78, 0
  s_and_b64 s[76:77], s[76:77], s[26:27]
  s_cmp_eq_u64 s[76:77], s[26:27]
  s_cbranch_scc0 k1fqn_slow
k1fqn_ok:
  v_readfirstlane_b32 s6, v18
  v_readfirstlane_b32 s7, v19
  v_mov_b32 v31, 114688
  s_mov_b64 exec, s[26:27]
  ds_write_b64 v31, v[18:19]
  s_mov_b64 exec, -1
  v_mfma_f32_16x16x32_bf16 v[248:251], v[44:47], a[24:27], v[248:251]
  v_perm_b32 v35, v62, v17, s70
  v_mfma_f32_16x16x32_bf16 v[220:223], v[40:43], a[28:31], v[220:223]
  v_perm_b32 v39, v62, v17, s71
  v_mfma_f32_16x16x32_bf16 v[252:255], v[44:47], a[28:31], v[252:255]
  v_mfma_f32_16x16x32_bf16 a[248:251], v[40:43], v[24:27], a[248:251]
  v_mfma_f32_16x16x32_bf16 a[252:255], v[44:47], v[24:27], a[252:255]
  s_waitcnt lgkmcnt(8)
  v_mfma_f32_16x16x32_bf16 v[128:131], v[32:35], a[32:35], v[128:131]
  v_cndmask_b32_dpp v14, v51, v49, vcc row_ror:8 row_mask:0xf bank_mask:0xf
  v_mov_b32_dpp v51, v49 row_ror:8 row_mask:0xf bank_mask:0x3
  v_mfma_f32_16x16x32_bf16 v[160:163], v[36:39], a[32:35], v[160:163]
  v_cndmask_b32_dpp v15, v55, v53, vcc row_ror:8 row_mask:0xf bank_mask:0xf
  s_waitcnt lgkmcnt(7)
  v_mfma_f32_16x16x32_bf16 v[132:135], v[32:35], a[36:39], v[132:135]
  v_mov_b32_dpp v55, v53 row_ror:8 row_mask:0xf bank_mask:0x3
  s_barrier
  v_mfma_f32_16x16x32_bf16 v[164:167], v[36:39], a[36:39], v[164:167]
  v_cndmask_b32_dpp v16, v59, v57, vcc row_ror:8 row_mask:0xf bank_mask:0xf
  s_waitcnt lgkmcnt(6)
  v_mfma_f32_16x16x32_bf16 v[136:139], v[32:35], a[40:43], v[136:139]
  v_mov_b32_dpp v59, v57 row_ror:8 row_mask:0xf bank_mask:0x3
  ds_read_b128 a[0:3], v5 offset:49152
  v_mfma_f32_16x16x32_bf16 v[168:171], v[36:39], a[40:43], v[168:171]
  v_cndmask_b32_dpp v17, v63, v61, vcc row_ror:8 row_mask:0xf bank_mask:0xf
  s_waitcnt lgkmcnt(6)
  v_mfma_f32_16x16x32_bf16 v[140:143], v[32:35], a[44:47], v[140:143]
  v_mov_b32_dpp v63, v61 row_ror:8 row_mask:0xf bank_mask:0x3
  ds_read_b128 a[4:7], v5 offset:51200
  v_mfma_f32_16x16x32_bf16 v[172:175], v[36:39], a[44:47], v[172:175]
  v_perm_b32 v40, v51, v14, s70
  s_waitcnt lgkmcnt(6)
  v_mfma_f32_16x16x32_bf16 v[144:147], v[32:35], a[48:51], v[144:147]
  v_perm_b32 v44, v51, v14, s71
  v_mfma_f32_16x16x32_bf16 v[176:179], v[36:39], a[48:51], v[176:179]
  v_perm_b32 v41, v55, v15, s70
  ds_read_b128 a[8:11], v5 offset:53248
  s_waitcnt lgkmcnt(6)
  v_mfma_f32_16x16x32_bf16 v[148:151], v[32:35], a[52:55], v[148:151]
  v_perm_b32 v45, v55, v15, s71
  v_mfma_f32_16x16x32_bf16 v[180:183], v[36:39], a[52:55], v[180:183]
  v_perm_b32 v42, v59, v16, s70
  ds_read_b128 a[12:15], v5 offset:55296
  s_waitcnt lgkmcnt(6)
  v_mfma_f32_16x16x32_bf16 v[152:155], v[32:35], a[56:59], v[152:155]
  v_perm_b32 v46, v59, v16, s71
  v_mfma_f32_16x16x32_bf16 v[184:187], v[36:39], a[56:59], v[184:187]
  v_perm_b32 v43, v63, v17, s70
  s_waitcnt lgkmcnt(5)
  v_mfma_f32_16x16x32_bf16 v[156:159], v[32:35], a[60:63], v[156:159]
  v_perm_b32 v47, v63, v17, s71
  v_mfma_f32_16x16x32_bf16 v[188:191], v[36:39], a[60:63], v[188:191]
  v_mfma_f32_16x16x32_bf16 a[240:243], v[32:35], v[24:27], a[240:243]
  v_mfma_f32_16x16x32_bf16 a[244:247], v[36:39], v[24:27], a[244:247]
  v_mfma_f32_16x16x32_bf16 v[192:195], v[40:43], a[32:35], v[192:195]
  v_lshlrev_b32 v30, 3, v0
  s_mov_b64 exec, s[26:27]
  buffer_load_dwordx2 v[20:21], v30, s[36:39], s55 offen sc1
  s_mov_b64 exec, -1
  v_cndmask_b32_dpp v14, v66, v64, vcc row_ror:8 row_mask:0xf bank_mask:0xf
  v_mov_b32_dpp v66, v64 row_ror:8 row_mask:0xf bank_mask:0x3
  buffer_load_dwordx4 v[48:51], v1, s[32:35], s66 offen
  v_mfma_f32_16x16x32_bf16 v[224:227], v[44:47], a[32:35], v[224:227]
  v_cndmask_b32_dpp v15, v70, v68, vcc row_ror:8 row_mask:0xf bank_mask:0xf
  ds_read_b128 a[16:19], v5 offset:57344
  buffer_load_dwordx4 v[52:55], v2, s[32:35], s66 offen
  v_mfma_f32_16x16x32_bf16 v[196:199], v[40:43], a[36:39], v[196:199]
  v_mov_b32_dpp v70, v68 row_ror:8 row_mask:0xf bank_mask:0x3
  v_mfma_f32_16x16x32_bf16 v[228:231], v[44:47], a[36:39], v[228:231]
  v_cndmask_b32_dpp v16, v74, v72, vcc row_ror:8 row_mask:0xf bank_mask:0xf
  ds_read_b128 a[20:23], v5 offset:59392
  buffer_load_dwordx4 v[56:59], v3, s[32:35], s66 offen
  v_mfma_f32_16x16x32_bf16 v[200:203], v[40:43], a[40:43], v[200:203]
  v_mov_b32_dpp v74, v72 row_ror:8 row_mask:0xf bank_mask:0x3
  v_mfma_f32_16x16x32_bf16 v[232:235], v[44:47], a[40:43], v[232:235]
  v_cndmask_b32_dpp v17, v78, v76, vcc row_ror:8 row_mask:0xf bank_mask:0xf
  buffer_load_dwordx4 v[60:63], v4, s[32:35], s66 offen
  v_mfma_f32_16x16x32_bf16 v[204:207], v[40:43], a[44:47], v[204:207]
  v_mov_b32_dpp v78, v76 row_ror:8 row_mask:0xf bank_mask:0x3
  ds_read_b128 a[24:27], v5 offset:61440
  v_mfma_f32_16x16x32_bf16 v[236:239], v[44:47], a[44:47], v[236:239]
  v_perm_b32 v32, v66, v14, s70
  v_mfma_f32_16x16x32_bf16 v[208:211], v[40:43], a[48:51], v[208:211]
  v_perm_b32 v36, v66, v14, s71
  ds_read_b128 a[28:31], v5 offset:63488
  v_mfma_f32_16x16x32_bf16 v[240:243], v[44:47], a[48:51], v[240:243]
  v_perm_b32 v33, v70, v15, s70
  v_mfma_f32_16x16x32_bf16 v[212:215], v[40:43], a[52:55], v[212:215]
  v_perm_b32 v37, v70, v15, s71
  v_mfma_f32_16x16x32_bf16 v[244:247], v[44:47], a[52:55], v[244:247]
  v_perm_b32 v34, v74, v16, s70
  v_mfma_f32_16x16x32_bf16 v[216:219], v[40:43], a[56:59], v[216:219]
  v_perm_b32 v38, v74, v16, s71
  v_mfma_f32_16x16x32_bf16 v[248:251], v[44:47], a[56:59], v[248:251]
  v_perm_b32 v35, v78, v17, s70
  v_mfma_f32_16x16x32_bf16 v[220:223], v[40:43], a[60:63], v[220:223]
  v_perm_b32 v39, v78, v17, s71
  v_mfma_f32_16x16x32_bf16 v[252:255], v[44:47], a[60:63], v[252:255]
  v_mfma_f32_16x16x32_bf16 a[248:251], v[40:43], v[24:27], a[248:251]
  v_mfma_f32_16x16x32_bf16 a[252:255], v[44:47], v[24:27], a[252:255]
  s_waitcnt lgkmcnt(7)
  v_mfma_f32_16x16x32_bf16 v[128:131], v[32:35], a[0:3], v[128:131]
  v_cndmask_b32_dpp v14, v67, v65, vcc row_ror:8 row_mask:0xf bank_mask:0xf
  v_mov_b32_dpp v67, v65 row_ror:8 row_mask:0xf bank_mask:0x3
  v_mfma_f32_16x16x32_bf16 v[160:163], v[36:39], a[0:3], v[160:163]
  v_cndmask_b32_dpp v15, v71, v69, vcc row_ror:8 row_mask:0xf bank_mask:0xf
  s_waitcnt lgkmcnt(6)
  v_mfma_f32_16x16x32_bf16 v[132:135], v[32:35], a[4:7], v[132:135]
  v_mov_b32_dpp v71, v69 row_ror:8 row_mask:0xf bank_mask:0x3
  ds_read_b128 a[32:35], v6 offset:49152
  v_mfma_f32_16x16x32_bf16 v[164:167], v[36:39], a[4:7], v[164:167]
  v_cndmask_b32_dpp v16, v75, v73, vcc row_ror:8 row_mask:0xf bank_mask:0xf
  s_waitcnt lgkmcnt(6)
  v_mfma_f32_16x16x32_bf16 v[136:139], v[32:35], a[8:11], v[136:139]
  v_mov_b32_dpp v75, v73 row_ror:8 row_mask:0xf bank_mask:0x3
  v_mfma_f32_16x16x32_bf16 v[168:171], v[36:39], a[8:11], v[168:171]
  v_cndmask_b32_dpp v17, v79, v77, vcc row_ror:8 row_mask:0xf bank_mask:0xf
  ds_read_b128 a[36:39], v6 offset:51200
  s_waitcnt lgkmcnt(6)
  v_mfma_f32_16x16x32_bf16 v[140:143], v[32:35], a[12:15], v[140:143]
  v_mov_b32_dpp v79, v77 row_ror:8 row_mask:0xf bank_mask:0x3
  v_mfma_f32_16x16x32_bf16 v[172:175], v[36:39], a[12:15], v[172:175]
  v_perm_b32 v40, v67, v14, s70
  s_waitcnt lgkmcnt(5)
  v_mfma_f32_16x16x32_bf16 v[144:147], v[32:35], a[16:19], v[144:147]
  v_perm_b32 v44, v67, v14, s71
  ds_read_b128 a[40:43], v6 offset:53248
  v_mfma_f32_16x16x32_bf16 v[176:179], v[36:39], a[16:19], v[176:179]
  v_perm_b32 v41, v71, v15, s70
  s_waitcnt lgkmcnt(5)
  v_mfma_f32_16x16x32_bf16 v[148:151], v[32:35], a[20:23], v[148:151]
  v_perm_b32 v45, v71, v15, s71
  v_mfma_f32_16x16x32_bf16 v[180:183], v[36:39], a[20:23], v[180:183]
  v_perm_b32 v42, v75, v16, s70
  ds_read_b128 a[44:47], v6 offset:55296
  s_waitcnt lgkmcnt(5)
  v_mfma_f32_16x16x32_bf16 v[152:155], v[32:35], a[24:27], v[152:155]
  v_perm_b32 v46, v75, v16, s71
  v_mfma_f32_16x16x32_bf16 v[184:187], v[36:39], a[24:27], v[184:187]
  v_perm_b32 v43, v79, v17, s70
  s_waitcnt lgkmcnt(4)
  v_mfma_f32_16x16x32_bf16 v[156:159], v[32:35], a[28:31], v[156:159]
  v_perm_b32 v47, v79, v17, s71
  v_mfma_f32_16x16x32_bf16 v[188:191], v[36:39], a[28:31], v[188:191]
  v_mfma_f32_16x16x32_bf16 a[240:243], v[32:35], v[24:27], a[240:243]
  v_mfma_f32_16x16x32_bf16 a[244:247], v[36:39], v[24:27], a[244:247]
  v_mfma_f32_16x16x32_bf16 v[192:195], v[40:43], a[0:3], v[192:195]
  s_waitcnt vmcnt(24)
  v_cndmask_b32_dpp v14, v82, v80, vcc row_ror:8 row_mask:0xf bank_mask:0xf
  v_mov_b32_dpp v82, v80 row_ror:8 row_mask:0xf bank_mask:0x3
  buffer_load_dwordx4 v[64:67], v1, s[32:35], s67 offen
  v_mfma_f32_16x16x32_bf16 v[224:227], v[44:47], a[0:3], v[224:227]
  s_waitcnt vmcnt(24)
  v_cndmask_b32_dpp v15, v86, v84, vcc row_ror:8 row_mask:0xf bank_mask:0xf
  ds_read_b128 a[48:51], v6 offset:57344
  buffer_load_dwordx4 v[68:71], v2, s[32:35], s67 offen
  v_mfma_f32_16x16x32_bf16 v[196:199], v[40:43], a[4:7], v[196:199]
  v_mov_b32_dpp v86, v84 row_ror:8 row_mask:0xf bank_mask:0x3
  v_mfma_f32_16x16x32_bf16 v[228:231], v[44:47], a[4:7], v[228:231]
  s_waitcnt vmcnt(24)
  v_cndmask_b32_dpp v16, v90, v88, vcc row_ror:8 row_mask:0xf bank_mask:0xf
  ds_read_b128 a[52:55], v6 offset:59392
  buffer_load_dwordx4 v[72:75], v3, s[32:35], s67 offen
  v_mfma_f32_16x16x32_bf16 v[200:203], v[40:43], a[8:11], v[200:203]
  v_mov_b32_dpp v90, v88 row_ror:8 row_mask:0xf bank_mask:0x3
  v_mfma_f32_16x16x32_bf16 v[232:235], v[44:47], a[8:11], v[232:235]
  s_waitcnt vmcnt(24)
  v_cndmask_b32_dpp v17, v94, v92, vcc row_ror:8 row_mask:0xf bank_mask:0xf
  buffer_load_dwordx4 v[76:79], v4, s[32:35], s67 offen
  v_mfma_f32_16x16x32_bf16 v[204:207], v[40:43], a[12:15], v[204:207]
  v_mov_b32_dpp v94, v92 row_ror:8 row_mask:0xf bank_mask:0x3
  ds_read_b128 a[56:59], v6 offset:61440
  v_mfma_f32_16x16x32_bf16 v[236:239], v[44:47], a[12:15], v[236:239]
  v_perm_b32 v32, v82, v14, s70
  v_mfma_f32_16x16x32_bf16 v[208:211], v[40:43], a[16:19], v[208:211]
  v_perm_b32 v36, v82, v14, s71
  ds_read_b128 a[60:63], v6 offset:63488
  v_mfma_f32_16x16x32_bf16 v[240:243], v[44:47], a[16:19], v[240:243]
  v_perm_b32 v33, v86, v15, s70
  v_mfma_f32_16x16x32_bf16 v[212:215], v[40:43], a[20:23], v[212:215]
  v_perm_b32 v37, v86, v15, s71
  v_mfma_f32_16x16x32_bf16 v[244:247], v[44:47], a[20:23], v[244:247]
  v_perm_b32 v34, v90, v16, s70
  v_mfma_f32_16x16x32_bf16 v[216:219], v[40:43], a[24:27], v[216:219]
  v_perm_b32 v38, v90, v16, s71
  v_mfma_f32_16x16x32_bf16 v[248:251], v[44:47], a[24:27], v[248:251]
  v_perm_b32 v35, v94, v17, s70
  v_mfma_f32_16x16x32_bf16 v[220:223], v[40:43], a[28:31], v[220:223]
  v_perm_b32 v39, v94, v17, s71
  v_mfma_f32_16x16x32_bf16 v[252:255], v[44:47], a[28:31], v[252:255]
  v_mfma_f32_16x16x32_bf16 a[248:251], v[40:43], v[24:27], a[248:251]
  v_mfma_f32_16x16x32_bf16 a[252:255], v[44:47], v[24:27], a[252:255]
  s_waitcnt lgkmcnt(7)
  v_mfma_f32_16x16x32_bf16 v[128:131], v[32:35], a[32:35], v[128:131]
  v_cndmask_b32_dpp v14, v83, v81, vcc row_ror:8 row_mask:0xf bank_mask:0xf
  v_mov_b32_dpp v83, v81 row_ror:8 row_mask:0xf bank_mask:0x3
  v_mfma_f32_16x16x32_bf16 v[160:163], v[36:39], a[32:35], v[160:163]
  v_cndmask_b32_dpp v15, v87, v85, vcc row_ror:8 row_mask:0xf bank_mask:0xf
  s_waitcnt lgkmcnt(6)
  v_mfma_f32_16x16x32_bf16 v[132:135], v[32:35], a[36:39], v[132:135]
  v_mov_b32_dpp v87, v85 row_ror:8 row_mask:0xf bank_mask:0x3
  v_mfma_f32_16x16x32_bf16 v[164:167], v[36:39], a[36:39], v[164:167]
  v_cndmask_b32_dpp v16, v91, v89, vcc row_ror:8 row_mask:0xf bank_mask:0xf
  s_waitcnt vmcnt(8)
  v_cmp_eq_u64 s[76:77], s[6:7], v[20:21]
  s_mov_b32 s78, 0
  s_and_b64 s[76:77], s[76:77], s[26:27]
  s_cmp_eq_u64 s[76:77], s[26:27]
  s_cbranch_scc0 k1fq_slow
k1fq_ok:
  s_waitcnt lgkmcnt(5)
  v_mfma_f32_16x16x32_bf16 v[136:139], v[32:35], a[40:43], v[136:139]
  v_mov_b32_dpp v91, v89 row_ror:8 row_mask:0xf bank_mask:0x3
  v_mfma_f32_16x16x32_bf16 v[168:171], v[36:39], a[40:43], v[168:171]
  v_cndmask_b32_dpp v17, v95, v93, vcc row_ror:8 row_mask:0xf bank_mask:0xf
  s_barrier
  s_waitcnt lgkmcnt(4)
  v_mfma_f32_16x16x32_bf16 v[140:143], v[32:35], a[44:47], v[140:143]
  v_mov_b32_dpp v95, v93 row_ror:8 row_mask:0xf bank_mask:0x3
  v_mfma_f32_16x16x32_bf16 v[172:175], v[36:39], a[44:47], v[172:175]
  v_perm_b32 v40, v83, v14, s70
  s_waitcnt lgkmcnt(3)
  v_mfma_f32_16x16x32_bf16 v[144:147], v[32:35], a[48:51], v[144:147]
  v_perm_b32 v44, v83, v14, s71
  ds_read_b128 a[0:3], v7 offset:0
  v_mfma_f32_16x16x32_bf16 v[176:179], v[36:39], a[48:51], v[176:179]
  v_perm_b32 v41, v87, v15, s70
  ds_read_b128 a[4:7], v7 offset:2048
  s_waitcnt lgkmcnt(4)
  v_mfma_f32_16x16x32_bf16 v[148:151], v[32:35], a[52:55], v[148:151]
  v_perm_b32 v45, v87, v15, s71
  v_mfma_f32_16x16x32_bf16 v[180:183], v[36:39], a[52:55], v[180:183]
  v_perm_b32 v42, v91, v16, s70
  ds_read_b128 a[8:11], v7 offset:4096
  s_waitcnt lgkmcnt(4)
  v_mfma_f32_16x16x32_bf16 v[152:155], v[32:35], a[56:59], v[152:155]
  v_perm_b32 v46, v91, v16, s71
  ds_read_b128 a[12:15], v7 offset:6144
  v_mfma_f32_16x16x32_bf16 v[184:187], v[36:39], a[56:59], v[184:187]
  v_perm_b32 v43, v95, v17, s70
  s_waitcnt lgkmcnt(4)
  v_mfma_f32_16x16x32_bf16 v[156:159], v[32:35], a[60:63], v[156:159]
  v_perm_b32 v47, v95, v17, s71
  v_mfma_f32_16x16x32_bf16 v[188:191], v[36:39], a[60:63], v[188:191]
  v_mfma_f32_16x16x32_bf16 a[240:243], v[32:35], v[24:27], a[240:243]
  v_mfma_f32_16x16x32_bf16 a[244:247], v[36:39], v[24:27], a[244:247]
  v_mfma_f32_16x16x32_bf16 v[192:195], v[40:43], a[32:35], v[192:195]
  v_cndmask_b32_dpp v14, v98, v96, vcc row_ror:8 row_mask:0xf bank_mask:0xf
  v_mov_b32_dpp v98, v96 row_ror:8 row_mask:0xf bank_mask:0x3
  buffer_load_dwordx4 v[80:83], v1, s[32:35], s68 offen
  buffer_load_dwordx4 a[64:67], v13, s[36:39], s99 offen offset:0 sc1
  v_mfma_f32_16x16x32_bf16 v[224:227], v[44:47], a[32:35], v[224:227]
  v_cndmask_b32_dpp v15, v102, v100, vcc row_ror:8 row_mask:0xf bank_mask:0xf
  ds_read_b128 a[16:19], v7 offset:8192
  buffer_load_dwordx4 v[84:87], v2, s[32:35], s68 offen
  v_mfma_f32_16x16x32_bf16 v[196:199], v[40:43], a[36:39], v[196:199]
  v_mov_b32_dpp v102, v100 row_ror:8 row_mask:0xf bank_mask:0x3
  v_mfma_f32_16x16x32_bf16 v[228:231], v[44:47], a[36:39], v[228:231]
  v_cndmask_b32_dpp v16, v106, v104, vcc row_ror:8 row_mask:0xf bank_mask:0xf
  ds_read_b128 a[20:23], v7 offset:10240
  buffer_load_dwordx4 v[88:91], v3, s[32:35], s68 offen
  buffer_load_dwordx4 a[68:71], v13, s[36:39], s99 offen offset:1024 sc1
  v_mfma_f32_16x16x32_bf16 v[200:203], v[40:43], a[40:43], v[200:203]
  v_mov_b32_dpp v106, v104 row_ror:8 row_mask:0xf bank_mask:0x3
  v_mfma_f32_16x16x32_bf16 v[232:235], v[44:47], a[40:43], v[232:235]
  v_cndmask_b32_dpp v17, v110, v108, vcc row_ror:8 row_mask:0xf bank_mask:0xf
  buffer_load_dwordx4 v[92:95], v4, s[32:35], s68 offen
  v_mfma_f32_16x16x32_bf16 v[204:207], v[40:43], a[44:47], v[204:207]
  v_mov_b32_dpp v110, v108 row_ror:8 row_mask:0xf bank_mask:0x3
  ds_read_b128 a[24:27], v7 offset:12288
  buffer_load_dwordx4 a[72:75], v13, s[36:39], s99 offen offset:2048 sc1
  v_mfma_f32_16x16x32_bf16 v[236:239], v[44:47], a[44:47], v[236:239]
  v_perm_b32 v32, v98, v14, s70
  v_mfma_f32_16x16x32_bf16 v[208:211], v[40:43], a[48:51], v[208:211]
  v_perm_b32 v36, v98, v14, s71
  ds_read_b128 a[28:31], v7 offset:14336
  v_mfma_f32_16x16x32_bf16 v[240:243], v[44:47], a[48:51], v[240:243]
  v_perm_b32 v33, v102, v15, s70
  buffer_load_dwordx4 a[76:79], v13, s[36:39], s99 offen offset:3072 sc1
  v_mfma_f32_16x16x32_bf16 v[212:215], v[40:43], a[52:55], v[212:215]
  v_perm_b32 v37, v102, v15, s71
  v_mfma_f32_16x16x32_bf16 v[244:247], v[44:47], a[52:55], v[244:247]
  v_perm_b32 v34, v106, v16, s70
  v_mfma_f32_16x16x32_bf16 v[216:219], v[40:43], a[56:59], v[216:219]
  v_perm_b32 v38, v106, v16, s71
  s_add_u32 s99, s99, 4096
  v_mfma_f32_16x16x32_bf16 v[248:251], v[44:47], a[56:59], v[248:251]
  v_perm_b32 v35, v110, v17, s70
  v_mfma_f32_16x16x32_bf16 v[220:223], v[40:43], a[60:63], v[220:223]
  v_perm_b32 v39, v110, v17, s71
  v_mfma_f32_16x16x32_bf16 v[252:255], v[44:47], a[60:63], v[252:255]
  v_mfma_f32_16x16x32_bf16 a[248:251], v[40:43], v[24:27], a[248:251]
  v_mfma_f32_16x16x32_bf16 a[252:255], v[44:47], v[24:27], a[252:255]
  s_waitcnt lgkmcnt(7)
  v_mfma_f32_16x16x32_bf16 v[128:131], v[32:35], a[0:3], v[128:131]
  v_cndmask_b32_dpp v14, v99, v97, vcc row_ror:8 row_mask:0xf bank_mask:0xf
  v_mov_b32_dpp v99, v97 row_ror:8 row_mask:0xf bank_mask:0x3
  buffer_load_dwordx4 a[80:83], v13, s[36:39], s99 offen offset:0 sc1
  v_mfma_f32_16x16x32_bf16 v[160:163], v[36:39], a[0:3], v[160:163]
  v_cndmask_b32_dpp v15, v103, v101, vcc row_ror:8 row_mask:0xf bank_mask:0xf
  s_waitcnt lgkmcnt(6)
  v_mfma_f32_16x16x32_bf16 v[132:135], v[32:35], a[4:7], v[132:135]
  v_mov_b32_dpp v103, v101 row_ror:8 row_mask:0xf bank_mask:0x3
  ds_read_b128 a[32:35], v8 offset:0
  v_mfma_f32_16x16x32_bf16 v[164:167], v[36:39], a[4:7], v[164:167]
  v_cndmask_b32_dpp v16, v107, v105, vcc row_ror:8 row_mask:0xf bank_mask:0xf
  buffer_load_dwordx4 a[84:87], v13, s[36:39], s99 offen offset:1024 sc1
  s_waitcnt lgkmcnt(6)
  v_mfma_f32_16x16x32_bf16 v[136:139], v[32:35], a[8:11], v[136:139]
  v_mov_b32_dpp v107, v105 row_ror:8 row_mask:0xf bank_mask:0x3
  v_mfma_f32_16x16x32_bf16 v[168:171], v[36:39], a[8:11], v[168:171]
  v_cndmask_b32_dpp v17, v111, v109, vcc row_ror:8 row_mask:0xf bank_mask:0xf
  ds_read_b128 a[36:39], v8 offset:2048
  s_waitcnt lgkmcnt(6)
  v_mfma_f32_16x16x32_bf16 v[140:143], v[32:35], a[12:15], v[140:143]
  v_mov_b32_dpp v111, v109 row_ror:8 row_mask:0xf bank_mask:0x3
  buffer_load_dwordx4 a[88:91], v13, s[36:39], s99 offen offset:2048 sc1
  v_mfma_f32_16x16x32_bf16 v[172:175], v[36:39], a[12:15], v[172:175]
  v_perm_b32 v40, v99, v14, s70
  s_waitcnt lgkmcnt(5)
  v_mfma_f32_16x16x32_bf16 v[144:147], v[32:35], a[16:19], v[144:147]
  v_perm_b32 v44, v99, v14, s71
  ds_read_b128 a[40:43], v8 offset:4096
  v_mfma_f32_16x16x32_bf16 v[176:179], v[36:39], a[16:19], v[176:179]
  v_perm_b32 v41, v103, v15, s70
  buffer_load_dwordx4 a[92:95], v13, s[36:39], s99 offen offset:3072 sc1
  s_waitcnt lgkmcnt(5)
  v_mfma_f32_16x16x32_bf16 v[148:151], v[32:35], a[20:23], v[148:151]
  v_perm_b32 v45, v103, v15, s71
  v_mfma_f32_16x16x32_bf16 v[180:183], v[36:39], a[20:23], v[180:183]
  v_perm_b32 v42, v107, v16, s70
  ds_read_b128 a[44:47], v8 offset:6144
  s_waitcnt lgkmcnt(5)
  v_mfma_f32_16x16x32_bf16 v[152:155], v[32:35], a[24:27], v[152:155]
  v_perm_b32 v46, v107, v16, s71
  s_add_u32 s99, s99, 4096
  v_mfma_f32_16x16x32_bf16 v[184:187], v[36:39], a[24:27], v[184:187]
  v_perm_b32 v43, v111, v17, s70
  s_waitcnt lgkmcnt(4)
  v_mfma_f32_16x16x32_bf16 v[156:159], v[32:35], a[28:31], v[156:159]
  v_perm_b32 v47, v111, v17, s71
  v_mfma_f32_16x16x32_bf16 v[188:191], v[36:39], a[28:31], v[188:191]
  v_mfma_f32_16x16x32_bf16 a[240:243], v[32:35], v[24:27], a[240:243]
  v_mfma_f32_16x16x32_bf16 a[244:247], v[36:39], v[24:27], a[244:247]
  v_mfma_f32_16x16x32_bf16 v[192:195], v[40:43], a[0:3], v[192:195]
  v_cndmask_b32_dpp v14, v114, v112, vcc row_ror:8 row_mask:0xf bank_mask:0xf
  v_mov_b32_dpp v114, v112 row_ror:8 row_mask:0xf bank_mask:0x3
  buffer_load_dwordx4 v[96:99], v1, s[32:35], s69 offen
  buffer_load_dwordx4 a[96:99], v13, s[36:39], s99 offen offset:0 sc1
  v_mfma_f32_16x16x32_bf16 v[224:227], v[44:47], a[0:3], v[224:227]
  v_cndmask_b32_dpp v15, v118, v116, vcc row_ror:8 row_mask:0xf bank_mask:0xf
  ds_read_b128 a[48:51], v8 offset:8192
  buffer_load_dwordx4 v[100:103], v2, s[32:35], s69 offen
  v_mfma_f32_16x16x32_bf16 v[196:199], v[40:43], a[4:7], v[196:199]
  v_mov_b32_dpp v118, v116 row_ror:8 row_mask:0xf bank_mask:0x3
  v_mfma_f32_16x16x32_bf16 v[228:231], v[44:47], a[4:7], v[228:231]
  v_cndmask_b32_dpp v16, v122, v120, vcc row_ror:8 row_mask:0xf bank_mask:0xf
  ds_read_b128 a[52:55], v8 offset:10240
  buffer_load_dwordx4 v[104:107], v3, s[32:35], s69 offen
  buffer_load_dwordx4 a[100:103], v13, s[36:39], s99 offen offset:1024 sc1
  v_mfma_f32_16x16x32_bf16 v[200:203], v[40:43], a[8:11], v[200:203]
  v_mov_b32_dpp v122, v120 row_ror:8 row_mask:0xf bank_mask:0x3
  v_mfma_f32_16x16x32_bf16 v[232:235], v[44:47], a[8:11], v[232:235]
  v_cndmask_b32_dpp v17, v126, v124, vcc row_ror:8 row_mask:0xf bank_mask:0xf
  buffer_load_dwordx4 v[108:111], v4, s[32:35], s69 offen
  v_mfma_f32_16x16x32_bf16 v[204:207], v[40:43], a[12:15], v[204:207]
  v_mov_b32_dpp v126, v124 row_ror:8 row_mask:0xf bank_mask:0x3
  ds_read_b128 a[56:59], v8 offset:12288
  buffer_load_dwordx4 a[104:107], v13, s[36:39], s99 offen offset:2048 sc1
  v_mfma_f32_16x16x32_bf16 v[236:239], v[44:47], a[12:15], v[236:239]
  v_perm_b32 v32, v114, v14, s70
  v_mfma_f32_16x16x32_bf16 v[208:211], v[40:43], a[16:19], v[208:211]
  v_perm_b32 v36, v114, v14, s71
  ds_read_b128 a[60:63], v8 offset:14336
  v_mfma_f32_16x16x32_bf16 v[240:243], v[44:47], a[16:19], v[240:243]
  v_perm_b32 v33, v118, v15, s70
  buffer_load_dwordx4 a[108:111], v13, s[36:39], s99 offen offset:3072 sc1
  v_mfma_f32_16x16x32_bf16 v[212:215], v[40:43], a[20:23], v[212:215]
  v_perm_b32 v37, v118, v15, s71
  v_mfma_f32_16x16x32_bf16 v[244:247], v[44:47], a[20:23], v[244:247]
  v_perm_b32 v34, v122, v16, s70
  v_mfma_f32_16x16x32_bf16 v[216:219], v[40:43], a[24:27], v[216:219]
  v_perm_b32 v38, v122, v16, s71
  s_add_u32 s99, s99, 4096
  v_mfma_f32_16x16x32_bf16 v[248:251], v[44:47], a[24:27], v[248:251]
  v_perm_b32 v35, v126, v17, s70
  v_mfma_f32_16x16x32_bf16 v[220:223], v[40:43], a[28:31], v[220:223]
  v_perm_b32 v39, v126, v17, s71
  v_mfma_f32_16x16x32_bf16 v[252:255], v[44:47], a[28:31], v[252:255]
  v_mfma_f32_16x16x32_bf16 a[248:251], v[40:43], v[24:27], a[248:251]
  v_mfma_f32_16x16x32_bf16 a[252:255], v[44:47], v[24:27], a[252:255]
  s_waitcnt lgkmcnt(7)
  v_mfma_f32_16x16x32_bf16 v[128:131], v[32:35], a[32:35], v[128:131]
  v_cndmask_b32_dpp v14, v115, v113, vcc row_ror:8 row_mask:0xf bank_mask:0xf
  v_mov_b32_dpp v115, v113 row_ror:8 row_mask:0xf bank_mask:0x3
  buffer_load_dwordx4 a[112:115], v13, s[36:39], s99 offen offset:0 sc1
  v_mfma_f32_16x16x32_bf16 v[160:163], v[36:39], a[32:35], v[160:163]
  v_cndmask_b32_dpp v15, v119, v117, vcc row_ror:8 row_mask:0xf bank_mask:0xf
  s_waitcnt lgkmcnt(6)
  v_mfma_f32_16x16x32_bf16 v[132:135], v[32:35], a[36:39], v[132:135]
  v_mov_b32_dpp v119, v117 row_ror:8 row_mask:0xf bank_mask:0x3
  s_barrier
  v_mfma_f32_16x16x32_bf16 v[164:167], v[36:39], a[36:39], v[164:167]
  v_cndmask_b32_dpp v16, v123, v121, vcc row_ror:8 row_mask:0xf bank_mask:0xf
  buffer_load_dwordx4 a[116:119], v13, s[36:39], s99 offen offset:1024 sc1
  s_waitcnt lgkmcnt(5)
  v_mfma_f32_16x16x32_bf16 v[136:139], v[32:35], a[40:43], v[136:139]
  v_mov_b32_dpp v123, v121 row_ror:8 row_mask:0xf bank_mask:0x3
  ds_read_b128 a[0:3], v7 offset:16384
  v_mfma_f32_16x16x32_bf16 v[168:171], v[36:39], a[40:43], v[168:171]
  v_cndmask_b32_dpp v17, v127, v125, vcc row_ror:8 row_mask:0xf bank_mask:0xf
  s_waitcnt lgkmcnt(5)
  v_mfma_f32_16x16x32_bf16 v[140:143], v[32:35], a[44:47], v[140:143]
  v_mov_b32_dpp v127, v125 row_ror:8 row_mask:0xf bank_mask:0x3
  ds_read_b128 a[4:7], v7 offset:18432
  buffer_load_dwordx4 a[120:123], v13, s[36:39], s99 offen offset:2048 sc1
  v_mfma_f32_16x16x32_bf16 v[172:175], v[36:39], a[44:47], v[172:175]
  v_perm_b32 v40, v115, v14, s70
  s_waitcnt lgkmcnt(5)
  v_mfma_f32_16x16x32_bf16 v[144:147], v[32:35], a[48:51], v[144:147]
  v_perm_b32 v44, v115, v14, s71
  v_mfma_f32_16x16x32_bf16 v[176:179], v[36:39], a[48:51], v[176:179]
  v_perm_b32 v41, v119, v15, s70
  ds_read_b128 a[8:11], v7 offset:20480
  buffer_load_dwordx4 a[124:127], v13, s[36:39], s99 offen offset:3072 sc1
  s_waitcnt lgkmcnt(5)
  v_mfma_f32_16x16x32_bf16 v[148:151], v[32:35], a[52:55], v[148:151]
  v_perm_b32 v45, v119, v15, s71
  v_mfma_f32_16x16x32_bf16 v[180:183], v[36:39], a[52:55], v[180:183]
  v_perm_b32 v42, v123, v16, s70
  ds_read_b128 a[12:15], v7 offset:22528
  s_waitcnt lgkmcnt(5)
  v_mfma_f32_16x16x32_bf16 v[152:155], v[32:35], a[56:59], v[152:155]
  v_perm_b32 v46, v123, v16, s71
  s_add_u32 s99, s99, 4096
  v_mfma_f32_16x16x32_bf16 v[184:187], v[36:39], a[56:59], v[184:187]
  v_perm_b32 v43, v127, v17, s70
  s_waitcnt lgkmcnt(4)
  v_mfma_f32_16x16x32_bf16 v[156:159], v[32:35], a[60:63], v[156:159]
  v_perm_b32 v47, v127, v17, s71
  v_mfma_f32_16x16x32_bf16 v[188:191], v[36:39], a[60:63], v[188:191]
  v_mfma_f32_16x16x32_bf16 a[240:243], v[32:35], v[24:27], a[240:243]
  v_mfma_f32_16x16x32_bf16 a[244:247], v[36:39], v[24:27], a[244:247]
  v_mfma_f32_16x16x32_bf16 v[192:195], v[40:43], a[32:35], v[192:195]
  s_waitcnt vmcnt(31)
  v_cndmask_b32_dpp v14, v50, v48, vcc row_ror:8 row_mask:0xf bank_mask:0xf
  v_mov_b32_dpp v50, v48 row_ror:8 row_mask:0xf bank_mask:0x3
  buffer_load_dwordx4 a[128:131], v13, s[36:39], s99 offen offset:0 sc1
  v_mfma_f32_16x16x32_bf16 v[224:227], v[44:47], a[32:35], v[224:227]
  s_waitcnt vmcnt(31)
  v_cndmask_b32_dpp v15, v54, v52, vcc row_ror:8 row_mask:0xf bank_mask:0xf
  ds_read_b128 a[16:19], v7 offset:24576
  v_mfma_f32_16x16x32_bf16 v[196:199], v[40:43], a[36:39], v[196:199]
  v_mov_b32_dpp v54, v52 row_ror:8 row_mask:0xf bank_mask:0x3
  v_mfma_f32_16x16x32_bf16 v[228:231], v[44:47], a[36:39], v[228:231]
  s_waitcnt vmcnt(30)
  v_cndmask_b32_dpp v16, v58, v56, vcc row_ror:8 row_mask:0xf bank_mask:0xf
  ds_read_b128 a[20:23], v7 offset:26624
  buffer_load_dwordx4 a[132:135], v13, s[36:39], s99 offen offset:1024 sc1
  v_mfma_f32_16x16x32_bf16 v[200:203], v[40:43], a[40:43], v[200:203]
  v_mov_b32_dpp v58, v56 row_ror:8 row_mask:0xf bank_mask:0x3
  v_mfma_f32_16x16x32_bf16 v[232:235], v[44:47], a[40:43], v[232:235]
  s_waitcnt vmcnt(30)
  v_cndmask_b32_dpp v17, v62, v60, vcc row_ror:8 row_mask:0xf bank_mask:0xf
  v_mfma_f32_16x16x32_bf16 v[204:207], v[40:43], a[44:47], v[204:207]
  v_mov_b32_dpp v62, v60 row_ror:8 row_mask:0xf bank_mask:0x3
  ds_read_b128 a[24:27], v7 offset:28672
  buffer_load_dwordx4 a[136:139], v13, s[36:39], s99 offen offset:2048 sc1
  v_mfma_f32_16x16x32_bf16 v[236:239], v[44:47], a[44:47], v[236:239]
  v_perm_b32 v32, v50, v14, s70
  v_mfma_f32_16x16x32_bf16 v[208:211], v[40:43], a[48:51], v[208:211]
  v_perm_b32 v36, v50, v14, s71
  ds_read_b128 a[28:31], v7 offset:30720
  v_mfma_f32_16x16x32_bf16 v[240:243], v[44:47], a[48:51], v[240:243]
  v_perm_b32 v33, v54, v15, s70
  buffer_load_dwordx4 a[140:143], v13, s[36:39], s99 offen offset:3072 sc1
  v_mfma_f32_16x16x32_bf16 v[212:215], v[40:43], a[52:55], v[212:215]
  v_perm_b32 v37, v54, v15, s71
  v_mfma_f32_16x16x32_bf16 v[244:247], v[44:47], a[52:55], v[244:247]
  v_perm_b32 v34, v58, v16, s70
  v_mfma_f32_16x16x32_bf16 v[216:219], v[40:43], a[56:59], v[216:219]
  v_perm_b32 v38, v58, v16, s71
  s_add_u32 s99, s99, 4096
  v_mfma_f32_16x16x32_bf16 v[248:251], v[44:47], a[56:59], v[248:251]
  v_perm_b32 v35, v62, v17, s70
  v_mfma_f32_16x16x32_bf16 v[220:223], v[40:43], a[60:63], v[220:223]
  v_perm_b32 v39, v62, v17, s71
  v_mfma_f32_16x16x32_bf16 v[252:255], v[44:47], a[60:63], v[252:255]
  v_mfma_f32_16x16x32_bf16 a[248:251], v[40:43], v[24:27], a[248:251]
  v_mfma_f32_16x16x32_bf16 a[252:255], v[44:47], v[24:27], a[252:255]
  s_waitcnt lgkmcnt(7)
  v_mfma_f32_16x16x32_bf16 v[128:131], v[32:35], a[0:3], v[128:131]
  v_cndmask_b32_dpp v14, v51, v49, vcc row_ror:8 row_mask:0xf bank_mask:0xf
  v_mov_b32_dpp v51, v49 row_ror:8 row_mask:0xf bank_mask:0x3
  buffer_load_dwordx4 a[144:147], v13, s[36:39], s99 offen offset:0 sc1
  v_mfma_f32_16x16x32_bf16 v[160:163], v[36:39], a[0:3], v[160:163]
  v_cndmask_b32_dpp v15, v55, v53, vcc row_ror:8 row_mask:0xf bank_mask:0xf
  s_waitcnt lgkmcnt(6)
  v_mfma_f32_16x16x32_bf16 v[132:135], v[32:35], a[4:7], v[132:135]
  v_mov_b32_dpp v55, v53 row_ror:8 row_mask:0xf bank_mask:0x3
  ds_read_b128 a[32:35], v8 offset:16384
  v_mfma_f32_16x16x32_bf16 v[164:167], v[36:39], a[4:7], v[164:167]
  v_cndmask_b32_dpp v16, v59, v57, vcc row_ror:8 row_mask:0xf bank_mask:0xf
  buffer_load_dwordx4 a[148:151], v13, s[36:39], s99 offen offset:1024 sc1
  s_waitcnt lgkmcnt(6)
  v_mfma_f32_16x16x32_bf16 v[136:139], v[32:35], a[8:11], v[136:139]
  v_mov_b32_dpp v59, v57 row_ror:8 row_mask:0xf bank_mask:0x3
  v_mfma_f32_16x16x32_bf16 v[168:171], v[36:39], a[8:11], v[168:171]
  v_cndmask_b32_dpp v17, v63, v61, vcc row_ror:8 row_mask:0xf bank_mask:0xf
  ds_read_b128 a[36:39], v8 offset:18432
  s_waitcnt lgkmcnt(6)
  v_mfma_f32_16x16x32_bf16 v[140:143], v[32:35], a[12:15], v[140:143]
  v_mov_b32_dpp v63, v61 row_ror:8 row_mask:0xf bank_mask:0x3
  buffer_load_dwordx4 a[152:155], v13, s[36:39], s99 offen offset:2048 sc1
  v_mfma_f32_16x16x32_bf16 v[172:175], v[36:39], a[12:15], v[172:175]
  v_perm_b32 v40, v51, v14, s70
  s_waitcnt lgkmcnt(5)
  v_mfma_f32_16x16x32_bf16 v[144:147], v[32:35], a[16:19], v[144:147]
  v_perm_b32 v44, v51, v14, s71
  ds_read_b128 a[40:43], v8 offset:20480
  v_mfma_f32_16x16x32_bf16 v[176:179], v[36:39], a[16:19], v[176:179]
  v_perm_b32 v41, v55, v15, s70
  buffer_load_dwordx4 a[156:159], v13, s[36:39], s99 offen offset:3072 sc1
  s_waitcnt lgkmcnt(5)
  v_mfma_f32_16x16x32_bf16 v[148:151], v[32:35], a[20:23], v[148:151]
  v_perm_b32 v45, v55, v15, s71
  v_mfma_f32_16x16x32_bf16 v[180:183], v[36:39], a[20:23], v[180:183]
  v_perm_b32 v42, v59, v16, s70
  ds_read_b128 a[44:47], v8 offset:22528
  s_waitcnt lgkmcnt(5)
  v_mfma_f32_16x16x32_bf16 v[152:155], v[32:35], a[24:27], v[152:155]
  v_perm_b32 v46, v59, v16, s71
  s_add_u32 s99, s99, 4096
  v_mfma_f32_16x16x32_bf16 v[184:187], v[36:39], a[24:27], v[184:187]
  v_perm_b32 v43, v63, v17, s70
  s_waitcnt lgkmcnt(4)
  v_mfma_f32_16x16x32_bf16 v[156:159], v[32:35], a[28:31], v[156:159]
  v_perm_b32 v47, v63, v17, s71
  v_mfma_f32_16x16x32_bf16 v[188:191], v[36:39], a[28:31], v[188:191]
  v_mfma_f32_16x16x32_bf16 a[240:243], v[32:35], v[24:27], a[240:243]
  v_mfma_f32_16x16x32_bf16 a[244:247], v[36:39], v[24:27], a[244:247]
  v_mfma_f32_16x16x32_bf16 v[192:195], v[40:43], a[0:3], v[192:195]
  s_waitcnt vmcnt(35)
  v_cndmask_b32_dpp v14, v66, v64, vcc row_ror:8 row_mask:0xf bank_mask:0xf
  v_mov_b32_dpp v66, v64 row_ror:8 row_mask:0xf bank_mask:0x3
  buffer_load_dwordx4 a[160:163], v13, s[36:39], s99 offen offset:0 sc1
  v_mfma_f32_16x16x32_bf16 v[224:227], v[44:47], a[0:3], v[224:227]
  s_waitcnt vmcnt(35)
  v_cndmask_b32_dpp v15, v70, v68, vcc row_ror:8 row_mask:0xf bank_mask:0xf
  ds_read_b128 a[48:51], v8 offset:24576
  v_mfma_f32_16x16x32_bf16 v[196:199], v[40:43], a[4:7], v[196:199]
  v_mov_b32_dpp v70, v68 row_ror:8 row_mask:0xf bank_mask:0x3
  v_mfma_f32_16x16x32_bf16 v[228:231], v[44:47], a[4:7], v[228:231]
  s_waitcnt vmcnt(34)
  v_cndmask_b32_dpp v16, v74, v72, vcc row_ror:8 row_mask:0xf bank_mask:0xf
  ds_read_b128 a[52:55], v8 offset:26624
  buffer_load_dwordx4 a[164:167], v13, s[36:39], s99 offen offset:1024 sc1
  v_mfma_f32_16x16x32_bf16 v[200:203], v[40:43], a[8:11], v[200:203]
  v_mov_b32_dpp v74, v72 row_ror:8 row_mask:0xf bank_mask:0x3
  v_mfma_f32_16x16x32_bf16 v[232:235], v[44:47], a[8:11], v[232:235]
  s_waitcnt vmcnt(34)
  v_cndmask_b32_dpp v17, v78, v76, vcc row_ror:8 row_mask:0xf bank_mask:0xf
  v_mfma_f32_16x16x32_bf16 v[204:207], v[40:43], a[12:15], v[204:207]
  v_mov_b32_dpp v78, v76 row_ror:8 row_mask:0xf bank_mask:0x3
  ds_read_b128 a[56:59], v8 offset:28672
  buffer_load_dwordx4 a[168:171], v13, s[36:39], s99 offen offset:2048 sc1
  v_mfma_f32_16x16x32_bf16 v[236:239], v[44:47], a[12:15], v[236:239]
  v_perm_b32 v32, v66, v14, s70
  v_mfma_f32_16x16x32_bf16 v[208:211], v[40:43], a[16:19], v[208:211]
  v_perm_b32 v36, v66, v14, s71
  ds_read_b128 a[60:63], v8 offset:30720
  v_mfma_f32_16x16x32_bf16 v[240:243], v[44:47], a[16:19], v[240:243]
  v_perm_b32 v33, v70, v15, s70
  buffer_load_dwordx4 a[172:175], v13, s[36:39], s99 offen offset:3072 sc1
  v_mfma_f32_16x16x32_bf16 v[212:215], v[40:43], a[20:23], v[212:215]
  v_perm_b32 v37, v70, v15, s71
  v_mfma_f32_16x16x32_bf16 v[244:247], v[44:47], a[20:23], v[244:247]
  v_perm_b32 v34, v74, v16, s70
  v_mfma_f32_16x16x32_bf16 v[216:219], v[40:43], a[24:27], v[216:219]
  v_perm_b32 v38, v74, v16, s71
  s_add_u32 s99, s99, 4096
  v_mfma_f32_16x16x32_bf16 v[248:251], v[44:47], a[24:27], v[248:251]
  v_perm_b32 v35, v78, v17, s70
  v_mfma_f32_16x16x32_bf16 v[220:223], v[40:43], a[28:31], v[220:223]
  v_perm_b32 v39, v78, v17, s71
  v_mfma_f32_16x16x32_bf16 v[252:255], v[44:47], a[28:31], v[252:255]
  v_mfma_f32_16x16x32_bf16 a[248:251], v[40:43], v[24:27], a[248:251]
  v_mfma_f32_16x16x32_bf16 a[252:255], v[44:47], v[24:27], a[252:255]
  s_waitcnt lgkmcnt(7)
  v_mfma_f32_16x16x32_bf16 v[128:131], v[32:35], a[32:35], v[128:131]
  v_cndmask_b32_dpp v14, v67, v65, vcc row_ror:8 row_mask:0xf bank_mask:0xf
  v_mov_b32_dpp v67, v65 row_ror:8 row_mask:0xf bank_mask:0x3
  buffer_load_dwordx4 a[176:179], v13, s[36:39], s99 offen offset:0 sc1
  v_mfma_f32_16x16x32_bf16 v[160:163], v[36:39], a[32:35], v[160:163]
  v_cndmask_b32_dpp v15, v71, v69, vcc row_ror:8 row_mask:0xf bank_mask:0xf
  s_waitcnt lgkmcnt(6)
  v_mfma_f32_16x16x32_bf16 v[132:135], v[32:35], a[36:39], v[132:135]
  v_mov_b32_dpp v71, v69 row_ror:8 row_mask:0xf bank_mask:0x3
  s_barrier
  v_mfma_f32_16x16x32_bf16 v[164:167], v[36:39], a[36:39], v[164:167]
  v_cndmask_b32_dpp v16, v75, v73, vcc row_ror:8 row_mask:0xf bank_mask:0xf
  buffer_load_dwordx4 a[180:183], v13, s[36:39], s99 offen offset:1024 sc1
  s_waitcnt lgkmcnt(5)
  v_mfma_f32_16x16x32_bf16 v[136:139], v[32:35], a[40:43], v[136:139]
  v_mov_b32_dpp v75, v73 row_ror:8 row_mask:0xf bank_mask:0x3
  ds_read_b128 a[0:3], v7 offset:32768
  v_mfma_f32_16x16x32_bf16 v[168:171], v[36:39], a[40:43], v[168:171]
  v_cndmask_b32_dpp v17, v79, v77, vcc row_ror:8 row_mask:0xf bank_mask:0xf
  s_waitcnt lgkmcnt(5)
  v_mfma_f32_16x16x32_bf16 v[140:143], v[32:35], a[44:47], v[140:143]
  v_mov_b32_dpp v79, v77 row_ror:8 row_mask:0xf bank_mask:0x3
  ds_read_b128 a[4:7], v7 offset:34816
  buffer_load_dwordx4 a[184:187], v13, s[36:39], s99 offen offset:2048 sc1
  v_mfma_f32_16x16x32_bf16 v[172:175], v[36:39], a[44:47], v[172:175]
  v_perm_b32 v40, v67, v14, s70
  s_waitcnt lgkmcnt(5)
  v_mfma_f32_16x16x32_bf16 v[144:147], v[32:35], a[48:51], v[144:147]
  v_perm_b32 v44, v67, v14, s71
  v_mfma_f32_16x16x32_bf16 v[176:179], v[36:39], a[48:51], v[176:179]
  v_perm_b32 v41, v71, v15, s70
  ds_read_b128 a[8:11], v7 offset:36864
  buffer_load_dwordx4 a[188:191], v13, s[36:39], s99 offen offset:3072 sc1
  s_waitcnt lgkmcnt(5)
  v_mfma_f32_16x16x32_bf16 v[148:151], v[32:35], a[52:55], v[148:151]
  v_perm_b32 v45, v71, v15, s71
  v_mfma_f32_16x16x32_bf16 v[180:183], v[36:39], a[52:55], v[180:183]
  v_perm_b32 v42, v75, v16, s70
  ds_read_b128 a[12:15], v7 offset:38912
  s_waitcnt lgkmcnt(5)
  v_mfma_f32_16x16x32_bf16 v[152:155], v[32:35], a[56:59], v[152:155]
  v_perm_b32 v46, v75, v16, s71
  s_add_u32 s99, s99, 4096
  v_mfma_f32_16x16x32_bf16 v[184:187], v[36:39], a[56:59], v[184:187]
  v_perm_b32 v43, v79, v17, s70
  s_waitcnt lgkmcnt(4)
  v_mfma_f32_16x16x32_bf16 v[156:159], v[32:35], a[60:63], v[156:159]
  v_perm_b32 v47, v79, v17, s71
  v_mfma_f32_16x16x32_bf16 v[188:191], v[36:39], a[60:63], v[188:191]
  v_mfma_f32_16x16x32_bf16 a[240:243], v[32:35], v[24:27], a[240:243]
  v_mfma_f32_16x16x32_bf16 a[244:247], v[36:39], v[24:27], a[244:247]
  v_mfma_f32_16x16x32_bf16 v[192:195], v[40:43], a[32:35], v[192:195]
  s_waitcnt vmcnt(39)
  v_cndmask_b32_dpp v14, v82, v80, vcc row_ror:8 row_mask:0xf bank_mask:0xf
  v_mov_b32_dpp v82, v80 row_ror:8 row_mask:0xf bank_mask:0x3
  s_lshl_b32 s80, s94, 9
  s_add_u32 s80, s80, 14680064
  v_and_b32 v9, 15, v0
  v_lshl_add_u32 v9, v9, 2, s80
  s_cmp_eq_u32 s96, 2
  s_cselect_b32 s81, 64, 56
  s_cselect_b32 s82, 32, 28
  s_mul_i32 s81, s81, s95
  v_bfe_u32 v11, v0, 4, 1
  v_mul_u32_u24 v11, s82, v11
  v_lshrrev_b32 v10, 5, v0
  v_lshl_add_u32 v11, v10, 2, v11
  v_add_u32 v11, s81, v11
  v_lshlrev_b32 v11, 1, v11
  s_mov_b32 s84, 8192
  buffer_load_dword v112, v9, s[36:39], 0 offen offset:0 sc1
  v_mfma_f32_16x16x32_bf16 v[224:227], v[44:47], a[32:35], v[224:227]
  s_waitcnt vmcnt(38)
  v_cndmask_b32_dpp v15, v86, v84, vcc row_ror:8 row_mask:0xf bank_mask:0xf
  ds_read_b128 a[16:19], v7 offset:40960
  buffer_load_dword v120, v9, s[36:39], s84 offen offset:0 sc1
  buffer_load_dword v113, v9, s[36:39], 0 offen offset:64 sc1
  v_mfma_f32_16x16x32_bf16 v[196:199], v[40:43], a[36:39], v[196:199]
  v_mov_b32_dpp v86, v84 row_ror:8 row_mask:0xf bank_mask:0x3
  buffer_load_dword v121, v9, s[36:39], s84 offen offset:64 sc1
  v_mfma_f32_16x16x32_bf16 v[228:231], v[44:47], a[36:39], v[228:231]
  s_waitcnt vmcnt(40)
  v_cndmask_b32_dpp v16, v90, v88, vcc row_ror:8 row_mask:0xf bank_mask:0xf
  ds_read_b128 a[20:23], v7 offset:43008
  buffer_load_dword v114, v9, s[36:39], 0 offen offset:128 sc1
  buffer_load_dword v122, v9, s[36:39], s84 offen offset:128 sc1
  v_mfma_f32_16x16x32_bf16 v[200:203], v[40:43], a[40:43], v[200:203]
  v_mov_b32_dpp v90, v88 row_ror:8 row_mask:0xf bank_mask:0x3
  buffer_load_dword v115, v9, s[36:39], 0 offen offset:192 sc1
  buffer_load_dword v123, v9, s[36:39], s84 offen offset:192 sc1
  v_mfma_f32_16x16x32_bf16 v[232:235], v[44:47], a[40:43], v[232:235]
  s_waitcnt vmcnt(42)
  v_cndmask_b32_dpp v17, v94, v92, vcc row_ror:8 row_mask:0xf bank_mask:0xf
  buffer_load_dword v116, v9, s[36:39], 0 offen offset:256 sc1
  v_mfma_f32_16x16x32_bf16 v[204:207], v[40:43], a[44:47], v[204:207]
  v_mov_b32_dpp v94, v92 row_ror:8 row_mask:0xf bank_mask:0x3
  ds_read_b128 a[24:27], v7 offset:45056
  buffer_load_dword v124, v9, s[36:39], s84 offen offset:256 sc1
  buffer_load_dword v117, v9, s[36:39], 0 offen offset:320 sc1
  v_mfma_f32_16x16x32_bf16 v[236:239], v[44:47], a[44:47], v[236:239]
  v_perm_b32 v32, v82, v14, s70
  buffer_load_dword v125, v9, s[36:39], s84 offen offset:320 sc1
  v_mfma_f32_16x16x32_bf16 v[208:211], v[40:43], a[48:51], v[208:211]
  v_perm_b32 v36, v82, v14, s71
  ds_read_b128 a[28:31], v7 offset:47104
  buffer_load_dword v118, v9, s[36:39], 0 offen offset:384 sc1
  buffer_load_dword v126, v9, s[36:39], s84 offen offset:384 sc1
  v_mfma_f32_16x16x32_bf16 v[240:243], v[44:47], a[48:51], v[240:243]
  v_perm_b32 v33, v86, v15, s70
  buffer_load_dword v119, v9, s[36:39], 0 offen offset:448 sc1
  buffer_load_dword v127, v9, s[36:39], s84 offen offset:448 sc1
  v_mfma_f32_16x16x32_bf16 v[212:215], v[40:43], a[52:55], v[212:215]
  v_perm_b32 v37, v86, v15, s71
  buffer_load_dwordx2 v[48:49], v11, s[44:47], 0 offen offset:0
  v_mfma_f32_16x16x32_bf16 v[244:247], v[44:47], a[52:55], v[244:247]
  v_perm_b32 v34, v90, v16, s70
  buffer_load_dwordx2 v[50:51], v11, s[44:47], 0 offen offset:16
  buffer_load_dwordx2 v[52:53], v11, s[44:47], 0 offen offset:32
  v_mfma_f32_16x16x32_bf16 v[216:219], v[40:43], a[56:59], v[216:219]
  v_perm_b32 v38, v90, v16, s71
  buffer_load_dwordx2 v[54:55], v11, s[44:47], 0 offen offset:48
  buffer_load_dwordx4 a[192:195], v13, s[36:39], s99 offen offset:0 sc1
  v_mfma_f32_16x16x32_bf16 v[248:251], v[44:47], a[56:59], v[248:251]
  v_perm_b32 v35, v94, v17, s70
  buffer_load_dwordx4 a[196:199], v13, s[36:39], s99 offen offset:1024 sc1
  v_mfma_f32_16x16x32_bf16 v[220:223], v[40:43], a[60:63], v[220:223]
  v_perm_b32 v39, v94, v17, s71
  buffer_load_dwordx4 a[200:203], v13, s[36:39], s99 offen offset:2048 sc1
  buffer_load_dwordx4 a[204:207], v13, s[36:39], s99 offen offset:3072 sc1
  v_mfma_f32_16x16x32_bf16 v[252:255], v[44:47], a[60:63], v[252:255]
  s_add_u32 s99, s99, 4096
  v_mfma_f32_16x16x32_bf16 a[248:251], v[40:43], v[24:27], a[248:251]
  v_mfma_f32_16x16x32_bf16 a[252:255], v[44:47], v[24:27], a[252:255]
  s_waitcnt lgkmcnt(7)
  v_mfma_f32_16x16x32_bf16 v[128:131], v[32:35], a[0:3], v[128:131]
  v_cndmask_b32_dpp v14, v83, v81, vcc row_ror:8 row_mask:0xf bank_mask:0xf
  v_mov_b32_dpp v83, v81 row_ror:8 row_mask:0xf bank_mask:0x3
  buffer_load_dwordx4 a[208:211], v13, s[36:39], s99 offen offset:0 sc1
  v_mfma_f32_16x16x32_bf16 v[160:163], v[36:39], a[0:3], v[160:163]
  v_cndmask_b32_dpp v15, v87, v85, vcc row_ror:8 row_mask:0xf bank_mask:0xf
  s_waitcnt lgkmcnt(6)
  v_mfma_f32_16x16x32_bf16 v[132:135], v[32:35], a[4:7], v[132:135]
  v_mov_b32_dpp v87, v85 row_ror:8 row_mask:0xf bank_mask:0x3
  ds_read_b128 a[32:35], v8 offset:32768
  v_mfma_f32_16x16x32_bf16 v[164:167], v[36:39], a[4:7], v[164:167]
  v_cndmask_b32_dpp v16, v91, v89, vcc row_ror:8 row_mask:0xf bank_mask:0xf
  buffer_load_dwordx4 a[212:215], v13, s[36:39], s99 offen offset:1024 sc1
  s_waitcnt lgkmcnt(6)
  v_mfma_f32_16x16x32_bf16 v[136:139], v[32:35], a[8:11], v[136:139]
  v_mov_b32_dpp v91, v89 row_ror:8 row_mask:0xf bank_mask:0x3
  v_mfma_f32_16x16x32_bf16 v[168:171], v[36:39], a[8:11], v[168:171]
  v_cndmask_b32_dpp v17, v95, v93, vcc row_ror:8 row_mask:0xf bank_mask:0xf
  ds_read_b128 a[36:39], v8 offset:34816
  s_waitcnt lgkmcnt(6)
  v_mfma_f32_16x16x32_bf16 v[140:143], v[32:35], a[12:15], v[140:143]
  v_mov_b32_dpp v95, v93 row_ror:8 row_mask:0xf bank_mask:0x3
  buffer_load_dwordx4 a[216:219], v13, s[36:39], s99 offen offset:2048 sc1
  v_mfma_f32_16x16x32_bf16 v[172:175], v[36:39], a[12:15], v[172:175]
  v_perm_b32 v40, v83, v14, s70
  s_waitcnt lgkmcnt(5)
  v_mfma_f32_16x16x32_bf16 v[144:147], v[32:35], a[16:19], v[144:147]
  v_perm_b32 v44, v83, v14, s71
  ds_read_b128 a[40:43], v8 offset:36864
  v_mfma_f32_16x16x32_bf16 v[176:179], v[36:39], a[16:19], v[176:179]
  v_perm_b32 v41, v87, v15, s70
  buffer_load_dwordx4 a[220:223], v13, s[36:39], s99 offen offset:3072 sc1
  s_waitcnt lgkmcnt(5)
  v_mfma_f32_16x16x32_bf16 v[148:151], v[32:35], a[20:23], v[148:151]
  v_perm_b32 v45, v87, v15, s71
  v_mfma_f32_16x16x32_bf16 v[180:183], v[36:39], a[20:23], v[180:183]
  v_perm_b32 v42, v91, v16, s70
  ds_read_b128 a[44:47], v8 offset:38912
  s_waitcnt lgkmcnt(5)
  v_mfma_f32_16x16x32_bf16 v[152:155], v[32:35], a[24:27], v[152:155]
  v_perm_b32 v46, v91, v16, s71
  s_add_u32 s99, s99, 4096
  v_mfma_f32_16x16x32_bf16 v[184:187], v[36:39], a[24:27], v[184:187]
  v_perm_b32 v43, v95, v17, s70
  s_waitcnt lgkmcnt(4)
  v_mfma_f32_16x16x32_bf16 v[156:159], v[32:35], a[28:31], v[156:159]
  v_perm_b32 v47, v95, v17, s71
  v_mfma_f32_16x16x32_bf16 v[188:191], v[36:39], a[28:31], v[188:191]
  v_mfma_f32_16x16x32_bf16 a[240:243], v[32:35], v[24:27], a[240:243]
  v_mfma_f32_16x16x32_bf16 a[244:247], v[36:39], v[24:27], a[244:247]
  v_mfma_f32_16x16x32_bf16 v[192:195], v[40:43], a[0:3], v[192:195]
  s_waitcnt vmcnt(55)
  v_cndmask_b32_dpp v14, v98, v96, vcc row_ror:8 row_mask:0xf bank_mask:0xf
  v_mov_b32_dpp v98, v96 row_ror:8 row_mask:0xf bank_mask:0x3
  buffer_load_dwordx4 a[224:227], v13, s[36:39], s99 offen offset:0 sc1
  v_mfma_f32_16x16x32_bf16 v[224:227], v[44:47], a[0:3], v[224:227]
  s_waitcnt vmcnt(54)
  v_cndmask_b32_dpp v15, v102, v100, vcc row_ror:8 row_mask:0xf bank_mask:0xf
  ds_read_b128 a[48:51], v8 offset:40960
  v_mfma_f32_16x16x32_bf16 v[196:199], v[40:43], a[4:7], v[196:199]
  v_mov_b32_dpp v102, v100 row_ror:8 row_mask:0xf bank_mask:0x3
  v_mfma_f32_16x16x32_bf16 v[228:231], v[44:47], a[4:7], v[228:231]
  s_waitcnt vmcnt(53)
  v_cndmask_b32_dpp v16, v106, v104, vcc row_ror:8 row_mask:0xf bank_mask:0xf
  ds_read_b128 a[52:55], v8 offset:43008
  buffer_load_dwordx4 a[228:231], v13, s[36:39], s99 offen offset:1024 sc1
  v_mfma_f32_16x16x32_bf16 v[200:203], v[40:43], a[8:11], v[200:203]
  v_mov_b32_dpp v106, v104 row_ror:8 row_mask:0xf bank_mask:0x3
  v_mfma_f32_16x16x32_bf16 v[232:235], v[44:47], a[8:11], v[232:235]
  s_waitcnt vmcnt(52)
  v_cndmask_b32_dpp v17, v110, v108, vcc row_ror:8 row_mask:0xf bank_mask:0xf
  v_mfma_f32_16x16x32_bf16 v[204:207], v[40:43], a[12:15], v[204:207]
  v_mov_b32_dpp v110, v108 row_ror:8 row_mask:0xf bank_mask:0x3
  ds_read_b128 a[56:59], v8 offset:45056
  buffer_load_dwordx4 a[232:235], v13, s[36:39], s99 offen offset:2048 sc1
  v_mfma_f32_16x16x32_bf16 v[236:239], v[44:47], a[12:15], v[236:239]
  v_perm_b32 v32, v98, v14, s70
  v_mfma_f32_16x16x32_bf16 v[208:211], v[40:43], a[16:19], v[208:211]
  v_perm_b32 v36, v98, v14, s71
  ds_read_b128 a[60:63], v8 offset:47104
  v_mfma_f32_16x16x32_bf16 v[240:243], v[44:47], a[16:19], v[240:243]
  v_perm_b32 v33, v102, v15, s70
  buffer_load_dwordx4 a[236:239], v13, s[36:39], s99 offen offset:3072 sc1
  v_mfma_f32_16x16x32_bf16 v[212:215], v[40:43], a[20:23], v[212:215]
  v_perm_b32 v37, v102, v15, s71
  v_mfma_f32_16x16x32_bf16 v[244:247], v[44:47], a[20:23], v[244:247]
  v_perm_b32 v34, v106, v16, s70
  v_mfma_f32_16x16x32_bf16 v[216:219], v[40:43], a[24:27], v[216:219]
  v_perm_b32 v38, v106, v16, s71
  s_add_u32 s99, s99, 4096
  v_mfma_f32_16x16x32_bf16 v[248:251], v[44:47], a[24:27], v[248:251]
  v_perm_b32 v35, v110, v17, s70
  v_mfma_f32_16x16x32_bf16 v[220:223], v[40:43], a[28:31], v[220:223]
  v_perm_b32 v39, v110, v17, s71
  v_mfma_f32_16x16x32_bf16 v[252:255], v[44:47], a[28:31], v[252:255]
  v_mfma_f32_16x16x32_bf16 a[248:251], v[40:43], v[24:27], a[248:251]
  v_mfma_f32_16x16x32_bf16 a[252:255], v[44:47], v[24:27], a[252:255]
  s_waitcnt lgkmcnt(7)
  v_mfma_f32_16x16x32_bf16 v[128:131], v[32:35], a[32:35], v[128:131]
  v_cndmask_b32_dpp v14, v99, v97, vcc row_ror:8 row_mask:0xf bank_mask:0xf
  v_mov_b32_dpp v99, v97 row_ror:8 row_mask:0xf bank_mask:0x3
  s_lshl_b32 s99, s101, 4
  v_mfma_f32_16x16x32_bf16 v[160:163], v[36:39], a[32:35], v[160:163]
  v_cndmask_b32_dpp v15, v103, v101, vcc row_ror:8 row_mask:0xf bank_mask:0xf
  s_lshl_b32 s85, s97, 2
  s_waitcnt lgkmcnt(6)
  v_mfma_f32_16x16x32_bf16 v[132:135], v[32:35], a[36:39], v[132:135]
  v_mov_b32_dpp v103, v101 row_ror:8 row_mask:0xf bank_mask:0x3
  s_add_u32 s99, s99, s85
  v_mfma_f32_16x16x32_bf16 v[164:167], v[36:39], a[36:39], v[164:167]
  v_cndmask_b32_dpp v16, v107, v105, vcc row_ror:8 row_mask:0xf bank_mask:0xf
  s_waitcnt lgkmcnt(5)
  v_mfma_f32_16x16x32_bf16 v[136:139], v[32:35], a[40:43], v[136:139]
  v_mov_b32_dpp v107, v105 row_ror:8 row_mask:0xf bank_mask:0x3
  s_add_u32 s99, s99, 394
  v_mfma_f32_16x16x32_bf16 v[168:171], v[36:39], a[40:43], v[168:171]
  v_cndmask_b32_dpp v17, v111, v109, vcc row_ror:8 row_mask:0xf bank_mask:0xf
  s_lshl_b32 s99, s99, 12
  s_waitcnt lgkmcnt(4)
  v_mfma_f32_16x16x32_bf16 v[140:143], v[32:35], a[44:47], v[140:143]
  v_mov_b32_dpp v111, v109 row_ror:8 row_mask:0xf bank_mask:0x3
  v_mfma_f32_16x16x32_bf16 v[172:175], v[36:39], a[44:47], v[172:175]
  v_perm_b32 v40, v99, v14, s70
  s_add_u32 s99, s99, 16777216
  s_waitcnt lgkmcnt(3)
  v_mfma_f32_16x16x32_bf16 v[144:147], v[32:35], a[48:51], v[144:147]
  v_perm_b32 v44, v99, v14, s71
  s_lshl_b32 s85, s97, 13
  v_mfma_f32_16x16x32_bf16 v[176:179], v[36:39], a[48:51], v[176:179]
  v_perm_b32 v41, v103, v15, s70
  s_waitcnt lgkmcnt(2)
  v_mfma_f32_16x16x32_bf16 v[148:151], v[32:35], a[52:55], v[148:151]
  v_perm_b32 v45, v103, v15, s71
  s_add_u32 m0, s85, 115200
  v_mfma_f32_16x16x32_bf16 v[180:183], v[36:39], a[52:55], v[180:183]
  v_perm_b32 v42, v107, v16, s70
  s_nop 1
  s_waitcnt lgkmcnt(1)
  v_mfma_f32_16x16x32_bf16 v[152:155], v[32:35], a[56:59], v[152:155]
  v_perm_b32 v46, v107, v16, s71
  v_mfma_f32_16x16x32_bf16 v[184:187], v[36:39], a[56:59], v[184:187]
  v_perm_b32 v43, v111, v17, s70
  buffer_load_dwordx4 v13, s[36:39], s99 offen offset:0 sc1 lds
  s_waitcnt lgkmcnt(0)
  v_mfma_f32_16x16x32_bf16 v[156:159], v[32:35], a[60:63], v[156:159]
  v_perm_b32 v47, v111, v17, s71
  buffer_load_dwordx4 v13, s[36:39], s99 offen offset:1024 sc1 lds
  v_mfma_f32_16x16x32_bf16 v[188:191], v[36:39], a[60:63], v[188:191]
  v_mfma_f32_16x16x32_bf16 a[240:243], v[32:35], v[24:27], a[240:243]
  v_mfma_f32_16x16x32_bf16 a[244:247], v[36:39], v[24:27], a[244:247]
  v_mfma_f32_16x16x32_bf16 v[192:195], v[40:43], a[32:35], v[192:195]
  buffer_load_dwordx4 v13, s[36:39], s99 offen offset:2048 sc1 lds
  v_mfma_f32_16x16x32_bf16 v[224:227], v[44:47], a[32:35], v[224:227]
  buffer_load_dwordx4 v13, s[36:39], s99 offen offset:3072 sc1 lds
  v_mfma_f32_16x16x32_bf16 v[196:199], v[40:43], a[36:39], v[196:199]
  s_add_u32 s99, s99, 4096
  v_mfma_f32_16x16x32_bf16 v[228:231], v[44:47], a[36:39], v[228:231]
  v_mfma_f32_16x16x32_bf16 v[200:203], v[40:43], a[40:43], v[200:203]
  s_lshl_b32 s85, s97, 13
  v_mfma_f32_16x16x32_bf16 v[232:235], v[44:47], a[40:43], v[232:235]
  s_add_u32 m0, s85, 119296
  v_mfma_f32_16x16x32_bf16 v[204:207], v[40:43], a[44:47], v[204:207]
  v_mfma_f32_16x16x32_bf16 v[236:239], v[44:47], a[44:47], v[236:239]
  s_nop 1
  v_mfma_f32_16x16x32_bf16 v[208:211], v[40:43], a[48:51], v[208:211]
  buffer_load_dwordx4 v13, s[36:39], s99 offen offset:0 sc1 lds
  v_mfma_f32_16x16x32_bf16 v[240:243], v[44:47], a[48:51], v[240:243]
  v_mfma_f32_16x16x32_bf16 v[212:215], v[40:43], a[52:55], v[212:215]
  buffer_load_dwordx4 v13, s[36:39], s99 offen offset:1024 sc1 lds
  v_mfma_f32_16x16x32_bf16 v[244:247], v[44:47], a[52:55], v[244:247]
  buffer_load_dwordx4 v13, s[36:39], s99 offen offset:2048 sc1 lds
  v_mfma_f32_16x16x32_bf16 v[216:219], v[40:43], a[56:59], v[216:219]
  v_mfma_f32_16x16x32_bf16 v[248:251], v[44:47], a[56:59], v[248:251]
  buffer_load_dwordx4 v13, s[36:39], s99 offen offset:3072 sc1 lds
  v_mfma_f32_16x16x32_bf16 v[220:223], v[40:43], a[60:63], v[220:223]
  s_add_u32 s99, s99, 4096
  v_mfma_f32_16x16x32_bf16 v[252:255], v[44:47], a[60:63], v[252:255]
  v_mfma_f32_16x16x32_bf16 a[248:251], v[40:43], v[24:27], a[248:251]
  v_mfma_f32_16x16x32_bf16 a[252:255], v[44:47], v[24:27], a[252:255]
  s_waitcnt vmcnt(23)
  v_lshlrev_b32 v64, 16, v48
  v_and_b32 v68, 0xffff0000, v48
  v_lshlrev_b32 v72, 16, v49
  v_and_b32 v76, 0xffff0000, v49
  s_waitcnt vmcnt(22)
  v_lshlrev_b32 v65, 16, v50
  v_and_b32 v69, 0xffff0000, v50
  v_lshlrev_b32 v73, 16, v51
  v_and_b32 v77, 0xffff0000, v51
  s_waitcnt vmcnt(21)
  v_lshlrev_b32 v66, 16, v52
  v_and_b32 v70, 0xffff0000, v52
  v_lshlrev_b32 v74, 16, v53
  v_and_b32 v78, 0xffff0000, v53
  s_waitcnt vmcnt(20)
  v_lshlrev_b32 v67, 16, v54
  v_and_b32 v71, 0xffff0000, v54
  v_lshlrev_b32 v75, 16, v55
  v_and_b32 v79, 0xffff0000, v55
  v_accvgpr_read_b32 v48, a240
  v_accvgpr_read_b32 v49, a241
  v_accvgpr_read_b32 v50, a242
  v_accvgpr_read_b32 v51, a243
  v_accvgpr_read_b32 v52, a244
  v_accvgpr_read_b32 v53, a245
  v_accvgpr_read_b32 v54, a246
  v_accvgpr_read_b32 v55, a247
  v_accvgpr_read_b32 v56, a248
  v_accvgpr_read_b32 v57, a249
  v_accvgpr_read_b32 v58, a250
  v_accvgpr_read_b32 v59, a251
  v_accvgpr_read_b32 v60, a252
  v_accvgpr_read_b32 v61, a253
  v_accvgpr_read_b32 v62, a254
  v_accvgpr_read_b32 v63, a255
  s_mul_i32 s99, s101, 56
  s_mul_i32 s85, s97, 14
  s_add_u32 s99, s99, s85
  s_add_u32 s99, s99, 11
  s_lshl_b32 s99, s99, 12
  s_add_u32 s99, s99, 16777216
  buffer_load_dwordx4 a[240:243], v13, s[36:39], s99 offen offset:0 sc1
  buffer_load_dwordx4 a[244:247], v13, s[36:39], s99 offen offset:1024 sc1
  buffer_load_dwordx4 a[248:251], v13, s[36:39], s99 offen offset:2048 sc1
  buffer_load_dwordx4 a[252:255], v13, s[36:39], s99 offen offset:3072 sc1
  s_add_u32 s99, s99, 4096
  buffer_load_dwordx4 a[0:3], v13, s[36:39], s99 offen offset:0 sc1
  buffer_load_dwordx4 a[4:7], v13, s[36:39], s99 offen offset:1024 sc1
  buffer_load_dwordx4 a[8:11], v13, s[36:39], s99 offen offset:2048 sc1
  buffer_load_dwordx4 a[12:15], v13, s[36:39], s99 offen offset:3072 sc1
  s_add_u32 s99, s99, 4096
  buffer_load_dwordx4 a[16:19], v13, s[36:39], s99 offen offset:0 sc1
  buffer_load_dwordx4 a[20:23], v13, s[36:39], s99 offen offset:1024 sc1
  buffer_load_dwordx4 a[24:27], v13, s[36:39], s99 offen offset:2048 sc1
  buffer_load_dwordx4 a[28:31], v13, s[36:39], s99 offen offset:3072 sc1
  s_add_u32 s99, s99, 4096
  s_lshl_b32 s99, s101, 4
  s_lshl_b32 s85, s97, 2
  s_add_u32 s99, s99, s85
  s_add_u32 s99, s99, 392
  s_lshl_b32 s99, s99, 12
  s_add_u32 s99, s99, 16777216
  buffer_load_dwordx4 a[32:35], v13, s[36:39], s99 offen offset:0 sc1
  buffer_load_dwordx4 a[36:39], v13, s[36:39], s99 offen offset:1024 sc1
  buffer_load_dwordx4 a[40:43], v13, s[36:39], s99 offen offset:2048 sc1
  buffer_load_dwordx4 a[44:47], v13, s[36:39], s99 offen offset:3072 sc1
  s_add_u32 s99, s99, 4096
  buffer_load_dwordx4 a[48:51], v13, s[36:39], s99 offen offset:0 sc1
  buffer_load_dwordx4 a[52:55], v13, s[36:39], s99 offen offset:1024 sc1
  buffer_load_dwordx4 a[56:59], v13, s[36:39], s99 offen offset:2048 sc1
  buffer_load_dwordx4 a[60:63], v13, s[36:39], s99 offen offset:3072 sc1
  s_add_u32 s99, s99, 4096
  s_cmp_eq_u32 s96, 0
  s_cbranch_scc1 k1_q
  v_lshlrev_b32 v9, 4, v0
  s_mul_i32 s80, s94, 458752
  s_lshl_b32 s81, s95, 11
  s_add_u32 s80, s80, s81
  v_pk_fma_f32 v[14:15], v[48:49], v[120:121], v[64:65] op_sel:[0,0,0] op_sel_hi:[1,0,1]
  v_pk_fma_f32 v[16:17], v[50:51], v[120:121], v[66:67] op_sel:[0,0,0] op_sel_hi:[1,0,1]
  v_pk_fma_f32 v[18:19], v[52:53], v[120:121], v[68:69] op_sel:[0,0,0] op_sel_hi:[1,0,1]
  v_pk_fma_f32 v[20:21], v[54:55], v[120:121], v[70:71] op_sel:[0,0,0] op_sel_hi:[1,0,1]
  v_pk_fma_f32 v[128:129], v[128:129], v[112:113], v[14:15] op_sel:[0,0,0] op_sel_hi:[1,0,1]
  v_pk_fma_f32 v[130:131], v[130:131], v[112:113], v[16:17] op_sel:[0,0,0] op_sel_hi:[1,0,1]
  v_pk_fma_f32 v[160:161], v[160:161], v[112:113], v[18:19] op_sel:[0,0,0] op_sel_hi:[1,0,1]
  v_pk_fma_f32 v[162:163], v[162:163], v[112:113], v[20:21] op_sel:[0,0,0] op_sel_hi:[1,0,1]
  v_max_f32 v128, 0, v128
  v_max_f32 v130, 0, v130
  v_max_f32 v160, 0, v160
  v_max_f32 v162, 0, v162
  v_max_f32 v129, 0, v129
  v_max_f32 v131, 0, v131
  v_max_f32 v161, 0, v161
  v_max_f32 v163, 0, v163
  v_pk_mul_f32 v[128:129], v[128:129], v[128:129] op_sel:[0,0] op_sel_hi:[1,1]
  v_pk_mul_f32 v[130:131], v[130:131], v[130:131] op_sel:[0,0] op_sel_hi:[1,1]
  v_pk_mul_f32 v[160:161], v[160:161], v[160:161] op_sel:[0,0] op_sel_hi:[1,1]
  v_pk_mul_f32 v[162:163], v[162:163], v[162:163] op_sel:[0,0] op_sel_hi:[1,1]
  v_pk_fma_f32 v[14:15], v[56:57], v[120:121], v[72:73] op_sel:[0,0,0] op_sel_hi:[1,0,1]
  v_pk_fma_f32 v[16:17], v[58:59], v[120:121], v[74:75] op_sel:[0,0,0] op_sel_hi:[1,0,1]
  v_pk_fma_f32 v[18:19], v[60:61], v[120:121], v[76:77] op_sel:[0,0,0] op_sel_hi:[1,0,1]
  v_pk_fma_f32 v[20:21], v[62:63], v[120:121], v[78:79] op_sel:[0,0,0] op_sel_hi:[1,0,1]
  v_pk_fma_f32 v[192:193], v[192:193], v[112:113], v[14:15] op_sel:[0,0,0] op_sel_hi:[1,0,1]
  v_pk_fma_f32 v[194:195], v[194:195], v[112:113], v[16:17] op_sel:[0,0,0] op_sel_hi:[1,0,1]
  v_pk_fma_f32 v[224:225], v[224:225], v[112:113], v[18:19] op_sel:[0,0,0] op_sel_hi:[1,0,1]
  v_pk_fma_f32 v[226:227], v[226:227], v[112:113], v[20:21] op_sel:[0,0,0] op_sel_hi:[1,0,1]
  v_max_f32 v192, 0, v192
  v_max_f32 v194, 0, v194
  v_max_f32 v224, 0, v224
  v_max_f32 v226, 0, v226
  v_max_f32 v193, 0, v193
  v_max_f32 v195, 0, v195
  v_max_f32 v225, 0, v225
  v_max_f32 v227, 0, v227
  v_pk_mul_f32 v[192:193], v[192:193], v[192:193] op_sel:[0,0] op_sel_hi:[1,1]
  v_pk_mul_f32 v[194:195], v[194:195], v[194:195] op_sel:[0,0] op_sel_hi:[1,1]
  v_pk_mul_f32 v[224:225], v[224:225], v[224:225] op_sel:[0,0] op_sel_hi:[1,1]
  v_pk_mul_f32 v[226:227], v[226:227], v[226:227] op_sel:[0,0] op_sel_hi:[1,1]
  v_cvt_pk_bf16_f32 v80, v128, v160
  v_cvt_pk_bf16_f32 v81, v192, v224
  v_cvt_pk_bf16_f32 v82, v129, v161
  v_cvt_pk_bf16_f32 v83, v193, v225
  buffer_store_dwordx4 v[80:83], v9, s[36:39], s80 offen offset:0 sc1
  v_cvt_pk_bf16_f32 v84, v130, v162
  v_cvt_pk_bf16_f32 v85, v194, v226
  v_cvt_pk_bf16_f32 v86, v131, v163
  v_cvt_pk_bf16_f32 v87, v195, v227
  buffer_store_dwordx4 v[84:87], v9, s[36:39], s80 offen offset:1024 sc1
  s_add_u32 s80, s80, 57344
  v_pk_fma_f32 v[14:15], v[48:49], v[120:121], v[64:65] op_sel:[0,1,0] op_sel_hi:[1,1,1]
  v_pk_fma_f32 v[16:17], v[50:51], v[120:121], v[66:67] op_sel:[0,1,0] op_sel_hi:[1,1,1]
  v_pk_fma_f32 v[18:19], v[52:53], v[120:121], v[68:69] op_sel:[0,1,0] op_sel_hi:[1,1,1]
  v_pk_fma_f32 v[20:21], v[54:55], v[120:121], v[70:71] op_sel:[0,1,0] op_sel_hi:[1,1,1]
  v_pk_fma_f32 v[132:133], v[132:133], v[112:113], v[14:15] op_sel:[0,1,0] op_sel_hi:[1,1,1]
  v_pk_fma_f32 v[134:135], v[134:135], v[112:113], v[16:17] op_sel:[0,1,0] op_sel_hi:[1,1,1]
  v_pk_fma_f32 v[164:165], v[164:165], v[112:113], v[18:19] op_sel:[0,1,0] op_sel_hi:[1,1,1]
  v_pk_fma_f32 v[166:167], v[166:167], v[112:113], v[20:21] op_sel:[0,1,0] op_sel_hi:[1,1,1]
  v_max_f32 v132, 0, v132
  v_max_f32 v134, 0, v134
  v_max_f32 v164, 0, v164
  v_max_f32 v166, 0, v166
  v_max_f32 v133, 0, v133
  v_max_f32 v135, 0, v135
  v_max_f32 v165, 0, v165
  v_max_f32 v167, 0, v167
  v_pk_mul_f32 v[132:133], v[132:133], v[132:133] op_sel:[0,0] op_sel_hi:[1,1]
  v_pk_mul_f32 v[134:135], v[134:135], v[134:135] op_sel:[0,0] op_sel_hi:[1,1]
  v_pk_mul_f32 v[164:165], v[164:165], v[164:165] op_sel:[0,0] op_sel_hi:[1,1]
  v_pk_mul_f32 v[166:167], v[166:167], v[166:167] op_sel:[0,0] op_sel_hi:[1,1]
  v_pk_fma_f32 v[14:15], v[56:57], v[120:121], v[72:73] op_sel:[0,1,0] op_sel_hi:[1,1,1]
  v_pk_fma_f32 v[16:17], v[58:59], v[120:121], v[74:75] op_sel:[0,1,0] op_sel_hi:[1,1,1]
  v_pk_fma_f32 v[18:19], v[60:61], v[120:121], v[76:77] op_sel:[0,1,0] op_sel_hi:[1,1,1]
  v_pk_fma_f32 v[20:21], v[62:63], v[120:121], v[78:79] op_sel:[0,1,0] op_sel_hi:[1,1,1]
  v_pk_fma_f32 v[196:197], v[196:197], v[112:113], v[14:15] op_sel:[0,1,0] op_sel_hi:[1,1,1]
  v_pk_fma_f32 v[198:199], v[198:199], v[112:113], v[16:17] op_sel:[0,1,0] op_sel_hi:[1,1,1]
  v_pk_fma_f32 v[228:229], v[228:229], v[112:113], v[18:19] op_sel:[0,1,0] op_sel_hi:[1,1,1]
  v_pk_fma_f32 v[230:231], v[230:231], v[112:113], v[20:21] op_sel:[0,1,0] op_sel_hi:[1,1,1]
  v_max_f32 v196, 0, v196
  v_max_f32 v198, 0, v198
  v_max_f32 v228, 0, v228
  v_max_f32 v230, 0, v230
  v_max_f32 v197, 0, v197
  v_max_f32 v199, 0, v199
  v_max_f32 v229, 0, v229
  v_max_f32 v231, 0, v231
  v_pk_mul_f32 v[196:197], v[196:197], v[196:197] op_sel:[0,0] op_sel_hi:[1,1]
  v_pk_mul_f32 v[198:199], v[198:199], v[198:199] op_sel:[0,0] op_sel_hi:[1,1]
  v_pk_mul_f32 v[228:229], v[228:229], v[228:229] op_sel:[0,0] op_sel_hi:[1,1]
  v_pk_mul_f32 v[230:231], v[230:231], v[230:231] op_sel:[0,0] op_sel_hi:[1,1]
  v_cvt_pk_bf16_f32 v88, v132, v164
  v_cvt_pk_bf16_f32 v89, v196, v228
  v_cvt_pk_bf16_f32 v90, v133, v165
  v_cvt_pk_bf16_f32 v91, v197, v229
  buffer_store_dwordx4 v[88:91], v9, s[36:39], s80 offen offset:0 sc1
  v_cvt_pk_bf16_f32 v92, v134, v166
  v_cvt_pk_bf16_f32 v93, v198, v230
  v_cvt_pk_bf16_f32 v94, v135, v167
  v_cvt_pk_bf16_f32 v95, v199, v231
  buffer_store_dwordx4 v[92:95], v9, s[36:39], s80 offen offset:1024 sc1
  s_add_u32 s80, s80, 57344
  v_pk_fma_f32 v[14:15], v[48:49], v[122:123], v[64:65] op_sel:[0,0,0] op_sel_hi:[1,0,1]
  v_pk_fma_f32 v[16:17], v[50:51], v[122:123], v[66:67] op_sel:[0,0,0] op_sel_hi:[1,0,1]
  v_pk_fma_f32 v[18:19], v[52:53], v[122:123], v[68:69] op_sel:[0,0,0] op_sel_hi:[1,0,1]
  v_pk_fma_f32 v[20:21], v[54:55], v[122:123], v[70:71] op_sel:[0,0,0] op_sel_hi:[1,0,1]
  v_pk_fma_f32 v[136:137], v[136:137], v[114:115], v[14:15] op_sel:[0,0,0] op_sel_hi:[1,0,1]
  v_pk_fma_f32 v[138:139], v[138:139], v[114:115], v[16:17] op_sel:[0,0,0] op_sel_hi:[1,0,1]
  v_pk_fma_f32 v[168:169], v[168:169], v[114:115], v[18:19] op_sel:[0,0,0] op_sel_hi:[1,0,1]
  v_pk_fma_f32 v[170:171], v[170:171], v[114:115], v[20:21] op_sel:[0,0,0] op_sel_hi:[1,0,1]
  v_max_f32 v136, 0, v136
  v_max_f32 v138, 0, v138
  v_max_f32 v168, 0, v168
  v_max_f32 v170, 0, v170
  v_max_f32 v137, 0, v137
  v_max_f32 v139, 0, v139
  v_max_f32 v169, 0, v169
  v_max_f32 v171, 0, v171
  v_pk_mul_f32 v[136:137], v[136:137], v[136:137] op_sel:[0,0] op_sel_hi:[1,1]
  v_pk_mul_f32 v[138:139], v[138:139], v[138:139] op_sel:[0,0] op_sel_hi:[1,1]
  v_pk_mul_f32 v[168:169], v[168:169], v[168:169] op_sel:[0,0] op_sel_hi:[1,1]
  v_pk_mul_f32 v[170:171], v[170:171], v[170:171] op_sel:[0,0] op_sel_hi:[1,1]
  v_pk_fma_f32 v[14:15], v[56:57], v[122:123], v[72:73] op_sel:[0,0,0] op_sel_hi:[1,0,1]
  v_pk_fma_f32 v[16:17], v[58:59], v[122:123], v[74:75] op_sel:[0,0,0] op_sel_hi:[1,0,1]
  v_pk_fma_f32 v[18:19], v[60:61], v[122:123], v[76:77] op_sel:[0,0,0] op_sel_hi:[1,0,1]
  v_pk_fma_f32 v[20:21], v[62:63], v[122:123], v[78:79] op_sel:[0,0,0] op_sel_hi:[1,0,1]
  v_pk_fma_f32 v[200:201], v[200:201], v[114:115], v[14:15] op_sel:[0,0,0] op_sel_hi:[1,0,1]
  v_pk_fma_f32 v[202:203], v[202:203], v[114:115], v[16:17] op_sel:[0,0,0] op_sel_hi:[1,0,1]
  v_pk_fma_f32 v[232:233], v[232:233], v[114:115], v[18:19] op_sel:[0,0,0] op_sel_hi:[1,0,1]
  v_pk_fma_f32 v[234:235], v[234:235], v[114:115], v[20:21] op_sel:[0,0,0] op_sel_hi:[1,0,1]
  v_max_f32 v200, 0, v200
  v_max_f32 v202, 0, v202
  v_max_f32 v232, 0, v232
  v_max_f32 v234, 0, v234
  v_max_f32 v201, 0, v201
  v_max_f32 v203, 0, v203
  v_max_f32 v233, 0, v233
  v_max_f32 v235, 0, v235
  v_pk_mul_f32 v[200:201], v[200:201], v[200:201] op_sel:[0,0] op_sel_hi:[1,1]
  v_pk_mul_f32 v[202:203], v[202:203], v[202:203] op_sel:[0,0] op_sel_hi:[1,1]
  v_pk_mul_f32 v[232:233], v[232:233], v[232:233] op_sel:[0,0] op_sel_hi:[1,1]
  v_pk_mul_f32 v[234:235], v[234:235], v[234:235] op_sel:[0,0] op_sel_hi:[1,1]
  v_cvt_pk_bf16_f32 v96, v136, v168
  v_cvt_pk_bf16_f32 v97, v200, v232
  v_cvt_pk_bf16_f32 v98, v137, v169
  v_cvt_pk_bf16_f32 v99, v201, v233
  buffer_store_dwordx4 v[96:99], v9, s[36:39], s80 offen offset:0 sc1
  v_cvt_pk_bf16_f32 v100, v138, v170
  v_cvt_pk_bf16_f32 v101, v202, v234
  v_cvt_pk_bf16_f32 v102, v139, v171
  v_cvt_pk_bf16_f32 v103, v203, v235
  buffer_store_dwordx4 v[100:103], v9, s[36:39], s80 offen offset:1024 sc1
  s_add_u32 s80, s80, 57344
  v_pk_fma_f32 v[14:15], v[48:49], v[122:123], v[64:65] op_sel:[0,1,0] op_sel_hi:[1,1,1]
  v_pk_fma_f32 v[16:17], v[50:51], v[122:123], v[66:67] op_sel:[0,1,0] op_sel_hi:[1,1,1]
  v_pk_fma_f32 v[18:19], v[52:53], v[122:123], v[68:69] op_sel:[0,1,0] op_sel_hi:[1,1,1]
  v_pk_fma_f32 v[20:21], v[54:55], v[122:123], v[70:71] op_sel:[0,1,0] op_sel_hi:[1,1,1]
  v_pk_fma_f32 v[140:141], v[140:141], v[114:115], v[14:15] op_sel:[0,1,0] op_sel_hi:[1,1,1]
  v_pk_fma_f32 v[142:143], v[142:143], v[114:115], v[16:17] op_sel:[0,1,0] op_sel_hi:[1,1,1]
  v_pk_fma_f32 v[172:173], v[172:173], v[114:115], v[18:19] op_sel:[0,1,0] op_sel_hi:[1,1,1]
  v_pk_fma_f32 v[174:175], v[174:175], v[114:115], v[20:21] op_sel:[0,1,0] op_sel_hi:[1,1,1]
  v_max_f32 v140, 0, v140
  v_max_f32 v142, 0, v142
  v_max_f32 v172, 0, v172
  v_max_f32 v174, 0, v174
  v_max_f32 v141, 0, v141
  v_max_f32 v143, 0, v143
  v_max_f32 v173, 0, v173
  v_max_f32 v175, 0, v175
  v_pk_mul_f32 v[140:141], v[140:141], v[140:141] op_sel:[0,0] op_sel_hi:[1,1]
  v_pk_mul_f32 v[142:143], v[142:143], v[142:143] op_sel:[0,0] op_sel_hi:[1,1]
  v_pk_mul_f32 v[172:173], v[172:173], v[172:173] op_sel:[0,0] op_sel_hi:[1,1]
  v_pk_mul_f32 v[174:175], v[174:175], v[174:175] op_sel:[0,0] op_sel_hi:[1,1]
  v_pk_fma_f32 v[14:15], v[56:57], v[122:123], v[72:73] op_sel:[0,1,0] op_sel_hi:[1,1,1]
  v_pk_fma_f32 v[16:17], v[58:59], v[122:123], v[74:75] op_sel:[0,1,0] op_sel_hi:[1,1,1]
  v_pk_fma_f32 v[18:19], v[60:61], v[122:123], v[76:77] op_sel:[0,1,0] op_sel_hi:[1,1,1]
  v_pk_fma_f32 v[20:21], v[62:63], v[122:123], v[78:79] op_sel:[0,1,0] op_sel_hi:[1,1,1]
  v_pk_fma_f32 v[204:205], v[204:205], v[114:115], v[14:15] op_sel:[0,1,0] op_sel_hi:[1,1,1]
  v_pk_fma_f32 v[206:207], v[206:207], v[114:115], v[16:17] op_sel:[0,1,0] op_sel_hi:[1,1,1]
  v_pk_fma_f32 v[236:237], v[236:237], v[114:115], v[18:19] op_sel:[0,1,0] op_sel_hi:[1,1,1]
  v_pk_fma_f32 v[238:239], v[238:239], v[114:115], v[20:21] op_sel:[0,1,0] op_sel_hi:[1,1,1]
  v_max_f32 v204, 0, v204
  v_max_f32 v206, 0, v206
  v_max_f32 v236, 0, v236
  v_max_f32 v238, 0, v238
  v_max_f32 v205, 0, v205
  v_max_f32 v207, 0, v207
  v_max_f32 v237, 0, v237
  v_max_f32 v239, 0, v239
  v_pk_mul_f32 v[204:205], v[204:205], v[204:205] op_sel:[0,0] op_sel_hi:[1,1]
  v_pk_mul_f32 v[206:207], v[206:207], v[206:207] op_sel:[0,0] op_sel_hi:[1,1]
  v_pk_mul_f32 v[236:237], v[236:237], v[236:237] op_sel:[0,0] op_sel_hi:[1,1]
  v_pk_mul_f32 v[238:239], v[238:239], v[238:239] op_sel:[0,0] op_sel_hi:[1,1]
  v_cvt_pk_bf16_f32 v104, v140, v172
  v_cvt_pk_bf16_f32 v105, v204, v236
  v_cvt_pk_bf16_f32 v106, v141, v173
  v_cvt_pk_bf16_f32 v107, v205, v237
  buffer_store_dwordx4 v[104:107], v9, s[36:39], s80 offen offset:0 sc1
  v_cvt_pk_bf16_f32 v108, v142, v174
  v_cvt_pk_bf16_f32 v109, v206, v238
  v_cvt_pk_bf16_f32 v110, v143, v175
  v_cvt_pk_bf16_f32 v111, v207, v239
  buffer_store_dwordx4 v[108:111], v9, s[36:39], s80 offen offset:1024 sc1
  s_add_u32 s80, s80, 57344
  v_pk_fma_f32 v[14:15], v[48:49], v[124:125], v[64:65] op_sel:[0,0,0] op_sel_hi:[1,0,1]
  v_pk_fma_f32 v[16:17], v[50:51], v[124:125], v[66:67] op_sel:[0,0,0] op_sel_hi:[1,0,1]
  v_pk_fma_f32 v[18:19], v[52:53], v[124:125], v[68:69] op_sel:[0,0,0] op_sel_hi:[1,0,1]
  v_pk_fma_f32 v[20:21], v[54:55], v[124:125], v[70:71] op_sel:[0,0,0] op_sel_hi:[1,0,1]
  v_pk_fma_f32 v[144:145], v[144:145], v[116:117], v[14:15] op_sel:[0,0,0] op_sel_hi:[1,0,1]
  v_pk_fma_f32 v[146:147], v[146:147], v[116:117], v[16:17] op_sel:[0,0,0] op_sel_hi:[1,0,1]
  v_pk_fma_f32 v[176:177], v[176:177], v[116:117], v[18:19] op_sel:[0,0,0] op_sel_hi:[1,0,1]
  v_pk_fma_f32 v[178:179], v[178:179], v[116:117], v[20:21] op_sel:[0,0,0] op_sel_hi:[1,0,1]
  v_max_f32 v144, 0, v144
  v_max_f32 v146, 0, v146
  v_max_f32 v176, 0, v176
  v_max_f32 v178, 0, v178
  v_max_f32 v145, 0, v145
  v_max_f32 v147, 0, v147
  v_max_f32 v177, 0, v177
  v_max_f32 v179, 0, v179
  v_pk_mul_f32 v[144:145], v[144:145], v[144:145] op_sel:[0,0] op_sel_hi:[1,1]
  v_pk_mul_f32 v[146:147], v[146:147], v[146:147] op_sel:[0,0] op_sel_hi:[1,1]
  v_pk_mul_f32 v[176:177], v[176:177], v[176:177] op_sel:[0,0] op_sel_hi:[1,1]
  v_pk_mul_f32 v[178:179], v[178:179], v[178:179] op_sel:[0,0] op_sel_hi:[1,1]
  v_pk_fma_f32 v[14:15], v[56:57], v[124:125], v[72:73] op_sel:[0,0,0] op_sel_hi:[1,0,1]
  v_pk_fma_f32 v[16:17], v[58:59], v[124:125], v[74:75] op_sel:[0,0,0] op_sel_hi:[1,0,1]
  v_pk_fma_f32 v[18:19], v[60:61], v[124:125], v[76:77] op_sel:[0,0,0] op_sel_hi:[1,0,1]
  v_pk_fma_f32 v[20:21], v[62:63], v[124:125], v[78:79] op_sel:[0,0,0] op_sel_hi:[1,0,1]
  v_pk_fma_f32 v[208:209], v[208:209], v[116:117], v[14:15] op_sel:[0,0,0] op_sel_hi:[1,0,1]
  v_pk_fma_f32 v[210:211], v[210:211], v[116:117], v[16:17] op_sel:[0,0,0] op_sel_hi:[1,0,1]
  v_pk_fma_f32 v[240:241], v[240:241], v[116:117], v[18:19] op_sel:[0,0,0] op_sel_hi:[1,0,1]
  v_pk_fma_f32 v[242:243], v[242:243], v[116:117], v[20:21] op_sel:[0,0,0] op_sel_hi:[1,0,1]
  v_max_f32 v208, 0, v208
  v_max_f32 v210, 0, v210
  v_max_f32 v240, 0, v240
  v_max_f32 v242, 0, v242
  v_max_f32 v209, 0, v209
  v_max_f32 v211, 0, v211
  v_max_f32 v241, 0, v241
  v_max_f32 v243, 0, v243
  v_pk_mul_f32 v[208:209], v[208:209], v[208:209] op_sel:[0,0] op_sel_hi:[1,1]
  v_pk_mul_f32 v[210:211], v[210:211], v[210:211] op_sel:[0,0] op_sel_hi:[1,1]
  v_pk_mul_f32 v[240:241], v[240:241], v[240:241] op_sel:[0,0] op_sel_hi:[1,1]
  v_pk_mul_f32 v[242:243], v[242:243], v[242:243] op_sel:[0,0] op_sel_hi:[1,1]
  v_cvt_pk_bf16_f32 v80, v144, v176
  v_cvt_pk_bf16_f32 v81, v208, v240
  v_cvt_pk_bf16_f32 v82, v145, v177
  v_cvt_pk_bf16_f32 v83, v209, v241
  buffer_store_dwordx4 v[80:83], v9, s[36:39], s80 offen offset:0 sc1
  v_cvt_pk_bf16_f32 v84, v146, v178
  v_cvt_pk_bf16_f32 v85, v210, v242
  v_cvt_pk_bf16_f32 v86, v147, v179
  v_cvt_pk_bf16_f32 v87, v211, v243
  buffer_store_dwordx4 v[84:87], v9, s[36:39], s80 offen offset:1024 sc1
  s_add_u32 s80, s80, 57344
  v_pk_fma_f32 v[14:15], v[48:49], v[124:125], v[64:65] op_sel:[0,1,0] op_sel_hi:[1,1,1]
  v_pk_fma_f32 v[16:17], v[50:51], v[124:125], v[66:67] op_sel:[0,1,0] op_sel_hi:[1,1,1]
  v_pk_fma_f32 v[18:19], v[52:53], v[124:125], v[68:69] op_sel:[0,1,0] op_sel_hi:[1,1,1]
  v_pk_fma_f32 v[20:21], v[54:55], v[124:125], v[70:71] op_sel:[0,1,0] op_sel_hi:[1,1,1]
  v_pk_fma_f32 v[148:149], v[148:149], v[116:117], v[14:15] op_sel:[0,1,0] op_sel_hi:[1,1,1]
  v_pk_fma_f32 v[150:151], v[150:151], v[116:117], v[16:17] op_sel:[0,1,0] op_sel_hi:[1,1,1]
  v_pk_fma_f32 v[180:181], v[180:181], v[116:117], v[18:19] op_sel:[0,1,0] op_sel_hi:[1,1,1]
  v_pk_fma_f32 v[182:183], v[182:183], v[116:117], v[20:21] op_sel:[0,1,0] op_sel_hi:[1,1,1]
  v_max_f32 v148, 0, v148
  v_max_f32 v150, 0, v150
  v_max_f32 v180, 0, v180
  v_max_f32 v182, 0, v182
  v_max_f32 v149, 0, v149
  v_max_f32 v151, 0, v151
  v_max_f32 v181, 0, v181
  v_max_f32 v183, 0, v183
  v_pk_mul_f32 v[148:149], v[148:149], v[148:149] op_sel:[0,0] op_sel_hi:[1,1]
  v_pk_mul_f32 v[150:151], v[150:151], v[150:151] op_sel:[0,0] op_sel_hi:[1,1]
  v_pk_mul_f32 v[180:181], v[180:181], v[180:181] op_sel:[0,0] op_sel_hi:[1,1]
  v_pk_mul_f32 v[182:183], v[182:183], v[182:183] op_sel:[0,0] op_sel_hi:[1,1]
  v_pk_fma_f32 v[14:15], v[56:57], v[124:125], v[72:73] op_sel:[0,1,0] op_sel_hi:[1,1,1]
  v_pk_fma_f32 v[16:17], v[58:59], v[124:125], v[74:75] op_sel:[0,1,0] op_sel_hi:[1,1,1]
  v_pk_fma_f32 v[18:19], v[60:61], v[124:125], v[76:77] op_sel:[0,1,0] op_sel_hi:[1,1,1]
  v_pk_fma_f32 v[20:21], v[62:63], v[124:125], v[78:79] op_sel:[0,1,0] op_sel_hi:[1,1,1]
  v_pk_fma_f32 v[212:213], v[212:213], v[116:117], v[14:15] op_sel:[0,1,0] op_sel_hi:[1,1,1]
  v_pk_fma_f32 v[214:215], v[214:215], v[116:117], v[16:17] op_sel:[0,1,0] op_sel_hi:[1,1,1]
  v_pk_fma_f32 v[244:245], v[244:245], v[116:117], v[18:19] op_sel:[0,1,0] op_sel_hi:[1,1,1]
  v_pk_fma_f32 v[246:247], v[246:247], v[116:117], v[20:21] op_sel:[0,1,0] op_sel_hi:[1,1,1]
  v_max_f32 v212, 0, v212
  v_max_f32 v214, 0, v214
  v_max_f32 v244, 0, v244
  v_max_f32 v246, 0, v246
  v_max_f32 v213, 0, v213
  v_max_f32 v215, 0, v215
  v_max_f32 v245, 0, v245
  v_max_f32 v247, 0, v247
  v_pk_mul_f32 v[212:213], v[212:213], v[212:213] op_sel:[0,0] op_sel_hi:[1,1]
  v_pk_mul_f32 v[214:215], v[214:215], v[214:215] op_sel:[0,0] op_sel_hi:[1,1]
  v_pk_mul_f32 v[244:245], v[244:245], v[244:245] op_sel:[0,0] op_sel_hi:[1,1]
  v_pk_mul_f32 v[246:247], v[246:247], v[246:247] op_sel:[0,0] op_sel_hi:[1,1]
  v_cvt_pk_bf16_f32 v88, v148, v180
  v_cvt_pk_bf16_f32 v89, v212, v244
  v_cvt_pk_bf16_f32 v90, v149, v181
  v_cvt_pk_bf16_f32 v91, v213, v245
  buffer_store_dwordx4 v[88:91], v9, s[36:39], s80 offen offset:0 sc1
  v_cvt_pk_bf16_f32 v92, v150, v182
  v_cvt_pk_bf16_f32 v93, v214, v246
  v_cvt_pk_bf16_f32 v94, v151, v183
  v_cvt_pk_bf16_f32 v95, v215, v247
  buffer_store_dwordx4 v[92:95], v9, s[36:39], s80 offen offset:1024 sc1
  s_add_u32 s80, s80, 57344
  v_pk_fma_f32 v[14:15], v[48:49], v[126:127], v[64:65] op_sel:[0,0,0] op_sel_hi:[1,0,1]
  v_pk_fma_f32 v[16:17], v[50:51], v[126:127], v[66:67] op_sel:[0,0,0] op_sel_hi:[1,0,1]
  v_pk_fma_f32 v[18:19], v[52:53], v[126:127], v[68:69] op_sel:[0,0,0] op_sel_hi:[1,0,1]
  v_pk_fma_f32 v[20:21], v[54:55], v[126:127], v[70:71] op_sel:[0,0,0] op_sel_hi:[1,0,1]
  v_pk_fma_f32 v[152:153], v[152:153], v[118:119], v[14:15] op_sel:[0,0,0] op_sel_hi:[1,0,1]
  v_pk_fma_f32 v[154:155], v[154:155], v[118:119], v[16:17] op_sel:[0,0,0] op_sel_hi:[1,0,1]
  v_pk_fma_f32 v[184:185], v[184:185], v[118:119], v[18:19] op_sel:[0,0,0] op_sel_hi:[1,0,1]
  v_pk_fma_f32 v[186:187], v[186:187], v[118:119], v[20:21] op_sel:[0,0,0] op_sel_hi:[1,0,1]
  v_max_f32 v152, 0, v152
  v_max_f32 v154, 0, v154
  v_max_f32 v184, 0, v184
  v_max_f32 v186, 0, v186
  v_max_f32 v153, 0, v153
  v_max_f32 v155, 0, v155
  v_max_f32 v185, 0, v185
  v_max_f32 v187, 0, v187
  v_pk_mul_f32 v[152:153], v[152:153], v[152:153] op_sel:[0,0] op_sel_hi:[1,1]
  v_pk_mul_f32 v[154:155], v[154:155], v[154:155] op_sel:[0,0] op_sel_hi:[1,1]
  v_pk_mul_f32 v[184:185], v[184:185], v[184:185] op_sel:[0,0] op_sel_hi:[1,1]
  v_pk_mul_f32 v[186:187], v[186:187], v[186:187] op_sel:[0,0] op_sel_hi:[1,1]
  v_pk_fma_f32 v[14:15], v[56:57], v[126:127], v[72:73] op_sel:[0,0,0] op_sel_hi:[1,0,1]
  v_pk_fma_f32 v[16:17], v[58:59], v[126:127], v[74:75] op_sel:[0,0,0] op_sel_hi:[1,0,1]
  v_pk_fma_f32 v[18:19], v[60:61], v[126:127], v[76:77] op_sel:[0,0,0] op_sel_hi:[1,0,1]
  v_pk_fma_f32 v[20:21], v[62:63], v[126:127], v[78:79] op_sel:[0,0,0] op_sel_hi:[1,0,1]
  v_pk_fma_f32 v[216:217], v[216:217], v[118:119], v[14:15] op_sel:[0,0,0] op_sel_hi:[1,0,1]
  v_pk_fma_f32 v[218:219], v[218:219], v[118:119], v[16:17] op_sel:[0,0,0] op_sel_hi:[1,0,1]
  v_pk_fma_f32 v[248:249], v[248:249], v[118:119], v[18:19] op_sel:[0,0,0] op_sel_hi:[1,0,1]
  v_pk_fma_f32 v[250:251], v[250:251], v[118:119], v[20:21] op_sel:[0,0,0] op_sel_hi:[1,0,1]
  v_max_f32 v216, 0, v216
  v_max_f32 v218, 0, v218
  v_max_f32 v248, 0, v248
  v_max_f32 v250, 0, v250
  v_max_f32 v217, 0, v217
  v_max_f32 v219, 0, v219
  v_max_f32 v249, 0, v249
  v_max_f32 v251, 0, v251
  v_pk_mul_f32 v[216:217], v[216:217], v[216:217] op_sel:[0,0] op_sel_hi:[1,1]
  v_pk_mul_f32 v[218:219], v[218:219], v[218:219] op_sel:[0,0] op_sel_hi:[1,1]
  v_pk_mul_f32 v[248:249], v[248:249], v[248:249] op_sel:[0,0] op_sel_hi:[1,1]
  v_pk_mul_f32 v[250:251], v[250:251], v[250:251] op_sel:[0,0] op_sel_hi:[1,1]
  v_cvt_pk_bf16_f32 v96, v152, v184
  v_cvt_pk_bf16_f32 v97, v216, v248
  v_cvt_pk_bf16_f32 v98, v153, v185
  v_cvt_pk_bf16_f32 v99, v217, v249
  buffer_store_dwordx4 v[96:99], v9, s[36:39], s80 offen offset:0 sc1
  v_cvt_pk_bf16_f32 v100, v154, v186
  v_cvt_pk_bf16_f32 v101, v218, v250
  v_cvt_pk_bf16_f32 v102, v155, v187
  v_cvt_pk_bf16_f32 v103, v219, v251
  buffer_store_dwordx4 v[100:103], v9, s[36:39], s80 offen offset:1024 sc1
  s_add_u32 s80, s80, 57344
  v_pk_fma_f32 v[14:15], v[48:49], v[126:127], v[64:65] op_sel:[0,1,0] op_sel_hi:[1,1,1]
  v_pk_fma_f32 v[16:17], v[50:51], v[126:127], v[66:67] op_sel:[0,1,0] op_sel_hi:[1,1,1]
  v_pk_fma_f32 v[18:19], v[52:53], v[126:127], v[68:69] op_sel:[0,1,0] op_sel_hi:[1,1,1]
  v_pk_fma_f32 v[20:21], v[54:55], v[126:127], v[70:71] op_sel:[0,1,0] op_sel_hi:[1,1,1]
  v_pk_fma_f32 v[156:157], v[156:157], v[118:119], v[14:15] op_sel:[0,1,0] op_sel_hi:[1,1,1]
  v_pk_fma_f32 v[158:159], v[158:159], v[118:119], v[16:17] op_sel:[0,1,0] op_sel_hi:[1,1,1]
  v_pk_fma_f32 v[188:189], v[188:189], v[118:119], v[18:19] op_sel:[0,1,0] op_sel_hi:[1,1,1]
  v_pk_fma_f32 v[190:191], v[190:191], v[118:119], v[20:21] op_sel:[0,1,0] op_sel_hi:[1,1,1]
  v_max_f32 v156, 0, v156
  v_max_f32 v158, 0, v158
  v_max_f32 v188, 0, v188
  v_max_f32 v190, 0, v190
  v_max_f32 v157, 0, v157
  v_max_f32 v159, 0, v159
  v_max_f32 v189, 0, v189
  v_max_f32 v191, 0, v191
  v_pk_mul_f32 v[156:157], v[156:157], v[156:157] op_sel:[0,0] op_sel_hi:[1,1]
  v_pk_mul_f32 v[158:159], v[158:159], v[158:159] op_sel:[0,0] op_sel_hi:[1,1]
  v_pk_mul_f32 v[188:189], v[188:189], v[188:189] op_sel:[0,0] op_sel_hi:[1,1]
  v_pk_mul_f32 v[190:191], v[190:191], v[190:191] op_sel:[0,0] op_sel_hi:[1,1]
  v_pk_fma_f32 v[14:15], v[56:57], v[126:127], v[72:73] op_sel:[0,1,0] op_sel_hi:[1,1,1]
  v_pk_fma_f32 v[16:17], v[58:59], v[126:127], v[74:75] op_sel:[0,1,0] op_sel_hi:[1,1,1]
  v_pk_fma_f32 v[18:19], v[60:61], v[126:127], v[76:77] op_sel:[0,1,0] op_sel_hi:[1,1,1]
  v_pk_fma_f32 v[20:21], v[62:63], v[126:127], v[78:79] op_sel:[0,1,0] op_sel_hi:[1,1,1]
  v_pk_fma_f32 v[220:221], v[220:221], v[118:119], v[14:15] op_sel:[0,1,0] op_sel_hi:[1,1,1]
  v_pk_fma_f32 v[222:223], v[222:223], v[118:119], v[16:17] op_sel:[0,1,0] op_sel_hi:[1,1,1]
  v_pk_fma_f32 v[252:253], v[252:253], v[118:119], v[18:19] op_sel:[0,1,0] op_sel_hi:[1,1,1]
  v_pk_fma_f32 v[254:255], v[254:255], v[118:119], v[20:21] op_sel:[0,1,0] op_sel_hi:[1,1,1]
  v_max_f32 v220, 0, v220
  v_max_f32 v222, 0, v222
  v_max_f32 v252, 0, v252
  v_max_f32 v254, 0, v254
  v_max_f32 v221, 0, v221
  v_max_f32 v223, 0, v223
  v_max_f32 v253, 0, v253
  v_max_f32 v255, 0, v255
  v_pk_mul_f32 v[220:221], v[220:221], v[220:221] op_sel:[0,0] op_sel_hi:[1,1]
  v_pk_mul_f32 v[222:223], v[222:223], v[222:223] op_sel:[0,0] op_sel_hi:[1,1]
  v_pk_mul_f32 v[252:253], v[252:253], v[252:253] op_sel:[0,0] op_sel_hi:[1,1]
  v_pk_mul_f32 v[254:255], v[254:255], v[254:255] op_sel:[0,0] op_sel_hi:[1,1]
  v_cvt_pk_bf16_f32 v104, v156, v188
  v_cvt_pk_bf16_f32 v105, v220, v252
  v_cvt_pk_bf16_f32 v106, v157, v189
  v_cvt_pk_bf16_f32 v107, v221, v253
  buffer_store_dwordx4 v[104:107], v9, s[36:39], s80 offen offset:0 sc1
  v_cvt_pk_bf16_f32 v108, v158, v190
  v_cvt_pk_bf16_f32 v109, v222, v254
  v_cvt_pk_bf16_f32 v110, v159, v191
  v_cvt_pk_bf16_f32 v111, v223, v255
  buffer_store_dwordx4 v[108:111], v9, s[36:39], s80 offen offset:1024 sc1
  s_branch k_tail
k1_q:
  v_bfe_u32 v14, v0, 4, 1
  v_lshrrev_b32 v15, 5, v0
  v_and_b32 v16, 15, v0
  v_lshlrev_b32 v14, 10, v14
  v_lshl_add_u32 v14, v15, 9, v14
  v_lshl_add_u32 v9, v16, 4, v14
  s_lshl_b32 s80, s94, 17
  s_lshl_b32 s81, s95, 11
  s_add_u32 s80, s80, s81
  s_add_u32 s80, s80, 8388608
  v_pk_fma_f32 v[64:65], v[48:49], v[120:121], s[88:89] op_sel:[0,0,0] op_sel_hi:[1,0,1]
  v_pk_fma_f32 v[66:67], v[50:51], v[120:121], s[88:89] op_sel:[0,0,0] op_sel_hi:[1,0,1]
  v_pk_fma_f32 v[68:69], v[52:53], v[120:121], s[88:89] op_sel:[0,0,0] op_sel_hi:[1,0,1]
  v_pk_fma_f32 v[70:71], v[54:55], v[120:121], s[88:89] op_sel:[0,0,0] op_sel_hi:[1,0,1]
  v_pk_fma_f32 v[72:73], v[56:57], v[120:121], s[88:89] op_sel:[0,0,0] op_sel_hi:[1,0,1]
  v_pk_fma_f32 v[74:75], v[58:59], v[120:121], s[88:89] op_sel:[0,0,0] op_sel_hi:[1,0,1]
  v_pk_fma_f32 v[76:77], v[60:61], v[120:121], s[88:89] op_sel:[0,0,0] op_sel_hi:[1,0,1]
  v_pk_fma_f32 v[78:79], v[62:63], v[120:121], s[88:89] op_sel:[0,0,0] op_sel_hi:[1,0,1]
  v_pk_fma_f32 v[128:129], v[128:129], v[112:113], v[64:65] op_sel:[0,0,0] op_sel_hi:[1,0,1]
  v_pk_fma_f32 v[130:131], v[130:131], v[112:113], v[66:67] op_sel:[0,0,0] op_sel_hi:[1,0,1]
  v_pk_fma_f32 v[160:161], v[160:161], v[112:113], v[68:69] op_sel:[0,0,0] op_sel_hi:[1,0,1]
  v_pk_fma_f32 v[162:163], v[162:163], v[112:113], v[70:71] op_sel:[0,0,0] op_sel_hi:[1,0,1]
  v_pk_fma_f32 v[192:193], v[192:193], v[112:113], v[72:73] op_sel:[0,0,0] op_sel_hi:[1,0,1]
  v_pk_fma_f32 v[194:195], v[194:195], v[112:113], v[74:75] op_sel:[0,0,0] op_sel_hi:[1,0,1]
  v_pk_fma_f32 v[224:225], v[224:225], v[112:113], v[76:77] op_sel:[0,0,0] op_sel_hi:[1,0,1]
  v_pk_fma_f32 v[226:227], v[226:227], v[112:113], v[78:79] op_sel:[0,0,0] op_sel_hi:[1,0,1]
  v_pk_fma_f32 v[64:65], v[128:129], s[90:91], s[90:91] op_sel:[0,0,0] op_sel_hi:[1,1,1] neg_lo:[0,0,1] neg_hi:[0,0,1]
  v_pk_fma_f32 v[66:67], v[130:131], s[90:91], s[90:91] op_sel:[0,0,0] op_sel_hi:[1,1,1] neg_lo:[0,0,1] neg_hi:[0,0,1]
  v_pk_fma_f32 v[68:69], v[160:161], s[90:91], s[90:91] op_sel:[0,0,0] op_sel_hi:[1,1,1] neg_lo:[0,0,1] neg_hi:[0,0,1]
  v_pk_fma_f32 v[70:71], v[162:163], s[90:91], s[90:91] op_sel:[0,0,0] op_sel_hi:[1,1,1] neg_lo:[0,0,1] neg_hi:[0,0,1]
  v_pk_fma_f32 v[72:73], v[192:193], s[90:91], s[90:91] op_sel:[0,0,0] op_sel_hi:[1,1,1] neg_lo:[0,0,1] neg_hi:[0,0,1]
  v_pk_fma_f32 v[74:75], v[194:195], s[90:91], s[90:91] op_sel:[0,0,0] op_sel_hi:[1,1,1] neg_lo:[0,0,1] neg_hi:[0,0,1]
  v_pk_fma_f32 v[76:77], v[224:225], s[90:91], s[90:91] op_sel:[0,0,0] op_sel_hi:[1,1,1] neg_lo:[0,0,1] neg_hi:[0,0,1]
  v_pk_fma_f32 v[78:79], v[226:227], s[90:91], s[90:91] op_sel:[0,0,0] op_sel_hi:[1,1,1] neg_lo:[0,0,1] neg_hi:[0,0,1]
  v_exp_f32 v64, v64 clamp
  v_exp_f32 v66, v66 clamp
  v_exp_f32 v68, v68 clamp
  v_exp_f32 v70, v70 clamp
  v_exp_f32 v72, v72 clamp
  v_exp_f32 v74, v74 clamp
  v_exp_f32 v76, v76 clamp
  v_exp_f32 v78, v78 clamp
  v_exp_f32 v65, v65 clamp
  v_exp_f32 v67, v67 clamp
  v_exp_f32 v69, v69 clamp
  v_exp_f32 v71, v71 clamp
  v_exp_f32 v73, v73 clamp
  v_exp_f32 v75, v75 clamp
  v_exp_f32 v77, v77 clamp
  v_exp_f32 v79, v79 clamp
  v_pk_add_f32 v[64:65], v[64:65], s[92:93] op_sel:[0,0] op_sel_hi:[1,1]
  v_pk_add_f32 v[66:67], v[66:67], s[92:93] op_sel:[0,0] op_sel_hi:[1,1]
  v_pk_add_f32 v[68:69], v[68:69], s[92:93] op_sel:[0,0] op_sel_hi:[1,1]
  v_pk_add_f32 v[70:71], v[70:71], s[92:93] op_sel:[0,0] op_sel_hi:[1,1]
  v_pk_add_f32 v[72:73], v[72:73], s[92:93] op_sel:[0,0] op_sel_hi:[1,1]
  v_pk_add_f32 v[74:75], v[74:75], s[92:93] op_sel:[0,0] op_sel_hi:[1,1]
  v_pk_add_f32 v[76:77], v[76:77], s[92:93] op_sel:[0,0] op_sel_hi:[1,1]
  v_pk_add_f32 v[78:79], v[78:79], s[92:93] op_sel:[0,0] op_sel_hi:[1,1]
  v_max_f32 v128, v128, v64
  v_max_f32 v130, v130, v66
  v_max_f32 v160, v160, v68
  v_max_f32 v162, v162, v70
  v_max_f32 v192, v192, v72
  v_max_f32 v194, v194, v74
  v_max_f32 v224, v224, v76
  v_max_f32 v226, v226, v78
  v_max_f32 v129, v129, v65
  v_max_f32 v131, v131, v67
  v_max_f32 v161, v161, v69
  v_max_f32 v163, v163, v71
  v_max_f32 v193, v193, v73
  v_max_f32 v195, v195, v75
  v_max_f32 v225, v225, v77
  v_max_f32 v227, v227, v79
  v_cvt_pk_bf16_f32 v80, v128, v160
  v_cvt_pk_bf16_f32 v81, v129, v161
  v_cvt_pk_bf16_f32 v82, v130, v162
  v_cvt_pk_bf16_f32 v83, v131, v163
  buffer_store_dwordx4 v[80:83], v9, s[36:39], s80 offen offset:0 sc1
  v_cvt_pk_bf16_f32 v84, v192, v224
  v_cvt_pk_bf16_f32 v85, v193, v225
  v_cvt_pk_bf16_f32 v86, v194, v226
  v_cvt_pk_bf16_f32 v87, v195, v227
  buffer_store_dwordx4 v[84:87], v9, s[36:39], s80 offen offset:256 sc1
  s_add_u32 s80, s80, 16384
  v_pk_fma_f32 v[64:65], v[48:49], v[120:121], s[88:89] op_sel:[0,1,0] op_sel_hi:[1,1,1]
  v_pk_fma_f32 v[66:67], v[50:51], v[120:121], s[88:89] op_sel:[0,1,0] op_sel_hi:[1,1,1]
  v_pk_fma_f32 v[68:69], v[52:53], v[120:121], s[88:89] op_sel:[0,1,0] op_sel_hi:[1,1,1]
  v_pk_fma_f32 v[70:71], v[54:55], v[120:121], s[88:89] op_sel:[0,1,0] op_sel_hi:[1,1,1]
  v_pk_fma_f32 v[72:73], v[56:57], v[120:121], s[88:89] op_sel:[0,1,0] op_sel_hi:[1,1,1]
  v_pk_fma_f32 v[74:75], v[58:59], v[120:121], s[88:89] op_sel:[0,1,0] op_sel_hi:[1,1,1]
  v_pk_fma_f32 v[76:77], v[60:61], v[120:121], s[88:89] op_sel:[0,1,0] op_sel_hi:[1,1,1]
  v_pk_fma_f32 v[78:79], v[62:63], v[120:121], s[88:89] op_sel:[0,1,0] op_sel_hi:[1,1,1]
  v_pk_fma_f32 v[132:133], v[132:133], v[112:113], v[64:65] op_sel:[0,1,0] op_sel_hi:[1,1,1]
  v_pk_fma_f32 v[134:135], v[134:135], v[112:113], v[66:67] op_sel:[0,1,0] op_sel_hi:[1,1,1]
  v_pk_fma_f32 v[164:165], v[164:165], v[112:113], v[68:69] op_sel:[0,1,0] op_sel_hi:[1,1,1]
  v_pk_fma_f32 v[166:167], v[166:167], v[112:113], v[70:71] op_sel:[0,1,0] op_sel_hi:[1,1,1]
  v_pk_fma_f32 v[196:197], v[196:197], v[112:113], v[72:73] op_sel:[0,1,0] op_sel_hi:[1,1,1]
  v_pk_fma_f32 v[198:199], v[198:199], v[112:113], v[74:75] op_sel:[0,1,0] op_sel_hi:[1,1,1]
  v_pk_fma_f32 v[228:229], v[228:229], v[112:113], v[76:77] op_sel:[0,1,0] op_sel_hi:[1,1,1]
  v_pk_fma_f32 v[230:231], v[230:231], v[112:113], v[78:79] op_sel:[0,1,0] op_sel_hi:[1,1,1]
  v_pk_fma_f32 v[64:65], v[132:133], s[90:91], s[90:91] op_sel:[0,0,0] op_sel_hi:[1,1,1] neg_lo:[0,0,1] neg_hi:[0,0,1]
  v_pk_fma_f32 v[66:67], v[134:135], s[90:91], s[90:91] op_sel:[0,0,0] op_sel_hi:[1,1,1] neg_lo:[0,0,1] neg_hi:[0,0,1]
  v_pk_fma_f32 v[68:69], v[164:165], s[90:91], s[90:91] op_sel:[0,0,0] op_sel_hi:[1,1,1] neg_lo:[0,0,1] neg_hi:[0,0,1]
  v_pk_fma_f32 v[70:71], v[166:167], s[90:91], s[90:91] op_sel:[0,0,0] op_sel_hi:[1,1,1] neg_lo:[0,0,1] neg_hi:[0,0,1]
  v_pk_fma_f32 v[72:73], v[196:197], s[90:91], s[90:91] op_sel:[0,0,0] op_sel_hi:[1,1,1] neg_lo:[0,0,1] neg_hi:[0,0,1]
  v_pk_fma_f32 v[74:75], v[198:199], s[90:91], s[90:91] op_sel:[0,0,0] op_sel_hi:[1,1,1] neg_lo:[0,0,1] neg_hi:[0,0,1]
  v_pk_fma_f32 v[76:77], v[228:229], s[90:91], s[90:91] op_sel:[0,0,0] op_sel_hi:[1,1,1] neg_lo:[0,0,1] neg_hi:[0,0,1]
  v_pk_fma_f32 v[78:79], v[230:231], s[90:91], s[90:91] op_sel:[0,0,0] op_sel_hi:[1,1,1] neg_lo:[0,0,1] neg_hi:[0,0,1]
  v_exp_f32 v64, v64 clamp
  v_exp_f32 v66, v66 clamp
  v_exp_f32 v68, v68 clamp
  v_exp_f32 v70, v70 clamp
  v_exp_f32 v72, v72 clamp
  v_exp_f32 v74, v74 clamp
  v_exp_f32 v76, v76 clamp
  v_exp_f32 v78, v78 clamp
  v_exp_f32 v65, v65 clamp
  v_exp_f32 v67, v67 clamp
  v_exp_f32 v69, v69 clamp
  v_exp_f32 v71, v71 clamp
  v_exp_f32 v73, v73 clamp
  v_exp_f32 v75, v75 clamp
  v_exp_f32 v77, v77 clamp
  v_exp_f32 v79, v79 clamp
  v_pk_add_f32 v[64:65], v[64:65], s[92:93] op_sel:[0,0] op_sel_hi:[1,1]
  v_pk_add_f32 v[66:67], v[66:67], s[92:93] op_sel:[0,0] op_sel_hi:[1,1]
  v_pk_add_f32 v[68:69], v[68:69], s[92:93] op_sel:[0,0] op_sel_hi:[1,1]
  v_pk_add_f32 v[70:71], v[70:71], s[92:93] op_sel:[0,0] op_sel_hi:[1,1]
  v_pk_add_f32 v[72:73], v[72:73], s[92:93] op_sel:[0,0] op_sel_hi:[1,1]
  v_pk_add_f32 v[74:75], v[74:75], s[92:93] op_sel:[0,0] op_sel_hi:[1,1]
  v_pk_add_f32 v[76:77], v[76:77], s[92:93] op_sel:[0,0] op_sel_hi:[1,1]
  v_pk_add_f32 v[78:79], v[78:79], s[92:93] op_sel:[0,0] op_sel_hi:[1,1]
  v_max_f32 v132, v132, v64
  v_max_f32 v134, v134, v66
  v_max_f32 v164, v164, v68
  v_max_f32 v166, v166, v70
  v_max_f32 v196, v196, v72
  v_max_f32 v198, v198, v74
  v_max_f32 v228, v228, v76
  v_max_f32 v230, v230, v78
  v_max_f32 v133, v133, v65
  v_max_f32 v135, v135, v67
  v_max_f32 v165, v165, v69
  v_max_f32 v167, v167, v71
  v_max_f32 v197, v197, v73
  v_max_f32 v199, v199, v75
  v_max_f32 v229, v229, v77
  v_max_f32 v231, v231, v79
  v_cvt_pk_bf16_f32 v88, v132, v164
  v_cvt_pk_bf16_f32 v89, v133, v165
  v_cvt_pk_bf16_f32 v90, v134, v166
  v_cvt_pk_bf16_f32 v91, v135, v167
  buffer_store_dwordx4 v[88:91], v9, s[36:39], s80 offen offset:0 sc1
  v_cvt_pk_bf16_f32 v92, v196, v228
  v_cvt_pk_bf16_f32 v93, v197, v229
  v_cvt_pk_bf16_f32 v94, v198, v230
  v_cvt_pk_bf16_f32 v95, v199, v231
  buffer_store_dwordx4 v[92:95], v9, s[36:39], s80 offen offset:256 sc1
  s_add_u32 s80, s80, 16384
  v_pk_fma_f32 v[64:65], v[48:49], v[122:123], s[88:89] op_sel:[0,0,0] op_sel_hi:[1,0,1]
  v_pk_fma_f32 v[66:67], v[50:51], v[122:123], s[88:89] op_sel:[0,0,0] op_sel_hi:[1,0,1]
  v_pk_fma_f32 v[68:69], v[52:53], v[122:123], s[88:89] op_sel:[0,0,0] op_sel_hi:[1,0,1]
  v_pk_fma_f32 v[70:71], v[54:55], v[122:123], s[88:89] op_sel:[0,0,0] op_sel_hi:[1,0,1]
  v_pk_fma_f32 v[72:73], v[56:57], v[122:123], s[88:89] op_sel:[0,0,0] op_sel_hi:[1,0,1]
  v_pk_fma_f32 v[74:75], v[58:59], v[122:123], s[88:89] op_sel:[0,0,0] op_sel_hi:[1,0,1]
  v_pk_fma_f32 v[76:77], v[60:61], v[122:123], s[88:89] op_sel:[0,0,0] op_sel_hi:[1,0,1]
  v_pk_fma_f32 v[78:79], v[62:63], v[122:123], s[88:89] op_sel:[0,0,0] op_sel_hi:[1,0,1]
  v_pk_fma_f32 v[136:137], v[136:137], v[114:115], v[64:65] op_sel:[0,0,0] op_sel_hi:[1,0,1]
  v_pk_fma_f32 v[138:139], v[138:139], v[114:115], v[66:67] op_sel:[0,0,0] op_sel_hi:[1,0,1]
  v_pk_fma_f32 v[168:169], v[168:169], v[114:115], v[68:69] op_sel:[0,0,0] op_sel_hi:[1,0,1]
  v_pk_fma_f32 v[170:171], v[170:171], v[114:115], v[70:71] op_sel:[0,0,0] op_sel_hi:[1,0,1]
  v_pk_fma_f32 v[200:201], v[200:201], v[114:115], v[72:73] op_sel:[0,0,0] op_sel_hi:[1,0,1]
  v_pk_fma_f32 v[202:203], v[202:203], v[114:115], v[74:75] op_sel:[0,0,0] op_sel_hi:[1,0,1]
  v_pk_fma_f32 v[232:233], v[232:233], v[114:115], v[76:77] op_sel:[0,0,0] op_sel_hi:[1,0,1]
  v_pk_fma_f32 v[234:235], v[234:235], v[114:115], v[78:79] op_sel:[0,0,0] op_sel_hi:[1,0,1]
  v_pk_fma_f32 v[64:65], v[136:137], s[90:91], s[90:91] op_sel:[0,0,0] op_sel_hi:[1,1,1] neg_lo:[0,0,1] neg_hi:[0,0,1]
  v_pk_fma_f32 v[66:67], v[138:139], s[90:91], s[90:91] op_sel:[0,0,0] op_sel_hi:[1,1,1] neg_lo:[0,0,1] neg_hi:[0,0,1]
  v_pk_fma_f32 v[68:69], v[168:169], s[90:91], s[90:91] op_sel:[0,0,0] op_sel_hi:[1,1,1] neg_lo:[0,0,1] neg_hi:[0,0,1]
  v_pk_fma_f32 v[70:71], v[170:171], s[90:91], s[90:91] op_sel:[0,0,0] op_sel_hi:[1,1,1] neg_lo:[0,0,1] neg_hi:[0,0,1]
  v_pk_fma_f32 v[72:73], v[200:201], s[90:91], s[90:91] op_sel:[0,0,0] op_sel_hi:[1,1,1] neg_lo:[0,0,1] neg_hi:[0,0,1]
  v_pk_fma_f32 v[74:75], v[202:203], s[90:91], s[90:91] op_sel:[0,0,0] op_sel_hi:[1,1,1] neg_lo:[0,0,1] neg_hi:[0,0,1]
  v_pk_fma_f32 v[76:77], v[232:233], s[90:91], s[90:91] op_sel:[0,0,0] op_sel_hi:[1,1,1] neg_lo:[0,0,1] neg_hi:[0,0,1]
  v_pk_fma_f32 v[78:79], v[234:235], s[90:91], s[90:91] op_sel:[0,0,0] op_sel_hi:[1,1,1] neg_lo:[0,0,1] neg_hi:[0,0,1]
  v_exp_f32 v64, v64 clamp
  v_exp_f32 v66, v66 clamp
  v_exp_f32 v68, v68 clamp
  v_exp_f32 v70, v70 clamp
  v_exp_f32 v72, v72 clamp
  v_exp_f32 v74, v74 clamp
  v_exp_f32 v76, v76 clamp
  v_exp_f32 v78, v78 clamp
  v_exp_f32 v65, v65 clamp
  v_exp_f32 v67, v67 clamp
  v_exp_f32 v69, v69 clamp
  v_exp_f32 v71, v71 clamp
  v_exp_f32 v73, v73 clamp
  v_exp_f32 v75, v75 clamp
  v_exp_f32 v77, v77 clamp
  v_exp_f32 v79, v79 clamp
  v_pk_add_f32 v[64:65], v[64:65], s[92:93] op_sel:[0,0] op_sel_hi:[1,1]
  v_pk_add_f32 v[66:67], v[66:67], s[92:93] op_sel:[0,0] op_sel_hi:[1,1]
  v_pk_add_f32 v[68:69], v[68:69], s[92:93] op_sel:[0,0] op_sel_hi:[1,1]
  v_pk_add_f32 v[70:71], v[70:71], s[92:93] op_sel:[0,0] op_sel_hi:[1,1]
  v_pk_add_f32 v[72:73], v[72:73], s[92:93] op_sel:[0,0] op_sel_hi:[1,1]
  v_pk_add_f32 v[74:75], v[74:75], s[92:93] op_sel:[0,0] op_sel_hi:[1,1]
  v_pk_add_f32 v[76:77], v[76:77], s[92:93] op_sel:[0,0] op_sel_hi:[1,1]
  v_pk_add_f32 v[78:79], v[78:79], s[92:93] op_sel:[0,0] op_sel_hi:[1,1]
  v_max_f32 v136, v136, v64
  v_max_f32 v138, v138, v66
  v_max_f32 v168, v168, v68
  v_max_f32 v170, v170, v70
  v_max_f32 v200, v200, v72
  v_max_f32 v202, v202, v74
  v_max_f32 v232, v232, v76
  v_max_f32 v234, v234, v78
  v_max_f32 v137, v137, v65
  v_max_f32 v139, v139, v67
  v_max_f32 v169, v169, v69
  v_max_f32 v171, v171, v71
  v_max_f32 v201, v201, v73
  v_max_f32 v203, v203, v75
  v_max_f32 v233, v233, v77
  v_max_f32 v235, v235, v79
  v_cvt_pk_bf16_f32 v96, v136, v168
  v_cvt_pk_bf16_f32 v97, v137, v169
  v_cvt_pk_bf16_f32 v98, v138, v170
  v_cvt_pk_bf16_f32 v99, v139, v171
  buffer_store_dwordx4 v[96:99], v9, s[36:39], s80 offen offset:0 sc1
  v_cvt_pk_bf16_f32 v100, v200, v232
  v_cvt_pk_bf16_f32 v101, v201, v233
  v_cvt_pk_bf16_f32 v102, v202, v234
  v_cvt_pk_bf16_f32 v103, v203, v235
  buffer_store_dwordx4 v[100:103], v9, s[36:39], s80 offen offset:256 sc1
  s_add_u32 s80, s80, 16384
  v_pk_fma_f32 v[64:65], v[48:49], v[122:123], s[88:89] op_sel:[0,1,0] op_sel_hi:[1,1,1]
  v_pk_fma_f32 v[66:67], v[50:51], v[122:123], s[88:89] op_sel:[0,1,0] op_sel_hi:[1,1,1]
  v_pk_fma_f32 v[68:69], v[52:53], v[122:123], s[88:89] op_sel:[0,1,0] op_sel_hi:[1,1,1]
  v_pk_fma_f32 v[70:71], v[54:55], v[122:123], s[88:89] op_sel:[0,1,0] op_sel_hi:[1,1,1]
  v_pk_fma_f32 v[72:73], v[56:57], v[122:123], s[88:89] op_sel:[0,1,0] op_sel_hi:[1,1,1]
  v_pk_fma_f32 v[74:75], v[58:59], v[122:123], s[88:89] op_sel:[0,1,0] op_sel_hi:[1,1,1]
  v_pk_fma_f32 v[76:77], v[60:61], v[122:123], s[88:89] op_sel:[0,1,0] op_sel_hi:[1,1,1]
  v_pk_fma_f32 v[78:79], v[62:63], v[122:123], s[88:89] op_sel:[0,1,0] op_sel_hi:[1,1,1]
  v_pk_fma_f32 v[140:141], v[140:141], v[114:115], v[64:65] op_sel:[0,1,0] op_sel_hi:[1,1,1]
  v_pk_fma_f32 v[142:143], v[142:143], v[114:115], v[66:67] op_sel:[0,1,0] op_sel_hi:[1,1,1]
  v_pk_fma_f32 v[172:173], v[172:173], v[114:115], v[68:69] op_sel:[0,1,0] op_sel_hi:[1,1,1]
  v_pk_fma_f32 v[174:175], v[174:175], v[114:115], v[70:71] op_sel:[0,1,0] op_sel_hi:[1,1,1]
  v_pk_fma_f32 v[204:205], v[204:205], v[114:115], v[72:73] op_sel:[0,1,0] op_sel_hi:[1,1,1]
  v_pk_fma_f32 v[206:207], v[206:207], v[114:115], v[74:75] op_sel:[0,1,0] op_sel_hi:[1,1,1]
  v_pk_fma_f32 v[236:237], v[236:237], v[114:115], v[76:77] op_sel:[0,1,0] op_sel_hi:[1,1,1]
  v_pk_fma_f32 v[238:239], v[238:239], v[114:115], v[78:79] op_sel:[0,1,0] op_sel_hi:[1,1,1]
  v_pk_fma_f32 v[64:65], v[140:141], s[90:91], s[90:91] op_sel:[0,0,0] op_sel_hi:[1,1,1] neg_lo:[0,0,1] neg_hi:[0,0,1]
  v_pk_fma_f32 v[66:67], v[142:143], s[90:91], s[90:91] op_sel:[0,0,0] op_sel_hi:[1,1,1] neg_lo:[0,0,1] neg_hi:[0,0,1]
  v_pk_fma_f32 v[68:69], v[172:173], s[90:91], s[90:91] op_sel:[0,0,0] op_sel_hi:[1,1,1] neg_lo:[0,0,1] neg_hi:[0,0,1]
  v_pk_fma_f32 v[70:71], v[174:175], s[90:91], s[90:91] op_sel:[0,0,0] op_sel_hi:[1,1,1] neg_lo:[0,0,1] neg_hi:[0,0,1]
  v_pk_fma_f32 v[72:73], v[204:205], s[90:91], s[90:91] op_sel:[0,0,0] op_sel_hi:[1,1,1] neg_lo:[0,0,1] neg_hi:[0,0,1]
  v_pk_fma_f32 v[74:75], v[206:207], s[90:91], s[90:91] op_sel:[0,0,0] op_sel_hi:[1,1,1] neg_lo:[0,0,1] neg_hi:[0,0,1]
  v_pk_fma_f32 v[76:77], v[236:237], s[90:91], s[90:91] op_sel:[0,0,0] op_sel_hi:[1,1,1] neg_lo:[0,0,1] neg_hi:[0,0,1]
  v_pk_fma_f32 v[78:79], v[238:239], s[90:91], s[90:91] op_sel:[0,0,0] op_sel_hi:[1,1,1] neg_lo:[0,0,1] neg_hi:[0,0,1]
  v_exp_f32 v64, v64 clamp
  v_exp_f32 v66, v66 clamp
  v_exp_f32 v68, v68 clamp
  v_exp_f32 v70, v70 clamp
  v_exp_f32 v72, v72 clamp
  v_exp_f32 v74, v74 clamp
  v_exp_f32 v76, v76 clamp
  v_exp_f32 v78, v78 clamp
  v_exp_f32 v65, v65 clamp
  v_exp_f32 v67, v67 clamp
  v_exp_f32 v69, v69 clamp
  v_exp_f32 v71, v71 clamp
  v_exp_f32 v73, v73 clamp
  v_exp_f32 v75, v75 clamp
  v_exp_f32 v77, v77 clamp
  v_exp_f32 v79, v79 clamp
  v_pk_add_f32 v[64:65], v[64:65], s[92:93] op_sel:[0,0] op_sel_hi:[1,1]
  v_pk_add_f32 v[66:67], v[66:67], s[92:93] op_sel:[0,0] op_sel_hi:[1,1]
  v_pk_add_f32 v[68:69], v[68:69], s[92:93] op_sel:[0,0] op_sel_hi:[1,1]
  v_pk_add_f32 v[70:71], v[70:71], s[92:93] op_sel:[0,0] op_sel_hi:[1,1]
  v_pk_add_f32 v[72:73], v[72:73], s[92:93] op_sel:[0,0] op_sel_hi:[1,1]
  v_pk_add_f32 v[74:75], v[74:75], s[92:93] op_sel:[0,0] op_sel_hi:[1,1]
  v_pk_add_f32 v[76:77], v[76:77], s[92:93] op_sel:[0,0] op_sel_hi:[1,1]
  v_pk_add_f32 v[78:79], v[78:79], s[92:93] op_sel:[0,0] op_sel_hi:[1,1]
  v_max_f32 v140, v140, v64
  v_max_f32 v142, v142, v66
  v_max_f32 v172, v172, v68
  v_max_f32 v174, v174, v70
  v_max_f32 v204, v204, v72
  v_max_f32 v206, v206, v74
  v_max_f32 v236, v236, v76
  v_max_f32 v238, v238, v78
  v_max_f32 v141, v141, v65
  v_max_f32 v143, v143, v67
  v_max_f32 v173, v173, v69
  v_max_f32 v175, v175, v71
  v_max_f32 v205, v205, v73
  v_max_f32 v207, v207, v75
  v_max_f32 v237, v237, v77
  v_max_f32 v239, v239, v79
  v_cvt_pk_bf16_f32 v104, v140, v172
  v_cvt_pk_bf16_f32 v105, v141, v173
  v_cvt_pk_bf16_f32 v106, v142, v174
  v_cvt_pk_bf16_f32 v107, v143, v175
  buffer_store_dwordx4 v[104:107], v9, s[36:39], s80 offen offset:0 sc1
  v_cvt_pk_bf16_f32 v108, v204, v236
  v_cvt_pk_bf16_f32 v109, v205, v237
  v_cvt_pk_bf16_f32 v110, v206, v238
  v_cvt_pk_bf16_f32 v111, v207, v239
  buffer_store_dwordx4 v[108:111], v9, s[36:39], s80 offen offset:256 sc1
  s_add_u32 s80, s80, 16384
  v_pk_fma_f32 v[64:65], v[48:49], v[124:125], s[88:89] op_sel:[0,0,0] op_sel_hi:[1,0,1]
  v_pk_fma_f32 v[66:67], v[50:51], v[124:125], s[88:89] op_sel:[0,0,0] op_sel_hi:[1,0,1]
  v_pk_fma_f32 v[68:69], v[52:53], v[124:125], s[88:89] op_sel:[0,0,0] op_sel_hi:[1,0,1]
  v_pk_fma_f32 v[70:71], v[54:55], v[124:125], s[88:89] op_sel:[0,0,0] op_sel_hi:[1,0,1]
  v_pk_fma_f32 v[72:73], v[56:57], v[124:125], s[88:89] op_sel:[0,0,0] op_sel_hi:[1,0,1]
  v_pk_fma_f32 v[74:75], v[58:59], v[124:125], s[88:89] op_sel:[0,0,0] op_sel_hi:[1,0,1]
  v_pk_fma_f32 v[76:77], v[60:61], v[124:125], s[88:89] op_sel:[0,0,0] op_sel_hi:[1,0,1]
  v_pk_fma_f32 v[78:79], v[62:63], v[124:125], s[88:89] op_sel:[0,0,0] op_sel_hi:[1,0,1]
  v_pk_fma_f32 v[144:145], v[144:145], v[116:117], v[64:65] op_sel:[0,0,0] op_sel_hi:[1,0,1]
  v_pk_fma_f32 v[146:147], v[146:147], v[116:117], v[66:67] op_sel:[0,0,0] op_sel_hi:[1,0,1]
  v_pk_fma_f32 v[176:177], v[176:177], v[116:117], v[68:69] op_sel:[0,0,0] op_sel_hi:[1,0,1]
  v_pk_fma_f32 v[178:179], v[178:179], v[116:117], v[70:71] op_sel:[0,0,0] op_sel_hi:[1,0,1]
  v_pk_fma_f32 v[208:209], v[208:209], v[116:117], v[72:73] op_sel:[0,0,0] op_sel_hi:[1,0,1]
  v_pk_fma_f32 v[210:211], v[210:211], v[116:117], v[74:75] op_sel:[0,0,0] op_sel_hi:[1,0,1]
  v_pk_fma_f32 v[240:241], v[240:241], v[116:117], v[76:77] op_sel:[0,0,0] op_sel_hi:[1,0,1]
  v_pk_fma_f32 v[242:243], v[242:243], v[116:117], v[78:79] op_sel:[0,0,0] op_sel_hi:[1,0,1]
  v_pk_fma_f32 v[64:65], v[144:145], s[90:91], s[90:91] op_sel:[0,0,0] op_sel_hi:[1,1,1] neg_lo:[0,0,1] neg_hi:[0,0,1]
  v_pk_fma_f32 v[66:67], v[146:147], s[90:91], s[90:91] op_sel:[0,0,0] op_sel_hi:[1,1,1] neg_lo:[0,0,1] neg_hi:[0,0,1]
  v_pk_fma_f32 v[68:69], v[176:177], s[90:91], s[90:91] op_sel:[0,0,0] op_sel_hi:[1,1,1] neg_lo:[0,0,1] neg_hi:[0,0,1]
  v_pk_fma_f32 v[70:71], v[178:179], s[90:91], s[90:91] op_sel:[0,0,0] op_sel_hi:[1,1,1] neg_lo:[0,0,1] neg_hi:[0,0,1]
  v_pk_fma_f32 v[72:73], v[208:209], s[90:91], s[90:91] op_sel:[0,0,0] op_sel_hi:[1,1,1] neg_lo:[0,0,1] neg_hi:[0,0,1]
  v_pk_fma_f32 v[74:75], v[210:211], s[90:91], s[90:91] op_sel:[0,0,0] op_sel_hi:[1,1,1] neg_lo:[0,0,1] neg_hi:[0,0,1]
  v_pk_fma_f32 v[76:77], v[240:241], s[90:91], s[90:91] op_sel:[0,0,0] op_sel_hi:[1,1,1] neg_lo:[0,0,1] neg_hi:[0,0,1]
  v_pk_fma_f32 v[78:79], v[242:243], s[90:91], s[90:91] op_sel:[0,0,0] op_sel_hi:[1,1,1] neg_lo:[0,0,1] neg_hi:[0,0,1]
  v_exp_f32 v64, v64 clamp
  v_exp_f32 v66, v66 clamp
  v_exp_f32 v68, v68 clamp
  v_exp_f32 v70, v70 clamp
  v_exp_f32 v72, v72 clamp
  v_exp_f32 v74, v74 clamp
  v_exp_f32 v76, v76 clamp
  v_exp_f32 v78, v78 clamp
  v_exp_f32 v65, v65 clamp
  v_exp_f32 v67, v67 clamp
  v_exp_f32 v69, v69 clamp
  v_exp_f32 v71, v71 clamp
  v_exp_f32 v73, v73 clamp
  v_exp_f32 v75, v75 clamp
  v_exp_f32 v77, v77 clamp
  v_exp_f32 v79, v79 clamp
  v_pk_add_f32 v[64:65], v[64:65], s[92:93] op_sel:[0,0] op_sel_hi:[1,1]
  v_pk_add_f32 v[66:67], v[66:67], s[92:93] op_sel:[0,0] op_sel_hi:[1,1]
  v_pk_add_f32 v[68:69], v[68:69], s[92:93] op_sel:[0,0] op_sel_hi:[1,1]
  v_pk_add_f32 v[70:71], v[70:71], s[92:93] op_sel:[0,0] op_sel_hi:[1,1]
  v_pk_add_f32 v[72:73], v[72:73], s[92:93] op_sel:[0,0] op_sel_hi:[1,1]
  v_pk_add_f32 v[74:75], v[74:75], s[92:93] op_sel:[0,0] op_sel_hi:[1,1]
  v_pk_add_f32 v[76:77], v[76:77], s[92:93] op_sel:[0,0] op_sel_hi:[1,1]
  v_pk_add_f32 v[78:79], v[78:79], s[92:93] op_sel:[0,0] op_sel_hi:[1,1]
  v_max_f32 v144, v144, v64
  v_max_f32 v146, v146, v66
  v_max_f32 v176, v176, v68
  v_max_f32 v178, v178, v70
  v_max_f32 v208, v208, v72
  v_max_f32 v210, v210, v74
  v_max_f32 v240, v240, v76
  v_max_f32 v242, v242, v78
  v_max_f32 v145, v145, v65
  v_max_f32 v147, v147, v67
  v_max_f32 v177, v177, v69
  v_max_f32 v179, v179, v71
  v_max_f32 v209, v209, v73
  v_max_f32 v211, v211, v75
  v_max_f32 v241, v241, v77
  v_max_f32 v243, v243, v79
  v_cvt_pk_bf16_f32 v80, v144, v176
  v_cvt_pk_bf16_f32 v81, v145, v177
  v_cvt_pk_bf16_f32 v82, v146, v178
  v_cvt_pk_bf16_f32 v83, v147, v179
  buffer_store_dwordx4 v[80:83], v9, s[36:39], s80 offen offset:0 sc1
  v_cvt_pk_bf16_f32 v84, v208, v240
  v_cvt_pk_bf16_f32 v85, v209, v241
  v_cvt_pk_bf16_f32 v86, v210, v242
  v_cvt_pk_bf16_f32 v87, v211, v243
  buffer_store_dwordx4 v[84:87], v9, s[36:39], s80 offen offset:256 sc1
  s_add_u32 s80, s80, 16384
  v_pk_fma_f32 v[64:65], v[48:49], v[124:125], s[88:89] op_sel:[0,1,0] op_sel_hi:[1,1,1]
  v_pk_fma_f32 v[66:67], v[50:51], v[124:125], s[88:89] op_sel:[0,1,0] op_sel_hi:[1,1,1]
  v_pk_fma_f32 v[68:69], v[52:53], v[124:125], s[88:89] op_sel:[0,1,0] op_sel_hi:[1,1,1]
  v_pk_fma_f32 v[70:71], v[54:55], v[124:125], s[88:89] op_sel:[0,1,0] op_sel_hi:[1,1,1]
  v_pk_fma_f32 v[72:73], v[56:57], v[124:125], s[88:89] op_sel:[0,1,0] op_sel_hi:[1,1,1]
  v_pk_fma_f32 v[74:75], v[58:59], v[124:125], s[88:89] op_sel:[0,1,0] op_sel_hi:[1,1,1]
  v_pk_fma_f32 v[76:77], v[60:61], v[124:125], s[88:89] op_sel:[0,1,0] op_sel_hi:[1,1,1]
  v_pk_fma_f32 v[78:79], v[62:63], v[124:125], s[88:89] op_sel:[0,1,0] op_sel_hi:[1,1,1]
  v_pk_fma_f32 v[148:149], v[148:149], v[116:117], v[64:65] op_sel:[0,1,0] op_sel_hi:[1,1,1]
  v_pk_fma_f32 v[150:151], v[150:151], v[116:117], v[66:67] op_sel:[0,1,0] op_sel_hi:[1,1,1]
  v_pk_fma_f32 v[180:181], v[180:181], v[116:117], v[68:69] op_sel:[0,1,0] op_sel_hi:[1,1,1]
  v_pk_fma_f32 v[182:183], v[182:183], v[116:117], v[70:71] op_sel:[0,1,0] op_sel_hi:[1,1,1]
  v_pk_fma_f32 v[212:213], v[212:213], v[116:117], v[72:73] op_sel:[0,1,0] op_sel_hi:[1,1,1]
  v_pk_fma_f32 v[214:215], v[214:215], v[116:117], v[74:75] op_sel:[0,1,0] op_sel_hi:[1,1,1]
  v_pk_fma_f32 v[244:245], v[244:245], v[116:117], v[76:77] op_sel:[0,1,0] op_sel_hi:[1,1,1]
  v_pk_fma_f32 v[246:247], v[246:247], v[116:117], v[78:79] op_sel:[0,1,0] op_sel_hi:[1,1,1]
  v_pk_fma_f32 v[64:65], v[148:149], s[90:91], s[90:91] op_sel:[0,0,0] op_sel_hi:[1,1,1] neg_lo:[0,0,1] neg_hi:[0,0,1]
  v_pk_fma_f32 v[66:67], v[150:151], s[90:91], s[90:91] op_sel:[0,0,0] op_sel_hi:[1,1,1] neg_lo:[0,0,1] neg_hi:[0,0,1]
  v_pk_fma_f32 v[68:69], v[180:181], s[90:91], s[90:91] op_sel:[0,0,0] op_sel_hi:[1,1,1] neg_lo:[0,0,1] neg_hi:[0,0,1]
  v_pk_fma_f32 v[70:71], v[182:183], s[90:91], s[90:91] op_sel:[0,0,0] op_sel_hi:[1,1,1] neg_lo:[0,0,1] neg_hi:[0,0,1]
  v_pk_fma_f32 v[72:73], v[212:213], s[90:91], s[90:91] op_sel:[0,0,0] op_sel_hi:[1,1,1] neg_lo:[0,0,1] neg_hi:[0,0,1]
  v_pk_fma_f32 v[74:75], v[214:215], s[90:91], s[90:91] op_sel:[0,0,0] op_sel_hi:[1,1,1] neg_lo:[0,0,1] neg_hi:[0,0,1]
  v_pk_fma_f32 v[76:77], v[244:245], s[90:91], s[90:91] op_sel:[0,0,0] op_sel_hi:[1,1,1] neg_lo:[0,0,1] neg_hi:[0,0,1]
  v_pk_fma_f32 v[78:79], v[246:247], s[90:91], s[90:91] op_sel:[0,0,0] op_sel_hi:[1,1,1] neg_lo:[0,0,1] neg_hi:[0,0,1]
  v_exp_f32 v64, v64 clamp
  v_exp_f32 v66, v66 clamp
  v_exp_f32 v68, v68 clamp
  v_exp_f32 v70, v70 clamp
  v_exp_f32 v72, v72 clamp
  v_exp_f32 v74, v74 clamp
  v_exp_f32 v76, v76 clamp
  v_exp_f32 v78, v78 clamp
  v_exp_f32 v65, v65 clamp
  v_exp_f32 v67, v67 clamp
  v_exp_f32 v69, v69 clamp
  v_exp_f32 v71, v71 clamp
  v_exp_f32 v73, v73 clamp
  v_exp_f32 v75, v75 clamp
  v_exp_f32 v77, v77 clamp
  v_exp_f32 v79, v79 clamp
  v_pk_add_f32 v[64:65], v[64:65], s[92:93] op_sel:[0,0] op_sel_hi:[1,1]
  v_pk_add_f32 v[66:67], v[66:67], s[92:93] op_sel:[0,0] op_sel_hi:[1,1]
  v_pk_add_f32 v[68:69], v[68:69], s[92:93] op_sel:[0,0] op_sel_hi:[1,1]
  v_pk_add_f32 v[70:71], v[70:71], s[92:93] op_sel:[0,0] op_sel_hi:[1,1]
  v_pk_add_f32 v[72:73], v[72:73], s[92:93] op_sel:[0,0] op_sel_hi:[1,1]
  v_pk_add_f32 v[74:75], v[74:75], s[92:93] op_sel:[0,0] op_sel_hi:[1,1]
  v_pk_add_f32 v[76:77], v[76:77], s[92:93] op_sel:[0,0] op_sel_hi:[1,1]
  v_pk_add_f32 v[78:79], v[78:79], s[92:93] op_sel:[0,0] op_sel_hi:[1,1]
  v_max_f32 v148, v148, v64
  v_max_f32 v150, v150, v66
  v_max_f32 v180, v180, v68
  v_max_f32 v182, v182, v70
  v_max_f32 v212, v212, v72
  v_max_f32 v214, v214, v74
  v_max_f32 v244, v244, v76
  v_max_f32 v246, v246, v78
  v_max_f32 v149, v149, v65
  v_max_f32 v151, v151, v67
  v_max_f32 v181, v181, v69
  v_max_f32 v183, v183, v71
  v_max_f32 v213, v213, v73
  v_max_f32 v215, v215, v75
  v_max_f32 v245, v245, v77
  v_max_f32 v247, v247, v79
  v_cvt_pk_bf16_f32 v88, v148, v180
  v_cvt_pk_bf16_f32 v89, v149, v181
  v_cvt_pk_bf16_f32 v90, v150, v182
  v_cvt_pk_bf16_f32 v91, v151, v183
  buffer_store_dwordx4 v[88:91], v9, s[36:39], s80 offen offset:0 sc1
  v_cvt_pk_bf16_f32 v92, v212, v244
  v_cvt_pk_bf16_f32 v93, v213, v245
  v_cvt_pk_bf16_f32 v94, v214, v246
  v_cvt_pk_bf16_f32 v95, v215, v247
  buffer_store_dwordx4 v[92:95], v9, s[36:39], s80 offen offset:256 sc1
  s_add_u32 s80, s80, 16384
  v_pk_fma_f32 v[64:65], v[48:49], v[126:127], s[88:89] op_sel:[0,0,0] op_sel_hi:[1,0,1]
  v_pk_fma_f32 v[66:67], v[50:51], v[126:127], s[88:89] op_sel:[0,0,0] op_sel_hi:[1,0,1]
  v_pk_fma_f32 v[68:69], v[52:53], v[126:127], s[88:89] op_sel:[0,0,0] op_sel_hi:[1,0,1]
  v_pk_fma_f32 v[70:71], v[54:55], v[126:127], s[88:89] op_sel:[0,0,0] op_sel_hi:[1,0,1]
  v_pk_fma_f32 v[72:73], v[56:57], v[126:127], s[88:89] op_sel:[0,0,0] op_sel_hi:[1,0,1]
  v_pk_fma_f32 v[74:75], v[58:59], v[126:127], s[88:89] op_sel:[0,0,0] op_sel_hi:[1,0,1]
  v_pk_fma_f32 v[76:77], v[60:61], v[126:127], s[88:89] op_sel:[0,0,0] op_sel_hi:[1,0,1]
  v_pk_fma_f32 v[78:79], v[62:63], v[126:127], s[88:89] op_sel:[0,0,0] op_sel_hi:[1,0,1]
  v_pk_fma_f32 v[152:153], v[152:153], v[118:119], v[64:65] op_sel:[0,0,0] op_sel_hi:[1,0,1]
  v_pk_fma_f32 v[154:155], v[154:155], v[118:119], v[66:67] op_sel:[0,0,0] op_sel_hi:[1,0,1]
  v_pk_fma_f32 v[184:185], v[184:185], v[118:119], v[68:69] op_sel:[0,0,0] op_sel_hi:[1,0,1]
  v_pk_fma_f32 v[186:187], v[186:187], v[118:119], v[70:71] op_sel:[0,0,0] op_sel_hi:[1,0,1]
  v_pk_fma_f32 v[216:217], v[216:217], v[118:119], v[72:73] op_sel:[0,0,0] op_sel_hi:[1,0,1]
  v_pk_fma_f32 v[218:219], v[218:219], v[118:119], v[74:75] op_sel:[0,0,0] op_sel_hi:[1,0,1]
  v_pk_fma_f32 v[248:249], v[248:249], v[118:119], v[76:77] op_sel:[0,0,0] op_sel_hi:[1,0,1]
  v_pk_fma_f32 v[250:251], v[250:251], v[118:119], v[78:79] op_sel:[0,0,0] op_sel_hi:[1,0,1]
  v_pk_fma_f32 v[64:65], v[152:153], s[90:91], s[90:91] op_sel:[0,0,0] op_sel_hi:[1,1,1] neg_lo:[0,0,1] neg_hi:[0,0,1]
  v_pk_fma_f32 v[66:67], v[154:155], s[90:91], s[90:91] op_sel:[0,0,0] op_sel_hi:[1,1,1] neg_lo:[0,0,1] neg_hi:[0,0,1]
  v_pk_fma_f32 v[68:69], v[184:185], s[90:91], s[90:91] op_sel:[0,0,0] op_sel_hi:[1,1,1] neg_lo:[0,0,1] neg_hi:[0,0,1]
  v_pk_fma_f32 v[70:71], v[186:187], s[90:91], s[90:91] op_sel:[0,0,0] op_sel_hi:[1,1,1] neg_lo:[0,0,1] neg_hi:[0,0,1]
  v_pk_fma_f32 v[72:73], v[216:217], s[90:91], s[90:91] op_sel:[0,0,0] op_sel_hi:[1,1,1] neg_lo:[0,0,1] neg_hi:[0,0,1]
  v_pk_fma_f32 v[74:75], v[218:219], s[90:91], s[90:91] op_sel:[0,0,0] op_sel_hi:[1,1,1] neg_lo:[0,0,1] neg_hi:[0,0,1]
  v_pk_fma_f32 v[76:77], v[248:249], s[90:91], s[90:91] op_sel:[0,0,0] op_sel_hi:[1,1,1] neg_lo:[0,0,1] neg_hi:[0,0,1]
  v_pk_fma_f32 v[78:79], v[250:251], s[90:91], s[90:91] op_sel:[0,0,0] op_sel_hi:[1,1,1] neg_lo:[0,0,1] neg_hi:[0,0,1]
  v_exp_f32 v64, v64 clamp
  v_exp_f32 v66, v66 clamp
  v_exp_f32 v68, v68 clamp
  v_exp_f32 v70, v70 clamp
  v_exp_f32 v72, v72 clamp
  v_exp_f32 v74, v74 clamp
  v_exp_f32 v76, v76 clamp
  v_exp_f32 v78, v78 clamp
  v_exp_f32 v65, v65 clamp
  v_exp_f32 v67, v67 clamp
  v_exp_f32 v69, v69 clamp
  v_exp_f32 v71, v71 clamp
  v_exp_f32 v73, v73 clamp
  v_exp_f32 v75, v75 clamp
  v_exp_f32 v77, v77 clamp
  v_exp_f32 v79, v79 clamp
  v_pk_add_f32 v[64:65], v[64:65], s[92:93] op_sel:[0,0] op_sel_hi:[1,1]
  v_pk_add_f32 v[66:67], v[66:67], s[92:93] op_sel:[0,0] op_sel_hi:[1,1]
  v_pk_add_f32 v[68:69], v[68:69], s[92:93] op_sel:[0,0] op_sel_hi:[1,1]
  v_pk_add_f32 v[70:71], v[70:71], s[92:93] op_sel:[0,0] op_sel_hi:[1,1]
  v_pk_add_f32 v[72:73], v[72:73], s[92:93] op_sel:[0,0] op_sel_hi:[1,1]
  v_pk_add_f32 v[74:75], v[74:75], s[92:93] op_sel:[0,0] op_sel_hi:[1,1]
  v_pk_add_f32 v[76:77], v[76:77], s[92:93] op_sel:[0,0] op_sel_hi:[1,1]
  v_pk_add_f32 v[78:79], v[78:79], s[92:93] op_sel:[0,0] op_sel_hi:[1,1]
  v_max_f32 v152, v152, v64
  v_max_f32 v154, v154, v66
  v_max_f32 v184, v184, v68
  v_max_f32 v186, v186, v70
  v_max_f32 v216, v216, v72
  v_max_f32 v218, v218, v74
  v_max_f32 v248, v248, v76
  v_max_f32 v250, v250, v78
  v_max_f32 v153, v153, v65
  v_max_f32 v155, v155, v67
  v_max_f32 v185, v185, v69
  v_max_f32 v187, v187, v71
  v_max_f32 v217, v217, v73
  v_max_f32 v219, v219, v75
  v_max_f32 v249, v249, v77
  v_max_f32 v251, v251, v79
  v_cvt_pk_bf16_f32 v96, v152, v184
  v_cvt_pk_bf16_f32 v97, v153, v185
  v_cvt_pk_bf16_f32 v98, v154, v186
  v_cvt_pk_bf16_f32 v99, v155, v187
  buffer_store_dwordx4 v[96:99], v9, s[36:39], s80 offen offset:0 sc1
  v_cvt_pk_bf16_f32 v100, v216, v248
  v_cvt_pk_bf16_f32 v101, v217, v249
  v_cvt_pk_bf16_f32 v102, v218, v250
  v_cvt_pk_bf16_f32 v103, v219, v251
  buffer_store_dwordx4 v[100:103], v9, s[36:39], s80 offen offset:256 sc1
  s_add_u32 s80, s80, 16384
  v_pk_fma_f32 v[64:65], v[48:49], v[126:127], s[88:89] op_sel:[0,1,0] op_sel_hi:[1,1,1]
  v_pk_fma_f32 v[66:67], v[50:51], v[126:127], s[88:89] op_sel:[0,1,0] op_sel_hi:[1,1,1]
  v_pk_fma_f32 v[68:69], v[52:53], v[126:127], s[88:89] op_sel:[0,1,0] op_sel_hi:[1,1,1]
  v_pk_fma_f32 v[70:71], v[54:55], v[126:127], s[88:89] op_sel:[0,1,0] op_sel_hi:[1,1,1]
  v_pk_fma_f32 v[72:73], v[56:57], v[126:127], s[88:89] op_sel:[0,1,0] op_sel_hi:[1,1,1]
  v_pk_fma_f32 v[74:75], v[58:59], v[126:127], s[88:89] op_sel:[0,1,0] op_sel_hi:[1,1,1]
  v_pk_fma_f32 v[76:77], v[60:61], v[126:127], s[88:89] op_sel:[0,1,0] op_sel_hi:[1,1,1]
  v_pk_fma_f32 v[78:79], v[62:63], v[126:127], s[88:89] op_sel:[0,1,0] op_sel_hi:[1,1,1]
  v_pk_fma_f32 v[156:157], v[156:157], v[118:119], v[64:65] op_sel:[0,1,0] op_sel_hi:[1,1,1]
  v_pk_fma_f32 v[158:159], v[158:159], v[118:119], v[66:67] op_sel:[0,1,0] op_sel_hi:[1,1,1]
  v_pk_fma_f32 v[188:189], v[188:189], v[118:119], v[68:69] op_sel:[0,1,0] op_sel_hi:[1,1,1]
  v_pk_fma_f32 v[190:191], v[190:191], v[118:119], v[70:71] op_sel:[0,1,0] op_sel_hi:[1,1,1]
  v_pk_fma_f32 v[220:221], v[220:221], v[118:119], v[72:73] op_sel:[0,1,0] op_sel_hi:[1,1,1]
  v_pk_fma_f32 v[222:223], v[222:223], v[118:119], v[74:75] op_sel:[0,1,0] op_sel_hi:[1,1,1]
  v_pk_fma_f32 v[252:253], v[252:253], v[118:119], v[76:77] op_sel:[0,1,0] op_sel_hi:[1,1,1]
  v_pk_fma_f32 v[254:255], v[254:255], v[118:119], v[78:79] op_sel:[0,1,0] op_sel_hi:[1,1,1]
  v_pk_fma_f32 v[64:65], v[156:157], s[90:91], s[90:91] op_sel:[0,0,0] op_sel_hi:[1,1,1] neg_lo:[0,0,1] neg_hi:[0,0,1]
  v_pk_fma_f32 v[66:67], v[158:159], s[90:91], s[90:91] op_sel:[0,0,0] op_sel_hi:[1,1,1] neg_lo:[0,0,1] neg_hi:[0,0,1]
  v_pk_fma_f32 v[68:69], v[188:189], s[90:91], s[90:91] op_sel:[0,0,0] op_sel_hi:[1,1,1] neg_lo:[0,0,1] neg_hi:[0,0,1]
  v_pk_fma_f32 v[70:71], v[190:191], s[90:91], s[90:91] op_sel:[0,0,0] op_sel_hi:[1,1,1] neg_lo:[0,0,1] neg_hi:[0,0,1]
  v_pk_fma_f32 v[72:73], v[220:221], s[90:91], s[90:91] op_sel:[0,0,0] op_sel_hi:[1,1,1] neg_lo:[0,0,1] neg_hi:[0,0,1]
  v_pk_fma_f32 v[74:75], v[222:223], s[90:91], s[90:91] op_sel:[0,0,0] op_sel_hi:[1,1,1] neg_lo:[0,0,1] neg_hi:[0,0,1]
  v_pk_fma_f32 v[76:77], v[252:253], s[90:91], s[90:91] op_sel:[0,0,0] op_sel_hi:[1,1,1] neg_lo:[0,0,1] neg_hi:[0,0,1]
  v_pk_fma_f32 v[78:79], v[254:255], s[90:91], s[90:91] op_sel:[0,0,0] op_sel_hi:[1,1,1] neg_lo:[0,0,1] neg_hi:[0,0,1]
  v_exp_f32 v64, v64 clamp
  v_exp_f32 v66, v66 clamp
  v_exp_f32 v68, v68 clamp
  v_exp_f32 v70, v70 clamp
  v_exp_f32 v72, v72 clamp
  v_exp_f32 v74, v74 clamp
  v_exp_f32 v76, v76 clamp
  v_exp_f32 v78, v78 clamp
  v_exp_f32 v65, v65 clamp
  v_exp_f32 v67, v67 clamp
  v_exp_f32 v69, v69 clamp
  v_exp_f32 v71, v71 clamp
  v_exp_f32 v73, v73 clamp
  v_exp_f32 v75, v75 clamp
  v_exp_f32 v77, v77 clamp
  v_exp_f32 v79, v79 clamp
  v_pk_add_f32 v[64:65], v[64:65], s[92:93] op_sel:[0,0] op_sel_hi:[1,1]
  v_pk_add_f32 v[66:67], v[66:67], s[92:93] op_sel:[0,0] op_sel_hi:[1,1]
  v_pk_add_f32 v[68:69], v[68:69], s[92:93] op_sel:[0,0] op_sel_hi:[1,1]
  v_pk_add_f32 v[70:71], v[70:71], s[92:93] op_sel:[0,0] op_sel_hi:[1,1]
  v_pk_add_f32 v[72:73], v[72:73], s[92:93] op_sel:[0,0] op_sel_hi:[1,1]
  v_pk_add_f32 v[74:75], v[74:75], s[92:93] op_sel:[0,0] op_sel_hi:[1,1]
  v_pk_add_f32 v[76:77], v[76:77], s[92:93] op_sel:[0,0] op_sel_hi:[1,1]
  v_pk_add_f32 v[78:79], v[78:79], s[92:93] op_sel:[0,0] op_sel_hi:[1,1]
  v_max_f32 v156, v156, v64
  v_max_f32 v158, v158, v66
  v_max_f32 v188, v188, v68
  v_max_f32 v190, v190, v70
  v_max_f32 v220, v220, v72
  v_max_f32 v222, v222, v74
  v_max_f32 v252, v252, v76
  v_max_f32 v254, v254, v78
  v_max_f32 v157, v157, v65
  v_max_f32 v159, v159, v67
  v_max_f32 v189, v189, v69
  v_max_f32 v191, v191, v71
  v_max_f32 v221, v221, v73
  v_max_f32 v223, v223, v75
  v_max_f32 v253, v253, v77
  v_max_f32 v255, v255, v79
  v_cvt_pk_bf16_f32 v104, v156, v188
  v_cvt_pk_bf16_f32 v105, v157, v189
  v_cvt_pk_bf16_f32 v106, v158, v190
  v_cvt_pk_bf16_f32 v107, v159, v191
  buffer_store_dwordx4 v[104:107], v9, s[36:39], s80 offen offset:0 sc1
  v_cvt_pk_bf16_f32 v108, v220, v252
  v_cvt_pk_bf16_f32 v109, v221, v253
  v_cvt_pk_bf16_f32 v110, v222, v254
  v_cvt_pk_bf16_f32 v111, v223, v255
  buffer_store_dwordx4 v[108:111], v9, s[36:39], s80 offen offset:256 sc1
  s_branch k_tail
k1_kv:
  s_add_u32 m0, s98, 0
  s_nop 0
  buffer_load_dwordx4 v9, s[28:31], s48 offen offset:0 lds
  buffer_load_dwordx4 v10, s[28:31], s48 offen offset:1024 lds
  buffer_load_dwordx4 v11, s[28:31], s48 offen offset:2048 lds
  buffer_load_dwordx4 v12, s[28:31], s48 offen offset:3072 lds
  buffer_load_dwordx4 v[48:51], v1, s[32:35], s56 offen
  buffer_load_dwordx4 v[52:55], v2, s[32:35], s56 offen
  buffer_load_dwordx4 v[56:59], v3, s[32:35], s56 offen
  buffer_load_dwordx4 v[60:63], v4, s[32:35], s56 offen
  buffer_load_dwordx4 v[64:67], v1, s[32:35], s57 offen
  buffer_load_dwordx4 v[68:71], v2, s[32:35], s57 offen
  buffer_load_dwordx4 v[72:75], v3, s[32:35], s57 offen
  buffer_load_dwordx4 v[76:79], v4, s[32:35], s57 offen
  s_add_u32 m0, s98, 16384
  s_nop 0
  buffer_load_dwordx4 v9, s[28:31], s49 offen offset:0 lds
  buffer_load_dwordx4 v10, s[28:31], s49 offen offset:1024 lds
  buffer_load_dwordx4 v11, s[28:31], s49 offen offset:2048 lds
  buffer_load_dwordx4 v12, s[28:31], s49 offen offset:3072 lds
  buffer_load_dwordx4 v[80:83], v1, s[32:35], s58 offen
  buffer_load_dwordx4 v[84:87], v2, s[32:35], s58 offen
  buffer_load_dwordx4 v[88:91], v3, s[32:35], s58 offen
  buffer_load_dwordx4 v[92:95], v4, s[32:35], s58 offen
  s_waitcnt vmcnt(16)
  s_barrier
  ds_read_b128 a[0:3], v5 offset:0
  ds_read_b128 a[4:7], v5 offset:2048
  ds_read_b128 a[8:11], v5 offset:4096
  ds_read_b128 a[12:15], v5 offset:6144
  ds_read_b128 a[16:19], v5 offset:8192
  ds_read_b128 a[20:23], v5 offset:10240
  ds_read_b128 a[24:27], v5 offset:12288
  ds_read_b128 a[28:31], v5 offset:14336
  s_mov_b64 vcc, s[72:73]
  s_waitcnt vmcnt(15)
  v_cndmask_b32_dpp v14, v50, v48, vcc row_ror:8 row_mask:0xf bank_mask:0xf
  v_mov_b32_dpp v50, v48 row_ror:8 row_mask:0xf bank_mask:0x3
  v_cndmask_b32_dpp v48, v51, v49, vcc row_ror:8 row_mask:0xf bank_mask:0xf
  v_mov_b32_dpp v51, v49 row_ror:8 row_mask:0xf bank_mask:0x3
  s_waitcnt vmcnt(14)
  v_cndmask_b32_dpp v15, v54, v52, vcc row_ror:8 row_mask:0xf bank_mask:0xf
  v_mov_b32_dpp v54, v52 row_ror:8 row_mask:0xf bank_mask:0x3
  v_cndmask_b32_dpp v52, v55, v53, vcc row_ror:8 row_mask:0xf bank_mask:0xf
  v_mov_b32_dpp v55, v53 row_ror:8 row_mask:0xf bank_mask:0x3
  s_mov_b64 vcc, s[74:75]
  v_cndmask_b32_dpp v49, v48, v14, vcc row_ror:4 row_mask:0xf bank_mask:0xf
  v_mov_b32_dpp v48, v14 row_ror:12 row_mask:0xf bank_mask:0x5
  v_cndmask_b32_dpp v14, v51, v50, vcc row_ror:4 row_mask:0xf bank_mask:0xf
  v_mov_b32_dpp v51, v50 row_ror:12 row_mask:0xf bank_mask:0x5
  v_cndmask_b32_dpp v53, v52, v15, vcc row_ror:4 row_mask:0xf bank_mask:0xf
  v_mov_b32_dpp v52, v15 row_ror:12 row_mask:0xf bank_mask:0x5
  v_cndmask_b32_dpp v15, v55, v54, vcc row_ror:4 row_mask:0xf bank_mask:0xf
  v_mov_b32_dpp v55, v54 row_ror:12 row_mask:0xf bank_mask:0x5
  s_mov_b64 vcc, s[72:73]
  s_waitcnt vmcnt(13)
  v_cndmask_b32_dpp v16, v58, v56, vcc row_ror:8 row_mask:0xf bank_mask:0xf
  v_mov_b32_dpp v58, v56 row_ror:8 row_mask:0xf bank_mask:0x3
  v_cndmask_b32_dpp v56, v59, v57, vcc row_ror:8 row_mask:0xf bank_mask:0xf
  v_mov_b32_dpp v59, v57 row_ror:8 row_mask:0xf bank_mask:0x3
  s_waitcnt vmcnt(12)
  v_cndmask_b32_dpp v17, v62, v60, vcc row_ror:8 row_mask:0xf bank_mask:0xf
  v_mov_b32_dpp v62, v60 row_ror:8 row_mask:0xf bank_mask:0x3
  v_cndmask_b32_dpp v60, v63, v61, vcc row_ror:8 row_mask:0xf bank_mask:0xf
  v_mov_b32_dpp v63, v61 row_ror:8 row_mask:0xf bank_mask:0x3
  s_mov_b64 vcc, s[74:75]
  v_cndmask_b32_dpp v57, v56, v16, vcc row_ror:4 row_mask:0xf bank_mask:0xf
  v_mov_b32_dpp v56, v16 row_ror:12 row_mask:0xf bank_mask:0x5
  v_cndmask_b32_dpp v16, v59, v58, vcc row_ror:4 row_mask:0xf bank_mask:0xf
  v_mov_b32_dpp v59, v58 row_ror:12 row_mask:0xf bank_mask:0x5
  v_cndmask_b32_dpp v61, v60, v17, vcc row_ror:4 row_mask:0xf bank_mask:0xf
  v_mov_b32_dpp v60, v17 row_ror:12 row_mask:0xf bank_mask:0x5
  v_cndmask_b32_dpp v17, v63, v62, vcc row_ror:4 row_mask:0xf bank_mask:0xf
  v_mov_b32_dpp v63, v62 row_ror:12 row_mask:0xf bank_mask:0x5
  v_perm_b32 v32, v14, v49, s70
  v_perm_b32 v36, v14, v49, s71
  v_perm_b32 v33, v15, v53, s70
  v_perm_b32 v37, v15, v53, s71
  v_perm_b32 v34, v16, v57, s70
  v_perm_b32 v38, v16, v57, s71
  v_perm_b32 v35, v17, v61, s70
  v_perm_b32 v39, v17, v61, s71
  s_waitcnt lgkmcnt(7)
  v_mfma_f32_16x16x32_bf16 v[128:131], a[0:3], v[32:35], 0
  v_perm_b32 v40, v51, v48, s70
  v_perm_b32 v44, v51, v48, s71
  buffer_load_dwordx4 v[96:99], v1, s[32:35], s59 offen
  v_mfma_f32_16x16x32_bf16 v[160:163], a[0:3], v[36:39], 0
  v_perm_b32 v41, v55, v52, s70
  v_perm_b32 v45, v55, v52, s71
  buffer_load_dwordx4 v[100:103], v2, s[32:35], s59 offen
  s_waitcnt lgkmcnt(6)
  v_mfma_f32_16x16x32_bf16 v[132:135], a[4:7], v[32:35], 0
  v_perm_b32 v42, v59, v56, s70
  v_perm_b32 v46, v59, v56, s71
  ds_read_b128 a[32:35], v6 offset:0
  v_mfma_f32_16x16x32_bf16 v[164:167], a[4:7], v[36:39], 0
  v_perm_b32 v43, v63, v60, s70
  buffer_load_dwordx4 v[104:107], v3, s[32:35], s59 offen
  s_waitcnt lgkmcnt(6)
  v_mfma_f32_16x16x32_bf16 v[136:139], a[8:11], v[32:35], 0
  v_perm_b32 v47, v63, v60, s71
  s_mov_b64 vcc, s[72:73]
  v_mfma_f32_16x16x32_bf16 v[168:171], a[8:11], v[36:39], 0
  s_waitcnt vmcnt(14)
  v_cndmask_b32_dpp v14, v66, v64, vcc row_ror:8 row_mask:0xf bank_mask:0xf
  v_mov_b32_dpp v66, v64 row_ror:8 row_mask:0xf bank_mask:0x3
  ds_read_b128 a[36:39], v6 offset:2048
  buffer_load_dwordx4 v[108:111], v4, s[32:35], s59 offen
  s_waitcnt lgkmcnt(6)
  v_mfma_f32_16x16x32_bf16 v[140:143], a[12:15], v[32:35], 0
  v_cndmask_b32_dpp v64, v67, v65, vcc row_ror:8 row_mask:0xf bank_mask:0xf
  v_mov_b32_dpp v67, v65 row_ror:8 row_mask:0xf bank_mask:0x3
  v_mfma_f32_16x16x32_bf16 v[172:175], a[12:15], v[36:39], 0
  s_waitcnt vmcnt(14)
  v_cndmask_b32_dpp v15, v70, v68, vcc row_ror:8 row_mask:0xf bank_mask:0xf
  s_add_u32 m0, s98, 32768
  s_waitcnt lgkmcnt(5)
  v_mfma_f32_16x16x32_bf16 v[144:147], a[16:19], v[32:35], 0
  v_mov_b32_dpp v70, v68 row_ror:8 row_mask:0xf bank_mask:0x3
  v_cndmask_b32_dpp v68, v71, v69, vcc row_ror:8 row_mask:0xf bank_mask:0xf
  ds_read_b128 a[40:43], v6 offset:4096
  buffer_load_dwordx4 v9, s[28:31], s50 offen offset:0 lds
  v_mfma_f32_16x16x32_bf16 v[176:179], a[16:19], v[36:39], 0
  v_mov_b32_dpp v71, v69 row_ror:8 row_mask:0xf bank_mask:0x3
  s_mov_b64 vcc, s[74:75]
  s_waitcnt lgkmcnt(5)
  v_mfma_f32_16x16x32_bf16 v[148:151], a[20:23], v[32:35], 0
  v_cndmask_b32_dpp v65, v64, v14, vcc row_ror:4 row_mask:0xf bank_mask:0xf
  v_mov_b32_dpp v64, v14 row_ror:12 row_mask:0xf bank_mask:0x5
  buffer_load_dwordx4 v10, s[28:31], s50 offen offset:1024 lds
  v_mfma_f32_16x16x32_bf16 v[180:183], a[20:23], v[36:39], 0
  v_cndmask_b32_dpp v14, v67, v66, vcc row_ror:4 row_mask:0xf bank_mask:0xf
  ds_read_b128 a[44:47], v6 offset:6144
  s_waitcnt lgkmcnt(5)
  v_mfma_f32_16x16x32_bf16 v[152:155], a[24:27], v[32:35], 0
  v_mov_b32_dpp v67, v66 row_ror:12 row_mask:0xf bank_mask:0x5
  v_cndmask_b32_dpp v69, v68, v15, vcc row_ror:4 row_mask:0xf bank_mask:0xf
  buffer_load_dwordx4 v11, s[28:31], s50 offen offset:2048 lds
  v_mfma_f32_16x16x32_bf16 v[184:187], a[24:27], v[36:39], 0
  v_mov_b32_dpp v68, v15 row_ror:12 row_mask:0xf bank_mask:0x5
  v_cndmask_b32_dpp v15, v71, v70, vcc row_ror:4 row_mask:0xf bank_mask:0xf
  s_waitcnt lgkmcnt(4)
  v_mfma_f32_16x16x32_bf16 v[156:159], a[28:31], v[32:35], 0
  v_mov_b32_dpp v71, v70 row_ror:12 row_mask:0xf bank_mask:0x5
  buffer_load_dwordx4 v12, s[28:31], s50 offen offset:3072 lds
  v_mfma_f32_16x16x32_bf16 v[188:191], a[28:31], v[36:39], 0
  v_mfma_f32_16x16x32_bf16 a[240:243], v[24:27], v[32:35], 0
  v_mfma_f32_16x16x32_bf16 a[244:247], v[24:27], v[36:39], 0
  v_mfma_f32_16x16x32_bf16 v[192:195], a[0:3], v[40:43], 0
  s_mov_b64 vcc, s[72:73]
  s_waitcnt vmcnt(17)
  v_cndmask_b32_dpp v16, v74, v72, vcc row_ror:8 row_mask:0xf bank_mask:0xf
  buffer_load_dwordx4 v[112:115], v1, s[32:35], s60 offen
  v_mfma_f32_16x16x32_bf16 v[224:227], a[0:3], v[44:47], 0
  v_mov_b32_dpp v74, v72 row_ror:8 row_mask:0xf bank_mask:0x3
  v_cndmask_b32_dpp v72, v75, v73, vcc row_ror:8 row_mask:0xf bank_mask:0xf
  ds_read_b128 a[48:51], v6 offset:8192
  buffer_load_dwordx4 v[116:119], v2, s[32:35], s60 offen
  v_mfma_f32_16x16x32_bf16 v[196:199], a[4:7], v[40:43], 0
  v_mov_b32_dpp v75, v73 row_ror:8 row_mask:0xf bank_mask:0x3
  s_waitcnt vmcnt(18)
  v_cndmask_b32_dpp v17, v78, v76, vcc row_ror:8 row_mask:0xf bank_mask:0xf
  v_mfma_f32_16x16x32_bf16 v[228:231], a[4:7], v[44:47], 0
  v_mov_b32_dpp v78, v76 row_ror:8 row_mask:0xf bank_mask:0x3
  ds_read_b128 a[52:55], v6 offset:10240
  buffer_load_dwordx4 v[120:123], v3, s[32:35], s60 offen
  v_mfma_f32_16x16x32_bf16 v[200:203], a[8:11], v[40:43], 0
  v_cndmask_b32_dpp v76, v79, v77, vcc row_ror:8 row_mask:0xf bank_mask:0xf
  v_mov_b32_dpp v79, v77 row_ror:8 row_mask:0xf bank_mask:0x3
  buffer_load_dwordx4 v[124:127], v4, s[32:35], s60 offen
  v_mfma_f32_16x16x32_bf16 v[232:235], a[8:11], v[44:47], 0
  s_mov_b64 vcc, s[74:75]
  v_cndmask_b32_dpp v73, v72, v16, vcc row_ror:4 row_mask:0xf bank_mask:0xf
  v_mfma_f32_16x16x32_bf16 v[204:207], a[12:15], v[40:43], 0
  v_mov_b32_dpp v72, v16 row_ror:12 row_mask:0xf bank_mask:0x5
  v_cndmask_b32_dpp v16, v75, v74, vcc row_ror:4 row_mask:0xf bank_mask:0xf
  ds_read_b128 a[56:59], v6 offset:12288
  buffer_load_dwordx4 v[48:51], v1, s[32:35], s61 offen
  v_mfma_f32_16x16x32_bf16 v[236:239], a[12:15], v[44:47], 0
  v_mov_b32_dpp v75, v74 row_ror:12 row_mask:0xf bank_mask:0x5
  v_mfma_f32_16x16x32_bf16 v[208:211], a[16:19], v[40:43], 0
  v_cndmask_b32_dpp v77, v76, v17, vcc row_ror:4 row_mask:0xf bank_mask:0xf
  v_mov_b32_dpp v76, v17 row_ror:12 row_mask:0xf bank_mask:0x5
  ds_read_b128 a[60:63], v6 offset:14336
  buffer_load_dwordx4 v[52:55], v2, s[32:35], s61 offen
  v_mfma_f32_16x16x32_bf16 v[240:243], a[16:19], v[44:47], 0
  v_cndmask_b32_dpp v17, v79, v78, vcc row_ror:4 row_mask:0xf bank_mask:0xf
  v_mov_b32_dpp v79, v78 row_ror:12 row_mask:0xf bank_mask:0x5
  buffer_load_dwordx4 v[56:59], v3, s[32:35], s61 offen
  v_mfma_f32_16x16x32_bf16 v[212:215], a[20:23], v[40:43], 0
  v_perm_b32 v32, v14, v65, s70
  v_perm_b32 v36, v14, v65, s71
  v_mfma_f32_16x16x32_bf16 v[244:247], a[20:23], v[44:47], 0
  v_perm_b32 v33, v15, v69, s70
  buffer_load_dwordx4 v[60:63], v4, s[32:35], s61 offen
  v_mfma_f32_16x16x32_bf16 v[216:219], a[24:27], v[40:43], 0
  v_perm_b32 v37, v15, v69, s71
  v_perm_b32 v34, v16, v73, s70
  v_mfma_f32_16x16x32_bf16 v[248:251], a[24:27], v[44:47], 0
  v_perm_b32 v38, v16, v73, s71
  v_perm_b32 v35, v17, v77, s70
  v_mfma_f32_16x16x32_bf16 v[220:223], a[28:31], v[40:43], 0
  v_perm_b32 v39, v17, v77, s71
  v_mfma_f32_16x16x32_bf16 v[252:255], a[28:31], v[44:47], 0
  v_mfma_f32_16x16x32_bf16 a[248:251], v[24:27], v[40:43], 0
  v_mfma_f32_16x16x32_bf16 a[252:255], v[24:27], v[44:47], 0
  s_waitcnt lgkmcnt(7)
  v_mfma_f32_16x16x32_bf16 v[128:131], a[32:35], v[32:35], v[128:131]
  v_perm_b32 v40, v67, v64, s70
  v_perm_b32 v44, v67, v64, s71
  s_add_u32 m0, s98, 49152
  v_mfma_f32_16x16x32_bf16 v[160:163], a[32:35], v[36:39], v[160:163]
  v_perm_b32 v41, v71, v68, s70
  v_perm_b32 v45, v71, v68, s71
  s_waitcnt lgkmcnt(6)
  v_mfma_f32_16x16x32_bf16 v[132:135], a[36:39], v[32:35], v[132:135]
  v_perm_b32 v42, v75, v72, s70
  v_perm_b32 v46, v75, v72, s71
  s_waitcnt vmcnt(20)
  s_barrier
  v_mfma_f32_16x16x32_bf16 v[164:167], a[36:39], v[36:39], v[164:167]
  v_perm_b32 v43, v79, v76, s70
  buffer_load_dwordx4 v9, s[28:31], s51 offen offset:0 lds
  s_waitcnt lgkmcnt(5)
  v_mfma_f32_16x16x32_bf16 v[136:139], a[40:43], v[32:35], v[136:139]
  v_perm_b32 v47, v79, v76, s71
  s_mov_b64 vcc, s[72:73]
  ds_read_b128 a[0:3], v5 offset:16384
  v_mfma_f32_16x16x32_bf16 v[168:171], a[40:43], v[36:39], v[168:171]
  s_waitcnt vmcnt(20)
  v_cndmask_b32_dpp v14, v82, v80, vcc row_ror:8 row_mask:0xf bank_mask:0xf
  v_mov_b32_dpp v82, v80 row_ror:8 row_mask:0xf bank_mask:0x3
  s_waitcnt lgkmcnt(5)
  v_mfma_f32_16x16x32_bf16 v[140:143], a[44:47], v[32:35], v[140:143]
  v_cndmask_b32_dpp v80, v83, v81, vcc row_ror:8 row_mask:0xf bank_mask:0xf
  v_mov_b32_dpp v83, v81 row_ror:8 row_mask:0xf bank_mask:0x3
  ds_read_b128 a[4:7], v5 offset:18432
  buffer_load_dwordx4 v10, s[28:31], s51 offen offset:1024 lds
  v_mfma_f32_16x16x32_bf16 v[172:175], a[44:47], v[36:39], v[172:175]
  s_waitcnt vmcnt(20)
  v_cndmask_b32_dpp v15, v86, v84, vcc row_ror:8 row_mask:0xf bank_mask:0xf
  s_waitcnt lgkmcnt(5)
  v_mfma_f32_16x16x32_bf16 v[144:147], a[48:51], v[32:35], v[144:147]
  v_mov_b32_dpp v86, v84 row_ror:8 row_mask:0xf bank_mask:0x3
  v_cndmask_b32_dpp v84, v87, v85, vcc row_ror:8 row_mask:0xf bank_mask:0xf
  v_mfma_f32_16x16x32_bf16 v[176:179], a[48:51], v[36:39], v[176:179]
  v_mov_b32_dpp v87, v85 row_ror:8 row_mask:0xf bank_mask:0x3
  s_mov_b64 vcc, s[74:75]
  ds_read_b128 a[8:11], v5 offset:20480
  buffer_load_dwordx4 v11, s[28:31], s51 offen offset:2048 lds
  s_waitcnt lgkmcnt(5)
  v_mfma_f32_16x16x32_bf16 v[148:151], a[52:55], v[32:35], v[148:151]
  v_cndmask_b32_dpp v81, v80, v14, vcc row_ror:4 row_mask:0xf bank_mask:0xf
  v_mov_b32_dpp v80, v14 row_ror:12 row_mask:0xf bank_mask:0x5
  v_mfma_f32_16x16x32_bf16 v[180:183], a[52:55], v[36:39], v[180:183]
  v_cndmask_b32_dpp v14, v83, v82, vcc row_ror:4 row_mask:0xf bank_mask:0xf
  ds_read_b128 a[12:15], v5 offset:22528
  s_waitcnt lgkmcnt(5)
  v_mfma_f32_16x16x32_bf16 v[152:155], a[56:59], v[32:35], v[152:155]
  v_mov_b32_dpp v83, v82 row_ror:12 row_mask:0xf bank_mask:0x5
  v_cndmask_b32_dpp v85, v84, v15, vcc row_ror:4 row_mask:0xf bank_mask:0xf
  buffer_load_dwordx4 v12, s[28:31], s51 offen offset:3072 lds
  v_mfma_f32_16x16x32_bf16 v[184:187], a[56:59], v[36:39], v[184:187]
  v_mov_b32_dpp v84, v15 row_ror:12 row_mask:0xf bank_mask:0x5
  v_cndmask_b32_dpp v15, v87, v86, vcc row_ror:4 row_mask:0xf bank_mask:0xf
  s_waitcnt lgkmcnt(4)
  v_mfma_f32_16x16x32_bf16 v[156:159], a[60:63], v[32:35], v[156:159]
  v_mov_b32_dpp v87, v86 row_ror:12 row_mask:0xf bank_mask:0x5
  v_mfma_f32_16x16x32_bf16 v[188:191], a[60:63], v[36:39], v[188:191]
  v_mfma_f32_16x16x32_bf16 a[240:243], v[24:27], v[32:35], a[240:243]
  v_mfma_f32_16x16x32_bf16 a[244:247], v[24:27], v[36:39], a[244:247]
  v_mfma_f32_16x16x32_bf16 v[192:195], a[32:35], v[40:43], v[192:195]
  s_mov_b64 vcc, s[72:73]
  s_waitcnt vmcnt(21)
  v_cndmask_b32_dpp v16, v90, v88, vcc row_ror:8 row_mask:0xf bank_mask:0xf
  buffer_load_dwordx4 v[64:67], v1, s[32:35], s62 offen
  v_mfma_f32_16x16x32_bf16 v[224:227], a[32:35], v[44:47], v[224:227]
  v_mov_b32_dpp v90, v88 row_ror:8 row_mask:0xf bank_mask:0x3
  v_cndmask_b32_dpp v88, v91, v89, vcc row_ror:8 row_mask:0xf bank_mask:0xf
  ds_read_b128 a[16:19], v5 offset:24576
  buffer_load_dwordx4 v[68:71], v2, s[32:35], s62 offen
  v_mfma_f32_16x16x32_bf16 v[196:199], a[36:39], v[40:43], v[196:199]
  v_mov_b32_dpp v91, v89 row_ror:8 row_mask:0xf bank_mask:0x3
  s_waitcnt vmcnt(22)
  v_cndmask_b32_dpp v17, v94, v92, vcc row_ror:8 row_mask:0xf bank_mask:0xf
  v_mfma_f32_16x16x32_bf16 v[228:231], a[36:39], v[44:47], v[228:231]
  v_mov_b32_dpp v94, v92 row_ror:8 row_mask:0xf bank_mask:0x3
  ds_read_b128 a[20:23], v5 offset:26624
  buffer_load_dwordx4 v[72:75], v3, s[32:35], s62 offen
  v_mfma_f32_16x16x32_bf16 v[200:203], a[40:43], v[40:43], v[200:203]
  v_cndmask_b32_dpp v92, v95, v93, vcc row_ror:8 row_mask:0xf bank_mask:0xf
  v_mov_b32_dpp v95, v93 row_ror:8 row_mask:0xf bank_mask:0x3
  v_mfma_f32_16x16x32_bf16 v[232:235], a[40:43], v[44:47], v[232:235]
  s_mov_b64 vcc, s[74:75]
  v_cndmask_b32_dpp v89, v88, v16, vcc row_ror:4 row_mask:0xf bank_mask:0xf
  buffer_load_dwordx4 v[76:79], v4, s[32:35], s62 offen
  v_mfma_f32_16x16x32_bf16 v[204:207], a[44:47], v[40:43], v[204:207]
  v_mov_b32_dpp v88, v16 row_ror:12 row_mask:0xf bank_mask:0x5
  v_cndmask_b32_dpp v16, v91, v90, vcc row_ror:4 row_mask:0xf bank_mask:0xf
  ds_read_b128 a[24:27], v5 offset:28672
  v_mfma_f32_16x16x32_bf16 v[236:239], a[44:47], v[44:47], v[236:239]
  v_mov_b32_dpp v91, v90 row_ror:12 row_mask:0xf bank_mask:0x5
  v_mfma_f32_16x16x32_bf16 v[208:211], a[48:51], v[40:43], v[208:211]
  v_cndmask_b32_dpp v93, v92, v17, vcc row_ror:4 row_mask:0xf bank_mask:0xf
  v_mov_b32_dpp v92, v17 row_ror:12 row_mask:0xf bank_mask:0x5
  ds_read_b128 a[28:31], v5 offset:30720
  v_mfma_f32_16x16x32_bf16 v[240:243], a[48:51], v[44:47], v[240:243]
  v_cndmask_b32_dpp v17, v95, v94, vcc row_ror:4 row_mask:0xf bank_mask:0xf
  v_mov_b32_dpp v95, v94 row_ror:12 row_mask:0xf bank_mask:0x5
  s_mov_b64 exec, s[26:27]
  buffer_load_dwordx2 v[18:19], off, s[40:43], 0 sc1
  s_mov_b64 exec, -1
  v_mfma_f32_16x16x32_bf16 v[212:215], a[52:55], v[40:43], v[212:215]
  v_perm_b32 v32, v14, v81, s70
  v_perm_b32 v36, v14, v81, s71
  v_mfma_f32_16x16x32_bf16 v[244:247], a[52:55], v[44:47], v[244:247]
  v_perm_b32 v33, v15, v85, s70
  v_mfma_f32_16x16x32_bf16 v[216:219], a[56:59], v[40:43], v[216:219]
  v_perm_b32 v37, v15, v85, s71
  v_perm_b32 v34, v16, v89, s70
  v_mfma_f32_16x16x32_bf16 v[248:251], a[56:59], v[44:47], v[248:251]
  v_perm_b32 v38, v16, v89, s71
  v_perm_b32 v35, v17, v93, s70
  v_mfma_f32_16x16x32_bf16 v[220:223], a[60:63], v[40:43], v[220:223]
  v_perm_b32 v39, v17, v93, s71
  v_mfma_f32_16x16x32_bf16 v[252:255], a[60:63], v[44:47], v[252:255]
  v_mfma_f32_16x16x32_bf16 a[248:251], v[24:27], v[40:43], a[248:251]
  v_mfma_f32_16x16x32_bf16 a[252:255], v[24:27], v[44:47], a[252:255]
  s_waitcnt lgkmcnt(7)
  v_mfma_f32_16x16x32_bf16 v[128:131], a[0:3], v[32:35], v[128:131]
  v_perm_b32 v40, v83, v80, s70
  v_perm_b32 v44, v83, v80, s71
  s_add_u32 m0, s98, 65536
  v_mfma_f32_16x16x32_bf16 v[160:163], a[0:3], v[36:39], v[160:163]
  v_perm_b32 v41, v87, v84, s70
  v_perm_b32 v45, v87, v84, s71
  s_waitcnt lgkmcnt(6)
  v_mfma_f32_16x16x32_bf16 v[132:135], a[4:7], v[32:35], v[132:135]
  v_perm_b32 v42, v91, v88, s70
  v_perm_b32 v46, v91, v88, s71
  ds_read_b128 a[32:35], v6 offset:16384
  v_mfma_f32_16x16x32_bf16 v[164:167], a[4:7], v[36:39], v[164:167]
  v_perm_b32 v43, v95, v92, s70
  buffer_load_dwordx4 v9, s[28:31], s52 offen offset:0 lds
  s_waitcnt lgkmcnt(6)
  v_mfma_f32_16x16x32_bf16 v[136:139], a[8:11], v[32:35], v[136:139]
  v_perm_b32 v47, v95, v92, s71
  s_mov_b64 vcc, s[72:73]
  v_mfma_f32_16x16x32_bf16 v[168:171], a[8:11], v[36:39], v[168:171]
  s_waitcnt vmcnt(25)
  v_cndmask_b32_dpp v14, v98, v96, vcc row_ror:8 row_mask:0xf bank_mask:0xf
  v_mov_b32_dpp v98, v96 row_ror:8 row_mask:0xf bank_mask:0x3
  ds_read_b128 a[36:39], v6 offset:18432
  s_waitcnt lgkmcnt(6)
  v_mfma_f32_16x16x32_bf16 v[140:143], a[12:15], v[32:35], v[140:143]
  v_cndmask_b32_dpp v96, v99, v97, vcc row_ror:8 row_mask:0xf bank_mask:0xf
  v_mov_b32_dpp v99, v97 row_ror:8 row_mask:0xf bank_mask:0x3
  buffer_load_dwordx4 v10, s[28:31], s52 offen offset:1024 lds
  v_mfma_f32_16x16x32_bf16 v[172:175], a[12:15], v[36:39], v[172:175]
  s_waitcnt vmcnt(25)
  v_cndmask_b32_dpp v15, v102, v100, vcc row_ror:8 row_mask:0xf bank_mask:0xf
  s_waitcnt lgkmcnt(5)
  v_mfma_f32_16x16x32_bf16 v[144:147], a[16:19], v[32:35], v[144:147]
  v_mov_b32_dpp v102, v100 row_ror:8 row_mask:0xf bank_mask:0x3
  v_cndmask_b32_dpp v100, v103, v101, vcc row_ror:8 row_mask:0xf bank_mask:0xf
  ds_read_b128 a[40:43], v6 offset:20480
  v_mfma_f32_16x16x32_bf16 v[176:179], a[16:19], v[36:39], v[176:179]
  v_mov_b32_dpp v103, v101 row_ror:8 row_mask:0xf bank_mask:0x3
  s_mov_b64 vcc, s[74:75]
  buffer_load_dwordx4 v11, s[28:31], s52 offen offset:2048 lds
  s_waitcnt lgkmcnt(5)
  v_mfma_f32_16x16x32_bf16 v[148:151], a[20:23], v[32:35], v[148:151]
  v_cndmask_b32_dpp v97, v96, v14, vcc row_ror:4 row_mask:0xf bank_mask:0xf
  v_mov_b32_dpp v96, v14 row_ror:12 row_mask:0xf bank_mask:0x5
  v_mfma_f32_16x16x32_bf16 v[180:183], a[20:23], v[36:39], v[180:183]
  v_cndmask_b32_dpp v14, v99, v98, vcc row_ror:4 row_mask:0xf bank_mask:0xf
  ds_read_b128 a[44:47], v6 offset:22528
  s_waitcnt lgkmcnt(5)
  v_mfma_f32_16x16x32_bf16 v[152:155], a[24:27], v[32:35], v[152:155]
  v_mov_b32_dpp v99, v98 row_ror:12 row_mask:0xf bank_mask:0x5
  v_cndmask_b32_dpp v101, v100, v15, vcc row_ror:4 row_mask:0xf bank_mask:0xf
  buffer_load_dwordx4 v12, s[28:31], s52 offen offset:3072 lds
  v_mfma_f32_16x16x32_bf16 v[184:187], a[24:27], v[36:39], v[184:187]
  v_mov_b32_dpp v100, v15 row_ror:12 row_mask:0xf bank_mask:0x5
  v_cndmask_b32_dpp v15, v103, v102, vcc row_ror:4 row_mask:0xf bank_mask:0xf
  s_waitcnt lgkmcnt(4)
  v_mfma_f32_16x16x32_bf16 v[156:159], a[28:31], v[32:35], v[156:159]
  v_mov_b32_dpp v103, v102 row_ror:12 row_mask:0xf bank_mask:0x5
  v_mfma_f32_16x16x32_bf16 v[188:191], a[28:31], v[36:39], v[188:191]
  v_mfma_f32_16x16x32_bf16 a[240:243], v[24:27], v[32:35], a[240:243]
  v_mfma_f32_16x16x32_bf16 a[244:247], v[24:27], v[36:39], a[244:247]
  v_mfma_f32_16x16x32_bf16 v[192:195], a[0:3], v[40:43], v[192:195]
  s_mov_b64 vcc, s[72:73]
  s_waitcnt vmcnt(26)
  v_cndmask_b32_dpp v16, v106, v104, vcc row_ror:8 row_mask:0xf bank_mask:0xf
  buffer_load_dwordx4 v[80:83], v1, s[32:35], s63 offen
  v_mfma_f32_16x16x32_bf16 v[224:227], a[0:3], v[44:47], v[224:227]
  v_mov_b32_dpp v106, v104 row_ror:8 row_mask:0xf bank_mask:0x3
  v_cndmask_b32_dpp v104, v107, v105, vcc row_ror:8 row_mask:0xf bank_mask:0xf
  ds_read_b128 a[48:51], v6 offset:24576
  buffer_load_dwordx4 v[84:87], v2, s[32:35], s63 offen
  v_mfma_f32_16x16x32_bf16 v[196:199], a[4:7], v[40:43], v[196:199]
  v_mov_b32_dpp v107, v105 row_ror:8 row_mask:0xf bank_mask:0x3
  s_waitcnt vmcnt(27)
  v_cndmask_b32_dpp v17, v110, v108, vcc row_ror:8 row_mask:0xf bank_mask:0xf
  v_mfma_f32_16x16x32_bf16 v[228:231], a[4:7], v[44:47], v[228:231]
  v_mov_b32_dpp v110, v108 row_ror:8 row_mask:0xf bank_mask:0x3
  ds_read_b128 a[52:55], v6 offset:26624
  buffer_load_dwordx4 v[88:91], v3, s[32:35], s63 offen
  v_mfma_f32_16x16x32_bf16 v[200:203], a[8:11], v[40:43], v[200:203]
  v_cndmask_b32_dpp v108, v111, v109, vcc row_ror:8 row_mask:0xf bank_mask:0xf
  v_mov_b32_dpp v111, v109 row_ror:8 row_mask:0xf bank_mask:0x3
  v_mfma_f32_16x16x32_bf16 v[232:235], a[8:11], v[44:47], v[232:235]
  s_mov_b64 vcc, s[74:75]
  v_cndmask_b32_dpp v105, v104, v16, vcc row_ror:4 row_mask:0xf bank_mask:0xf
  buffer_load_dwordx4 v[92:95], v4, s[32:35], s63 offen
  v_mfma_f32_16x16x32_bf16 v[204:207], a[12:15], v[40:43], v[204:207]
  v_mov_b32_dpp v104, v16 row_ror:12 row_mask:0xf bank_mask:0x5
  v_cndmask_b32_dpp v16, v107, v106, vcc row_ror:4 row_mask:0xf bank_mask:0xf
  ds_read_b128 a[56:59], v6 offset:28672
  v_mfma_f32_16x16x32_bf16 v[236:239], a[12:15], v[44:47], v[236:239]
  v_mov_b32_dpp v107, v106 row_ror:12 row_mask:0xf bank_mask:0x5
  v_mfma_f32_16x16x32_bf16 v[208:211], a[16:19], v[40:43], v[208:211]
  v_cndmask_b32_dpp v109, v108, v17, vcc row_ror:4 row_mask:0xf bank_mask:0xf
  v_mov_b32_dpp v108, v17 row_ror:12 row_mask:0xf bank_mask:0x5
  ds_read_b128 a[60:63], v6 offset:30720
  v_mfma_f32_16x16x32_bf16 v[240:243], a[16:19], v[44:47], v[240:243]
  v_cndmask_b32_dpp v17, v111, v110, vcc row_ror:4 row_mask:0xf bank_mask:0xf
  v_mov_b32_dpp v111, v110 row_ror:12 row_mask:0xf bank_mask:0x5
  v_mfma_f32_16x16x32_bf16 v[212:215], a[20:23], v[40:43], v[212:215]
  v_perm_b32 v32, v14, v97, s70
  v_perm_b32 v36, v14, v97, s71
  v_mfma_f32_16x16x32_bf16 v[244:247], a[20:23], v[44:47], v[244:247]
  v_perm_b32 v33, v15, v101, s70
  v_mfma_f32_16x16x32_bf16 v[216:219], a[24:27], v[40:43], v[216:219]
  v_perm_b32 v37, v15, v101, s71
  v_perm_b32 v34, v16, v105, s70
  v_mfma_f32_16x16x32_bf16 v[248:251], a[24:27], v[44:47], v[248:251]
  v_perm_b32 v38, v16, v105, s71
  v_perm_b32 v35, v17, v109, s70
  v_mfma_f32_16x16x32_bf16 v[220:223], a[28:31], v[40:43], v[220:223]
  v_perm_b32 v39, v17, v109, s71
  v_mfma_f32_16x16x32_bf16 v[252:255], a[28:31], v[44:47], v[252:255]
  v_mfma_f32_16x16x32_bf16 a[248:251], v[24:27], v[40:43], a[248:251]
  v_mfma_f32_16x16x32_bf16 a[252:255], v[24:27], v[44:47], a[252:255]
  s_waitcnt lgkmcnt(7)
  v_mfma_f32_16x16x32_bf16 v[128:131], a[32:35], v[32:35], v[128:131]
  v_perm_b32 v40, v99, v96, s70
  v_perm_b32 v44, v99, v96, s71
  s_add_u32 m0, s98, 81920
  v_mfma_f32_16x16x32_bf16 v[160:163], a[32:35], v[36:39], v[160:163]
  v_perm_b32 v41, v103, v100, s70
  v_perm_b32 v45, v103, v100, s71
  s_waitcnt lgkmcnt(6)
  v_mfma_f32_16x16x32_bf16 v[132:135], a[36:39], v[32:35], v[132:135]
  v_perm_b32 v42, v107, v104, s70
  v_perm_b32 v46, v107, v104, s71
  s_waitcnt vmcnt(25)
  s_barrier
  v_mfma_f32_16x16x32_bf16 v[164:167], a[36:39], v[36:39], v[164:167]
  v_perm_b32 v43, v111, v108, s70
  buffer_load_dwordx4 v9, s[28:31], s53 offen offset:0 lds
  s_waitcnt lgkmcnt(5)
  v_mfma_f32_16x16x32_bf16 v[136:139], a[40:43], v[32:35], v[136:139]
  v_perm_b32 v47, v111, v108, s71
  s_mov_b64 vcc, s[72:73]
  ds_read_b128 a[0:3], v5 offset:32768
  v_mfma_f32_16x16x32_bf16 v[168:171], a[40:43], v[36:39], v[168:171]
  s_waitcnt vmcnt(25)
  v_cndmask_b32_dpp v14, v114, v112, vcc row_ror:8 row_mask:0xf bank_mask:0xf
  v_mov_b32_dpp v114, v112 row_ror:8 row_mask:0xf bank_mask:0x3
  s_waitcnt lgkmcnt(5)
  v_mfma_f32_16x16x32_bf16 v[140:143], a[44:47], v[32:35], v[140:143]
  v_cndmask_b32_dpp v112, v115, v113, vcc row_ror:8 row_mask:0xf bank_mask:0xf
  v_mov_b32_dpp v115, v113 row_ror:8 row_mask:0xf bank_mask:0x3
  ds_read_b128 a[4:7], v5 offset:34816
  buffer_load_dwordx4 v10, s[28:31], s53 offen offset:1024 lds
  v_mfma_f32_16x16x32_bf16 v[172:175], a[44:47], v[36:39], v[172:175]
  s_waitcnt vmcnt(25)
  v_cndmask_b32_dpp v15, v118, v116, vcc row_ror:8 row_mask:0xf bank_mask:0xf
  s_waitcnt lgkmcnt(5)
  v_mfma_f32_16x16x32_bf16 v[144:147], a[48:51], v[32:35], v[144:147]
  v_mov_b32_dpp v118, v116 row_ror:8 row_mask:0xf bank_mask:0x3
  v_cndmask_b32_dpp v116, v119, v117, vcc row_ror:8 row_mask:0xf bank_mask:0xf
  v_mfma_f32_16x16x32_bf16 v[176:179], a[48:51], v[36:39], v[176:179]
  v_mov_b32_dpp v119, v117 row_ror:8 row_mask:0xf bank_mask:0x3
  s_mov_b64 vcc, s[74:75]
  ds_read_b128 a[8:11], v5 offset:36864
  buffer_load_dwordx4 v11, s[28:31], s53 offen offset:2048 lds
  s_waitcnt lgkmcnt(5)
  v_mfma_f32_16x16x32_bf16 v[148:151], a[52:55], v[32:35], v[148:151]
  v_cndmask_b32_dpp v113, v112, v14, vcc row_ror:4 row_mask:0xf bank_mask:0xf
  v_mov_b32_dpp v112, v14 row_ror:12 row_mask:0xf bank_mask:0x5
  v_mfma_f32_16x16x32_bf16 v[180:183], a[52:55], v[36:39], v[180:183]
  v_cndmask_b32_dpp v14, v115, v114, vcc row_ror:4 row_mask:0xf bank_mask:0xf
  ds_read_b128 a[12:15], v5 offset:38912
  s_waitcnt lgkmcnt(5)
  v_mfma_f32_16x16x32_bf16 v[152:155], a[56:59], v[32:35], v[152:155]
  v_mov_b32_dpp v115, v114 row_ror:12 row_mask:0xf bank_mask:0x5
  v_cndmask_b32_dpp v117, v116, v15, vcc row_ror:4 row_mask:0xf bank_mask:0xf
  buffer_load_dwordx4 v12, s[28:31], s53 offen offset:3072 lds
  v_mfma_f32_16x16x32_bf16 v[184:187], a[56:59], v[36:39], v[184:187]
  v_mov_b32_dpp v116, v15 row_ror:12 row_mask:0xf bank_mask:0x5
  v_cndmask_b32_dpp v15, v119, v118, vcc row_ror:4 row_mask:0xf bank_mask:0xf
  s_waitcnt lgkmcnt(4)
  v_mfma_f32_16x16x32_bf16 v[156:159], a[60:63], v[32:35], v[156:159]
  v_mov_b32_dpp v119, v118 row_ror:12 row_mask:0xf bank_mask:0x5
  v_mfma_f32_16x16x32_bf16 v[188:191], a[60:63], v[36:39], v[188:191]
  v_mfma_f32_16x16x32_bf16 a[240:243], v[24:27], v[32:35], a[240:243]
  v_mfma_f32_16x16x32_bf16 a[244:247], v[24:27], v[36:39], a[244:247]
  v_mfma_f32_16x16x32_bf16 v[192:195], a[32:35], v[40:43], v[192:195]
  s_mov_b64 vcc, s[72:73]
  s_waitcnt vmcnt(26)
  v_cndmask_b32_dpp v16, v122, v120, vcc row_ror:8 row_mask:0xf bank_mask:0xf
  buffer_load_dwordx4 v[96:99], v1, s[32:35], s64 offen
  v_mfma_f32_16x16x32_bf16 v[224:227], a[32:35], v[44:47], v[224:227]
  v_mov_b32_dpp v122, v120 row_ror:8 row_mask:0xf bank_mask:0x3
  v_cndmask_b32_dpp v120, v123, v121, vcc row_ror:8 row_mask:0xf bank_mask:0xf
  ds_read_b128 a[16:19], v5 offset:40960
  buffer_load_dwordx4 v[100:103], v2, s[32:35], s64 offen
  v_mfma_f32_16x16x32_bf16 v[196:199], a[36:39], v[40:43], v[196:199]
  v_mov_b32_dpp v123, v121 row_ror:8 row_mask:0xf bank_mask:0x3
  s_waitcnt vmcnt(27)
  v_cndmask_b32_dpp v17, v126, v124, vcc row_ror:8 row_mask:0xf bank_mask:0xf
  v_mfma_f32_16x16x32_bf16 v[228:231], a[36:39], v[44:47], v[228:231]
  v_mov_b32_dpp v126, v124 row_ror:8 row_mask:0xf bank_mask:0x3
  ds_read_b128 a[20:23], v5 offset:43008
  buffer_load_dwordx4 v[104:107], v3, s[32:35], s64 offen
  v_mfma_f32_16x16x32_bf16 v[200:203], a[40:43], v[40:43], v[200:203]
  v_cndmask_b32_dpp v124, v127, v125, vcc row_ror:8 row_mask:0xf bank_mask:0xf
  v_mov_b32_dpp v127, v125 row_ror:8 row_mask:0xf bank_mask:0x3
  v_mfma_f32_16x16x32_bf16 v[232:235], a[40:43], v[44:47], v[232:235]
  s_mov_b64 vcc, s[74:75]
  v_cndmask_b32_dpp v121, v120, v16, vcc row_ror:4 row_mask:0xf bank_mask:0xf
  buffer_load_dwordx4 v[108:111], v4, s[32:35], s64 offen
  v_mfma_f32_16x16x32_bf16 v[204:207], a[44:47], v[40:43], v[204:207]
  v_mov_b32_dpp v120, v16 row_ror:12 row_mask:0xf bank_mask:0x5
  v_cndmask_b32_dpp v16, v123, v122, vcc row_ror:4 row_mask:0xf bank_mask:0xf
  ds_read_b128 a[24:27], v5 offset:45056
  v_mfma_f32_16x16x32_bf16 v[236:239], a[44:47], v[44:47], v[236:239]
  v_mov_b32_dpp v123, v122 row_ror:12 row_mask:0xf bank_mask:0x5
  v_mfma_f32_16x16x32_bf16 v[208:211], a[48:51], v[40:43], v[208:211]
  v_cndmask_b32_dpp v125, v124, v17, vcc row_ror:4 row_mask:0xf bank_mask:0xf
  v_mov_b32_dpp v124, v17 row_ror:12 row_mask:0xf bank_mask:0x5
  ds_read_b128 a[28:31], v5 offset:47104
  v_mfma_f32_16x16x32_bf16 v[240:243], a[48:51], v[44:47], v[240:243]
  v_cndmask_b32_dpp v17, v127, v126, vcc row_ror:4 row_mask:0xf bank_mask:0xf
  v_mov_b32_dpp v127, v126 row_ror:12 row_mask:0xf bank_mask:0x5
  v_mfma_f32_16x16x32_bf16 v[212:215], a[52:55], v[40:43], v[212:215]
  v_perm_b32 v32, v14, v113, s70
  v_perm_b32 v36, v14, v113, s71
  v_mfma_f32_16x16x32_bf16 v[244:247], a[52:55], v[44:47], v[244:247]
  v_perm_b32 v33, v15, v117, s70
  v_mfma_f32_16x16x32_bf16 v[216:219], a[56:59], v[40:43], v[216:219]
  v_perm_b32 v37, v15, v117, s71
  v_perm_b32 v34, v16, v121, s70
  v_mfma_f32_16x16x32_bf16 v[248:251], a[56:59], v[44:47], v[248:251]
  v_perm_b32 v38, v16, v121, s71
  v_perm_b32 v35, v17, v125, s70
  v_mfma_f32_16x16x32_bf16 v[220:223], a[60:63], v[40:43], v[220:223]
  v_perm_b32 v39, v17, v125, s71
  v_mfma_f32_16x16x32_bf16 v[252:255], a[60:63], v[44:47], v[252:255]
  v_mfma_f32_16x16x32_bf16 a[248:251], v[24:27], v[40:43], a[248:251]
  v_mfma_f32_16x16x32_bf16 a[252:255], v[24:27], v[44:47], a[252:255]
  s_waitcnt lgkmcnt(7)
  v_mfma_f32_16x16x32_bf16 v[128:131], a[0:3], v[32:35], v[128:131]
  v_perm_b32 v40, v115, v112, s70
  v_perm_b32 v44, v115, v112, s71
  s_add_u32 m0, s98, 98304
  v_mfma_f32_16x16x32_bf16 v[160:163], a[0:3], v[36:39], v[160:163]
  v_perm_b32 v41, v119, v116, s70
  v_perm_b32 v45, v119, v116, s71
  s_waitcnt lgkmcnt(6)
  v_mfma_f32_16x16x32_bf16 v[132:135], a[4:7], v[32:35], v[132:135]
  v_perm_b32 v42, v123, v120, s70
  v_perm_b32 v46, v123, v120, s71
  ds_read_b128 a[32:35], v6 offset:32768
  v_mfma_f32_16x16x32_bf16 v[164:167], a[4:7], v[36:39], v[164:167]
  v_perm_b32 v43, v127, v124, s70
  buffer_load_dwordx4 v9, s[28:31], s54 offen offset:0 lds
  s_waitcnt lgkmcnt(6)
  v_mfma_f32_16x16x32_bf16 v[136:139], a[8:11], v[32:35], v[136:139]
  v_perm_b32 v47, v127, v124, s71
  s_mov_b64 vcc, s[72:73]
  v_mfma_f32_16x16x32_bf16 v[168:171], a[8:11], v[36:39], v[168:171]
  s_waitcnt vmcnt(29)
  v_cndmask_b32_dpp v14, v50, v48, vcc row_ror:8 row_mask:0xf bank_mask:0xf
  v_mov_b32_dpp v50, v48 row_ror:8 row_mask:0xf bank_mask:0x3
  ds_read_b128 a[36:39], v6 offset:34816
  s_waitcnt lgkmcnt(6)
  v_mfma_f32_16x16x32_bf16 v[140:143], a[12:15], v[32:35], v[140:143]
  v_cndmask_b32_dpp v48, v51, v49, vcc row_ror:8 row_mask:0xf bank_mask:0xf
  v_mov_b32_dpp v51, v49 row_ror:8 row_mask:0xf bank_mask:0x3
  buffer_load_dwordx4 v10, s[28:31], s54 offen offset:1024 lds
  v_mfma_f32_16x16x32_bf16 v[172:175], a[12:15], v[36:39], v[172:175]
  s_waitcnt vmcnt(29)
  v_cndmask_b32_dpp v15, v54, v52, vcc row_ror:8 row_mask:0xf bank_mask:0xf
  s_waitcnt lgkmcnt(5)
  v_mfma_f32_16x16x32_bf16 v[144:147], a[16:19], v[32:35], v[144:147]
  v_mov_b32_dpp v54, v52 row_ror:8 row_mask:0xf bank_mask:0x3
  v_cndmask_b32_dpp v52, v55, v53, vcc row_ror:8 row_mask:0xf bank_mask:0xf
  ds_read_b128 a[40:43], v6 offset:36864
  v_mfma_f32_16x16x32_bf16 v[176:179], a[16:19], v[36:39], v[176:179]
  v_mov_b32_dpp v55, v53 row_ror:8 row_mask:0xf bank_mask:0x3
  s_mov_b64 vcc, s[74:75]
  buffer_load_dwordx4 v11, s[28:31], s54 offen offset:2048 lds
  s_waitcnt lgkmcnt(5)
  v_mfma_f32_16x16x32_bf16 v[148:151], a[20:23], v[32:35], v[148:151]
  v_cndmask_b32_dpp v49, v48, v14, vcc row_ror:4 row_mask:0xf bank_mask:0xf
  v_mov_b32_dpp v48, v14 row_ror:12 row_mask:0xf bank_mask:0x5
  v_mfma_f32_16x16x32_bf16 v[180:183], a[20:23], v[36:39], v[180:183]
  v_cndmask_b32_dpp v14, v51, v50, vcc row_ror:4 row_mask:0xf bank_mask:0xf
  ds_read_b128 a[44:47], v6 offset:38912
  s_waitcnt lgkmcnt(5)
  v_mfma_f32_16x16x32_bf16 v[152:155], a[24:27], v[32:35], v[152:155]
  v_mov_b32_dpp v51, v50 row_ror:12 row_mask:0xf bank_mask:0x5
  v_cndmask_b32_dpp v53, v52, v15, vcc row_ror:4 row_mask:0xf bank_mask:0xf
  buffer_load_dwordx4 v12, s[28:31], s54 offen offset:3072 lds
  v_mfma_f32_16x16x32_bf16 v[184:187], a[24:27], v[36:39], v[184:187]
  v_mov_b32_dpp v52, v15 row_ror:12 row_mask:0xf bank_mask:0x5
  v_cndmask_b32_dpp v15, v55, v54, vcc row_ror:4 row_mask:0xf bank_mask:0xf
  s_waitcnt lgkmcnt(4)
  v_mfma_f32_16x16x32_bf16 v[156:159], a[28:31], v[32:35], v[156:159]
  v_mov_b32_dpp v55, v54 row_ror:12 row_mask:0xf bank_mask:0x5
  v_mfma_f32_16x16x32_bf16 v[188:191], a[28:31], v[36:39], v[188:191]
  v_mfma_f32_16x16x32_bf16 a[240:243], v[24:27], v[32:35], a[240:243]
  v_mfma_f32_16x16x32_bf16 a[244:247], v[24:27], v[36:39], a[244:247]
  v_mfma_f32_16x16x32_bf16 v[192:195], a[0:3], v[40:43], v[192:195]
  s_mov_b64 vcc, s[72:73]
  s_waitcnt vmcnt(30)
  v_cndmask_b32_dpp v16, v58, v56, vcc row_ror:8 row_mask:0xf bank_mask:0xf
  buffer_load_dwordx4 v[112:115], v1, s[32:35], s65 offen
  v_mfma_f32_16x16x32_bf16 v[224:227], a[0:3], v[44:47], v[224:227]
  v_mov_b32_dpp v58, v56 row_ror:8 row_mask:0xf bank_mask:0x3
  v_cndmask_b32_dpp v56, v59, v57, vcc row_ror:8 row_mask:0xf bank_mask:0xf
  ds_read_b128 a[48:51], v6 offset:40960
  buffer_load_dwordx4 v[116:119], v2, s[32:35], s65 offen
  v_mfma_f32_16x16x32_bf16 v[196:199], a[4:7], v[40:43], v[196:199]
  v_mov_b32_dpp v59, v57 row_ror:8 row_mask:0xf bank_mask:0x3
  s_waitcnt vmcnt(31)
  v_cndmask_b32_dpp v17, v62, v60, vcc row_ror:8 row_mask:0xf bank_mask:0xf
  v_mfma_f32_16x16x32_bf16 v[228:231], a[4:7], v[44:47], v[228:231]
  v_mov_b32_dpp v62, v60 row_ror:8 row_mask:0xf bank_mask:0x3
  ds_read_b128 a[52:55], v6 offset:43008
  buffer_load_dwordx4 v[120:123], v3, s[32:35], s65 offen
  v_mfma_f32_16x16x32_bf16 v[200:203], a[8:11], v[40:43], v[200:203]
  v_cndmask_b32_dpp v60, v63, v61, vcc row_ror:8 row_mask:0xf bank_mask:0xf
  v_mov_b32_dpp v63, v61 row_ror:8 row_mask:0xf bank_mask:0x3
  v_mfma_f32_16x16x32_bf16 v[232:235], a[8:11], v[44:47], v[232:235]
  s_mov_b64 vcc, s[74:75]
  v_cndmask_b32_dpp v57, v56, v16, vcc row_ror:4 row_mask:0xf bank_mask:0xf
  buffer_load_dwordx4 v[124:127], v4, s[32:35], s65 offen
  v_mfma_f32_16x16x32_bf16 v[204:207], a[12:15], v[40:43], v[204:207]
  v_mov_b32_dpp v56, v16 row_ror:12 row_mask:0xf bank_mask:0x5
  v_cndmask_b32_dpp v16, v59, v58, vcc row_ror:4 row_mask:0xf bank_mask:0xf
  ds_read_b128 a[56:59], v6 offset:45056
  v_mfma_f32_16x16x32_bf16 v[236:239], a[12:15], v[44:47], v[236:239]
  v_mov_b32_dpp v59, v58 row_ror:12 row_mask:0xf bank_mask:0x5
  v_mfma_f32_16x16x32_bf16 v[208:211], a[16:19], v[40:43], v[208:211]
  v_cndmask_b32_dpp v61, v60, v17, vcc row_ror:4 row_mask:0xf bank_mask:0xf
  v_mov_b32_dpp v60, v17 row_ror:12 row_mask:0xf bank_mask:0x5
  ds_read_b128 a[60:63], v6 offset:47104
  v_mfma_f32_16x16x32_bf16 v[240:243], a[16:19], v[44:47], v[240:243]
  v_cndmask_b32_dpp v17, v63, v62, vcc row_ror:4 row_mask:0xf bank_mask:0xf
  v_mov_b32_dpp v63, v62 row_ror:12 row_mask:0xf bank_mask:0x5
  v_mfma_f32_16x16x32_bf16 v[212:215], a[20:23], v[40:43], v[212:215]
  v_perm_b32 v32, v14, v49, s70
  v_perm_b32 v36, v14, v49, s71
  v_mfma_f32_16x16x32_bf16 v[244:247], a[20:23], v[44:47], v[244:247]
  v_perm_b32 v33, v15, v53, s70
  v_mfma_f32_16x16x32_bf16 v[216:219], a[24:27], v[40:43], v[216:219]
  v_perm_b32 v37, v15, v53, s71
  v_perm_b32 v34, v16, v57, s70
  s_waitcnt vmcnt(24)
  v_cmp_ne_u32 s[76:77], 0, v18
  s_mov_b32 s78, 0
  s_and_b64 s[76:77], s[76:77], s[26:27]
  s_cmp_eq_u64 s[76:77], s[26:27]
  s_cbranch_scc0 k1kvn_slow
k1kvn_ok:
  v_readfirstlane_b32 s6, v18
  v_readfirstlane_b32 s7, v19
  v_mov_b32 v31, 114688
  s_mov_b64 exec, s[26:27]
  ds_write_b64 v31, v[18:19]
  s_mov_b64 exec, -1
  v_mfma_f32_16x16x32_bf16 v[248:251], a[24:27], v[44:47], v[248:251]
  v_perm_b32 v38, v16, v57, s71
  v_perm_b32 v35, v17, v61, s70
  v_mfma_f32_16x16x32_bf16 v[220:223], a[28:31], v[40:43], v[220:223]
  v_perm_b32 v39, v17, v61, s71
  v_mfma_f32_16x16x32_bf16 v[252:255], a[28:31], v[44:47], v[252:255]
  v_mfma_f32_16x16x32_bf16 a[248:251], v[24:27], v[40:43], a[248:251]
  v_mfma_f32_16x16x32_bf16 a[252:255], v[24:27], v[44:47], a[252:255]
  s_waitcnt lgkmcnt(8)
  v_mfma_f32_16x16x32_bf16 v[128:131], a[32:35], v[32:35], v[128:131]
  v_perm_b32 v40, v51, v48, s70
  v_perm_b32 v44, v51, v48, s71
  v_mfma_f32_16x16x32_bf16 v[160:163], a[32:35], v[36:39], v[160:163]
  v_perm_b32 v41, v55, v52, s70
  v_perm_b32 v45, v55, v52, s71
  s_waitcnt lgkmcnt(7)
  v_mfma_f32_16x16x32_bf16 v[132:135], a[36:39], v[32:35], v[132:135]
  v_perm_b32 v42, v59, v56, s70
  v_perm_b32 v46, v59, v56, s71
  s_barrier
  v_mfma_f32_16x16x32_bf16 v[164:167], a[36:39], v[36:39], v[164:167]
  v_perm_b32 v43, v63, v60, s70
  s_waitcnt lgkmcnt(6)
  v_mfma_f32_16x16x32_bf16 v[136:139], a[40:43], v[32:35], v[136:139]
  v_perm_b32 v47, v63, v60, s71
  s_mov_b64 vcc, s[72:73]
  ds_read_b128 a[0:3], v5 offset:49152
  v_mfma_f32_16x16x32_bf16 v[168:171], a[40:43], v[36:39], v[168:171]
  v_cndmask_b32_dpp v14, v66, v64, vcc row_ror:8 row_mask:0xf bank_mask:0xf
  v_mov_b32_dpp v66, v64 row_ror:8 row_mask:0xf bank_mask:0x3
  s_waitcnt lgkmcnt(6)
  v_mfma_f32_16x16x32_bf16 v[140:143], a[44:47], v[32:35], v[140:143]
  v_cndmask_b32_dpp v64, v67, v65, vcc row_ror:8 row_mask:0xf bank_mask:0xf
  v_mov_b32_dpp v67, v65 row_ror:8 row_mask:0xf bank_mask:0x3
  ds_read_b128 a[4:7], v5 offset:51200
  v_mfma_f32_16x16x32_bf16 v[172:175], a[44:47], v[36:39], v[172:175]
  v_cndmask_b32_dpp v15, v70, v68, vcc row_ror:8 row_mask:0xf bank_mask:0xf
  s_waitcnt lgkmcnt(6)
  v_mfma_f32_16x16x32_bf16 v[144:147], a[48:51], v[32:35], v[144:147]
  v_mov_b32_dpp v70, v68 row_ror:8 row_mask:0xf bank_mask:0x3
  v_cndmask_b32_dpp v68, v71, v69, vcc row_ror:8 row_mask:0xf bank_mask:0xf
  v_mfma_f32_16x16x32_bf16 v[176:179], a[48:51], v[36:39], v[176:179]
  v_mov_b32_dpp v71, v69 row_ror:8 row_mask:0xf bank_mask:0x3
  s_mov_b64 vcc, s[74:75]
  ds_read_b128 a[8:11], v5 offset:53248
  s_waitcnt lgkmcnt(6)
  v_mfma_f32_16x16x32_bf16 v[148:151], a[52:55], v[32:35], v[148:151]
  v_cndmask_b32_dpp v65, v64, v14, vcc row_ror:4 row_mask:0xf bank_mask:0xf
  v_mov_b32_dpp v64, v14 row_ror:12 row_mask:0xf bank_mask:0x5
  v_mfma_f32_16x16x32_bf16 v[180:183], a[52:55], v[36:39], v[180:183]
  v_cndmask_b32_dpp v14, v67, v66, vcc row_ror:4 row_mask:0xf bank_mask:0xf
  ds_read_b128 a[12:15], v5 offset:55296
  s_waitcnt lgkmcnt(6)
  v_mfma_f32_16x16x32_bf16 v[152:155], a[56:59], v[32:35], v[152:155]
  v_mov_b32_dpp v67, v66 row_ror:12 row_mask:0xf bank_mask:0x5
  v_cndmask_b32_dpp v69, v68, v15, vcc row_ror:4 row_mask:0xf bank_mask:0xf
  v_mfma_f32_16x16x32_bf16 v[184:187], a[56:59], v[36:39], v[184:187]
  v_mov_b32_dpp v68, v15 row_ror:12 row_mask:0xf bank_mask:0x5
  v_cndmask_b32_dpp v15, v71, v70, vcc row_ror:4 row_mask:0xf bank_mask:0xf
  s_waitcnt lgkmcnt(5)
  v_mfma_f32_16x16x32_bf16 v[156:159], a[60:63], v[32:35], v[156:159]
  v_mov_b32_dpp v71, v70 row_ror:12 row_mask:0xf bank_mask:0x5
  v_mfma_f32_16x16x32_bf16 v[188:191], a[60:63], v[36:39], v[188:191]
  v_mfma_f32_16x16x32_bf16 a[240:243], v[24:27], v[32:35], a[240:243]
  v_mfma_f32_16x16x32_bf16 a[244:247], v[24:27], v[36:39], a[244:247]
  v_mfma_f32_16x16x32_bf16 v[192:195], a[32:35], v[40:43], v[192:195]
  v_lshlrev_b32 v30, 3, v0
  s_mov_b64 exec, s[26:27]
  buffer_load_dwordx2 v[20:21], v30, s[36:39], s55 offen sc1
  s_mov_b64 exec, -1
  s_mov_b64 vcc, s[72:73]
  v_cndmask_b32_dpp v16, v74, v72, vcc row_ror:8 row_mask:0xf bank_mask:0xf
  buffer_load_dwordx4 v[48:51], v1, s[32:35], s66 offen
  v_mfma_f32_16x16x32_bf16 v[224:227], a[32:35], v[44:47], v[224:227]
  v_mov_b32_dpp v74, v72 row_ror:8 row_mask:0xf bank_mask:0x3
  v_cndmask_b32_dpp v72, v75, v73, vcc row_ror:8 row_mask:0xf bank_mask:0xf
  ds_read_b128 a[16:19], v5 offset:57344
  buffer_load_dwordx4 v[52:55], v2, s[32:35], s66 offen
  v_mfma_f32_16x16x32_bf16 v[196:199], a[36:39], v[40:43], v[196:199]
  v_mov_b32_dpp v75, v73 row_ror:8 row_mask:0xf bank_mask:0x3
  v_cndmask_b32_dpp v17, v78, v76, vcc row_ror:8 row_mask:0xf bank_mask:0xf
  v_mfma_f32_16x16x32_bf16 v[228:231], a[36:39], v[44:47], v[228:231]
  v_mov_b32_dpp v78, v76 row_ror:8 row_mask:0xf bank_mask:0x3
  ds_read_b128 a[20:23], v5 offset:59392
  buffer_load_dwordx4 v[56:59], v3, s[32:35], s66 offen
  v_mfma_f32_16x16x32_bf16 v[200:203], a[40:43], v[40:43], v[200:203]
  v_cndmask_b32_dpp v76, v79, v77, vcc row_ror:8 row_mask:0xf bank_mask:0xf
  v_mov_b32_dpp v79, v77 row_ror:8 row_mask:0xf bank_mask:0x3
  v_mfma_f32_16x16x32_bf16 v[232:235], a[40:43], v[44:47], v[232:235]
  s_mov_b64 vcc, s[74:75]
  v_cndmask_b32_dpp v73, v72, v16, vcc row_ror:4 row_mask:0xf bank_mask:0xf
  buffer_load_dwordx4 v[60:63], v4, s[32:35], s66 offen
  v_mfma_f32_16x16x32_bf16 v[204:207], a[44:47], v[40:43], v[204:207]
  v_mov_b32_dpp v72, v16 row_ror:12 row_mask:0xf bank_mask:0x5
  v_cndmask_b32_dpp v16, v75, v74, vcc row_ror:4 row_mask:0xf bank_mask:0xf
  ds_read_b128 a[24:27], v5 offset:61440
  v_mfma_f32_16x16x32_bf16 v[236:239], a[44:47], v[44:47], v[236:239]
  v_mov_b32_dpp v75, v74 row_ror:12 row_mask:0xf bank_mask:0x5
  v_mfma_f32_16x16x32_bf16 v[208:211], a[48:51], v[40:43], v[208:211]
  v_cndmask_b32_dpp v77, v76, v17, vcc row_ror:4 row_mask:0xf bank_mask:0xf
  v_mov_b32_dpp v76, v17 row_ror:12 row_mask:0xf bank_mask:0x5
  ds_read_b128 a[28:31], v5 offset:63488
  v_mfma_f32_16x16x32_bf16 v[240:243], a[48:51], v[44:47], v[240:243]
  v_cndmask_b32_dpp v17, v79, v78, vcc row_ror:4 row_mask:0xf bank_mask:0xf
  v_mov_b32_dpp v79, v78 row_ror:12 row_mask:0xf bank_mask:0x5
  v_mfma_f32_16x16x32_bf16 v[212:215], a[52:55], v[40:43], v[212:215]
  v_perm_b32 v32, v14, v65, s70
  v_perm_b32 v36, v14, v65, s71
  v_mfma_f32_16x16x32_bf16 v[244:247], a[52:55], v[44:47], v[244:247]
  v_perm_b32 v33, v15, v69, s70
  v_mfma_f32_16x16x32_bf16 v[216:219], a[56:59], v[40:43], v[216:219]
  v_perm_b32 v37, v15, v69, s71
  v_perm_b32 v34, v16, v73, s70
  v_mfma_f32_16x16x32_bf16 v[248:251], a[56:59], v[44:47], v[248:251]
  v_perm_b32 v38, v16, v73, s71
  v_perm_b32 v35, v17, v77, s70
  v_mfma_f32_16x16x32_bf16 v[220:223], a[60:63], v[40:43], v[220:223]
  v_perm_b32 v39, v17, v77, s71
  v_mfma_f32_16x16x32_bf16 v[252:255], a[60:63], v[44:47], v[252:255]
  v_mfma_f32_16x16x32_bf16 a[248:251], v[24:27], v[40:43], a[248:251]
  v_mfma_f32_16x16x32_bf16 a[252:255], v[24:27], v[44:47], a[252:255]
  s_waitcnt lgkmcnt(7)
  v_mfma_f32_16x16x32_bf16 v[128:131], a[0:3], v[32:35], v[128:131]
  v_perm_b32 v40, v67, v64, s70
  v_perm_b32 v44, v67, v64, s71
  v_mfma_f32_16x16x32_bf16 v[160:163], a[0:3], v[36:39], v[160:163]
  v_perm_b32 v41, v71, v68, s70
  v_perm_b32 v45, v71, v68, s71
  s_waitcnt lgkmcnt(6)
  v_mfma_f32_16x16x32_bf16 v[132:135], a[4:7], v[32:35], v[132:135]
  v_perm_b32 v42, v75, v72, s70
  v_perm_b32 v46, v75, v72, s71
  ds_read_b128 a[32:35], v6 offset:49152
  v_mfma_f32_16x16x32_bf16 v[164:167], a[4:7], v[36:39], v[164:167]
  v_perm_b32 v43, v79, v76, s70
  s_waitcnt lgkmcnt(6)
  v_mfma_f32_16x16x32_bf16 v[136:139], a[8:11], v[32:35], v[136:139]
  v_perm_b32 v47, v79, v76, s71
  s_mov_b64 vcc, s[72:73]
  v_mfma_f32_16x16x32_bf16 v[168:171], a[8:11], v[36:39], v[168:171]
  s_waitcnt vmcnt(24)
  v_cndmask_b32_dpp v14, v82, v80, vcc row_ror:8 row_mask:0xf bank_mask:0xf
  v_mov_b32_dpp v82, v80 row_ror:8 row_mask:0xf bank_mask:0x3
  ds_read_b128 a[36:39], v6 offset:51200
  s_waitcnt lgkmcnt(6)
  v_mfma_f32_16x16x32_bf16 v[140:143], a[12:15], v[32:35], v[140:143]
  v_cndmask_b32_dpp v80, v83, v81, vcc row_ror:8 row_mask:0xf bank_mask:0xf
  v_mov_b32_dpp v83, v81 row_ror:8 row_mask:0xf bank_mask:0x3
  v_mfma_f32_16x16x32_bf16 v[172:175], a[12:15], v[36:39], v[172:175]
  s_waitcnt vmcnt(23)
  v_cndmask_b32_dpp v15, v86, v84, vcc row_ror:8 row_mask:0xf bank_mask:0xf
  s_waitcnt lgkmcnt(5)
  v_mfma_f32_16x16x32_bf16 v[144:147], a[16:19], v[32:35], v[144:147]
  v_mov_b32_dpp v86, v84 row_ror:8 row_mask:0xf bank_mask:0x3
  v_cndmask_b32_dpp v84, v87, v85, vcc row_ror:8 row_mask:0xf bank_mask:0xf
  ds_read_b128 a[40:43], v6 offset:53248
  v_mfma_f32_16x16x32_bf16 v[176:179], a[16:19], v[36:39], v[176:179]
  v_mov_b32_dpp v87, v85 row_ror:8 row_mask:0xf bank_mask:0x3
  s_mov_b64 vcc, s[74:75]
  s_waitcnt lgkmcnt(5)
  v_mfma_f32_16x16x32_bf16 v[148:151], a[20:23], v[32:35], v[148:151]
  v_cndmask_b32_dpp v81, v80, v14, vcc row_ror:4 row_mask:0xf bank_mask:0xf
  v_mov_b32_dpp v80, v14 row_ror:12 row_mask:0xf bank_mask:0x5
  v_mfma_f32_16x16x32_bf16 v[180:183], a[20:23], v[36:39], v[180:183]
  v_cndmask_b32_dpp v14, v83, v82, vcc row_ror:4 row_mask:0xf bank_mask:0xf
  ds_read_b128 a[44:47], v6 offset:55296
  s_waitcnt lgkmcnt(5)
  v_mfma_f32_16x16x32_bf16 v[152:155], a[24:27], v[32:35], v[152:155]
  v_mov_b32_dpp v83, v82 row_ror:12 row_mask:0xf bank_mask:0x5
  v_cndmask_b32_dpp v85, v84, v15, vcc row_ror:4 row_mask:0xf bank_mask:0xf
  v_mfma_f32_16x16x32_bf16 v[184:187], a[24:27], v[36:39], v[184:187]
  v_mov_b32_dpp v84, v15 row_ror:12 row_mask:0xf bank_mask:0x5
  v_cndmask_b32_dpp v15, v87, v86, vcc row_ror:4 row_mask:0xf bank_mask:0xf
  s_waitcnt lgkmcnt(4)
  v_mfma_f32_16x16x32_bf16 v[156:159], a[28:31], v[32:35], v[156:159]
  v_mov_b32_dpp v87, v86 row_ror:12 row_mask:0xf bank_mask:0x5
  v_mfma_f32_16x16x32_bf16 v[188:191], a[28:31], v[36:39], v[188:191]
  v_mfma_f32_16x16x32_bf16 a[240:243], v[24:27], v[32:35], a[240:243]
  v_mfma_f32_16x16x32_bf16 a[244:247], v[24:27], v[36:39], a[244:247]
  v_mfma_f32_16x16x32_bf16 v[192:195], a[0:3], v[40:43], v[192:195]
  s_mov_b64 vcc, s[72:73]
  s_waitcnt vmcnt(22)
  v_cndmask_b32_dpp v16, v90, v88, vcc row_ror:8 row_mask:0xf bank_mask:0xf
  buffer_load_dwordx4 v[64:67], v1, s[32:35], s67 offen
  v_mfma_f32_16x16x32_bf16 v[224:227], a[0:3], v[44:47], v[224:227]
  v_mov_b32_dpp v90, v88 row_ror:8 row_mask:0xf bank_mask:0x3
  v_cndmask_b32_dpp v88, v91, v89, vcc row_ror:8 row_mask:0xf bank_mask:0xf
  ds_read_b128 a[48:51], v6 offset:57344
  buffer_load_dwordx4 v[68:71], v2, s[32:35], s67 offen
  v_mfma_f32_16x16x32_bf16 v[196:199], a[4:7], v[40:43], v[196:199]
  v_mov_b32_dpp v91, v89 row_ror:8 row_mask:0xf bank_mask:0x3
  s_waitcnt vmcnt(23)
  v_cndmask_b32_dpp v17, v94, v92, vcc row_ror:8 row_mask:0xf bank_mask:0xf
  v_mfma_f32_16x16x32_bf16 v[228:231], a[4:7], v[44:47], v[228:231]
  v_mov_b32_dpp v94, v92 row_ror:8 row_mask:0xf bank_mask:0x3
  ds_read_b128 a[52:55], v6 offset:59392
  buffer_load_dwordx4 v[72:75], v3, s[32:35], s67 offen
  v_mfma_f32_16x16x32_bf16 v[200:203], a[8:11], v[40:43], v[200:203]
  v_cndmask_b32_dpp v92, v95, v93, vcc row_ror:8 row_mask:0xf bank_mask:0xf
  v_mov_b32_dpp v95, v93 row_ror:8 row_mask:0xf bank_mask:0x3
  v_mfma_f32_16x16x32_bf16 v[232:235], a[8:11], v[44:47], v[232:235]
  s_mov_b64 vcc, s[74:75]
  v_cndmask_b32_dpp v89, v88, v16, vcc row_ror:4 row_mask:0xf bank_mask:0xf
  buffer_load_dwordx4 v[76:79], v4, s[32:35], s67 offen
  v_mfma_f32_16x16x32_bf16 v[204:207], a[12:15], v[40:43], v[204:207]
  v_mov_b32_dpp v88, v16 row_ror:12 row_mask:0xf bank_mask:0x5
  v_cndmask_b32_dpp v16, v91, v90, vcc row_ror:4 row_mask:0xf bank_mask:0xf
  ds_read_b128 a[56:59], v6 offset:61440
  v_mfma_f32_16x16x32_bf16 v[236:239], a[12:15], v[44:47], v[236:239]
  v_mov_b32_dpp v91, v90 row_ror:12 row_mask:0xf bank_mask:0x5
  v_mfma_f32_16x16x32_bf16 v[208:211], a[16:19], v[40:43], v[208:211]
  v_cndmask_b32_dpp v93, v92, v17, vcc row_ror:4 row_mask:0xf bank_mask:0xf
  v_mov_b32_dpp v92, v17 row_ror:12 row_mask:0xf bank_mask:0x5
  ds_read_b128 a[60:63], v6 offset:63488
  v_mfma_f32_16x16x32_bf16 v[240:243], a[16:19], v[44:47], v[240:243]
  v_cndmask_b32_dpp v17, v95, v94, vcc row_ror:4 row_mask:0xf bank_mask:0xf
  v_mov_b32_dpp v95, v94 row_ror:12 row_mask:0xf bank_mask:0x5
  v_mfma_f32_16x16x32_bf16 v[212:215], a[20:23], v[40:43], v[212:215]
  v_perm_b32 v32, v14, v81, s70
  v_perm_b32 v36, v14, v81, s71
  v_mfma_f32_16x16x32_bf16 v[244:247], a[20:23], v[44:47], v[244:247]
  v_perm_b32 v33, v15, v85, s70
  v_mfma_f32_16x16x32_bf16 v[216:219], a[24:27], v[40:43], v[216:219]
  v_perm_b32 v37, v15, v85, s71
  v_perm_b32 v34, v16, v89, s70
  v_mfma_f32_16x16x32_bf16 v[248:251], a[24:27], v[44:47], v[248:251]
  v_perm_b32 v38, v16, v89, s71
  v_perm_b32 v35, v17, v93, s70
  v_mfma_f32_16x16x32_bf16 v[220:223], a[28:31], v[40:43], v[220:223]
  v_perm_b32 v39, v17, v93, s71
  v_mfma_f32_16x16x32_bf16 v[252:255], a[28:31], v[44:47], v[252:255]
  v_mfma_f32_16x16x32_bf16 a[248:251], v[24:27], v[40:43], a[248:251]
  v_mfma_f32_16x16x32_bf16 a[252:255], v[24:27], v[44:47], a[252:255]
  s_waitcnt lgkmcnt(7)
  v_mfma_f32_16x16x32_bf16 v[128:131], a[32:35], v[32:35], v[128:131]
  v_perm_b32 v40, v83, v80, s70
  v_perm_b32 v44, v83, v80, s71
  v_mfma_f32_16x16x32_bf16 v[160:163], a[32:35], v[36:39], v[160:163]
  v_perm_b32 v41, v87, v84, s70
  v_perm_b32 v45, v87, v84, s71
  s_waitcnt lgkmcnt(6)
  v_mfma_f32_16x16x32_bf16 v[132:135], a[36:39], v[32:35], v[132:135]
  v_perm_b32 v42, v91, v88, s70
  v_perm_b32 v46, v91, v88, s71
  v_mfma_f32_16x16x32_bf16 v[164:167], a[36:39], v[36:39], v[164:167]
  v_perm_b32 v43, v95, v92, s70
  s_waitcnt vmcnt(8)
  v_cmp_eq_u64 s[76:77], s[6:7], v[20:21]
  s_mov_b32 s78, 0
  s_and_b64 s[76:77], s[76:77], s[26:27]
  s_cmp_eq_u64 s[76:77], s[26:27]
  s_cbranch_scc0 k1kv_slow
k1kv_ok:
  s_waitcnt lgkmcnt(5)
  v_mfma_f32_16x16x32_bf16 v[136:139], a[40:43], v[32:35], v[136:139]
  v_perm_b32 v47, v95, v92, s71
  s_mov_b64 vcc, s[72:73]
  v_mfma_f32_16x16x32_bf16 v[168:171], a[40:43], v[36:39], v[168:171]
  v_cndmask_b32_dpp v14, v98, v96, vcc row_ror:8 row_mask:0xf bank_mask:0xf
  v_mov_b32_dpp v98, v96 row_ror:8 row_mask:0xf bank_mask:0x3
  s_barrier
  s_waitcnt lgkmcnt(4)
  v_mfma_f32_16x16x32_bf16 v[140:143], a[44:47], v[32:35], v[140:143]
  v_cndmask_b32_dpp v96, v99, v97, vcc row_ror:8 row_mask:0xf bank_mask:0xf
  v_mov_b32_dpp v99, v97 row_ror:8 row_mask:0xf bank_mask:0x3
  v_mfma_f32_16x16x32_bf16 v[172:175], a[44:47], v[36:39], v[172:175]
  v_cndmask_b32_dpp v15, v102, v100, vcc row_ror:8 row_mask:0xf bank_mask:0xf
  s_waitcnt lgkmcnt(3)
  v_mfma_f32_16x16x32_bf16 v[144:147], a[48:51], v[32:35], v[144:147]
  v_mov_b32_dpp v102, v100 row_ror:8 row_mask:0xf bank_mask:0x3
  v_cndmask_b32_dpp v100, v103, v101, vcc row_ror:8 row_mask:0xf bank_mask:0xf
  ds_read_b128 a[0:3], v7 offset:0
  v_mfma_f32_16x16x32_bf16 v[176:179], a[48:51], v[36:39], v[176:179]
  v_mov_b32_dpp v103, v101 row_ror:8 row_mask:0xf bank_mask:0x3
  s_mov_b64 vcc, s[74:75]
  ds_read_b128 a[4:7], v7 offset:2048
  s_waitcnt lgkmcnt(4)
  v_mfma_f32_16x16x32_bf16 v[148:151], a[52:55], v[32:35], v[148:151]
  v_cndmask_b32_dpp v97, v96, v14, vcc row_ror:4 row_mask:0xf bank_mask:0xf
  v_mov_b32_dpp v96, v14 row_ror:12 row_mask:0xf bank_mask:0x5
  v_mfma_f32_16x16x32_bf16 v[180:183], a[52:55], v[36:39], v[180:183]
  v_cndmask_b32_dpp v14, v99, v98, vcc row_ror:4 row_mask:0xf bank_mask:0xf
  ds_read_b128 a[8:11], v7 offset:4096
  s_waitcnt lgkmcnt(4)
  v_mfma_f32_16x16x32_bf16 v[152:155], a[56:59], v[32:35], v[152:155]
  v_mov_b32_dpp v99, v98 row_ror:12 row_mask:0xf bank_mask:0x5
  v_cndmask_b32_dpp v101, v100, v15, vcc row_ror:4 row_mask:0xf bank_mask:0xf
  ds_read_b128 a[12:15], v7 offset:6144
  v_mfma_f32_16x16x32_bf16 v[184:187], a[56:59], v[36:39], v[184:187]
  v_mov_b32_dpp v100, v15 row_ror:12 row_mask:0xf bank_mask:0x5
  v_cndmask_b32_dpp v15, v103, v102, vcc row_ror:4 row_mask:0xf bank_mask:0xf
  s_waitcnt lgkmcnt(4)
  v_mfma_f32_16x16x32_bf16 v[156:159], a[60:63], v[32:35], v[156:159]
  v_mov_b32_dpp v103, v102 row_ror:12 row_mask:0xf bank_mask:0x5
  v_mfma_f32_16x16x32_bf16 v[188:191], a[60:63], v[36:39], v[188:191]
  v_mfma_f32_16x16x32_bf16 a[240:243], v[24:27], v[32:35], a[240:243]
  v_mfma_f32_16x16x32_bf16 a[244:247], v[24:27], v[36:39], a[244:247]
  v_mfma_f32_16x16x32_bf16 v[192:195], a[32:35], v[40:43], v[192:195]
  s_mov_b64 vcc, s[72:73]
  v_cndmask_b32_dpp v16, v106, v104, vcc row_ror:8 row_mask:0xf bank_mask:0xf
  buffer_load_dwordx4 v[80:83], v1, s[32:35], s68 offen
  buffer_load_dwordx4 a[64:67], v13, s[36:39], s99 offen offset:0 sc1
  v_mfma_f32_16x16x32_bf16 v[224:227], a[32:35], v[44:47], v[224:227]
  v_mov_b32_dpp v106, v104 row_ror:8 row_mask:0xf bank_mask:0x3
  v_cndmask_b32_dpp v104, v107, v105, vcc row_ror:8 row_mask:0xf bank_mask:0xf
  ds_read_b128 a[16:19], v7 offset:8192
  buffer_load_dwordx4 v[84:87], v2, s[32:35], s68 offen
  v_mfma_f32_16x16x32_bf16 v[196:199], a[36:39], v[40:43], v[196:199]
  v_mov_b32_dpp v107, v105 row_ror:8 row_mask:0xf bank_mask:0x3
  v_cndmask_b32_dpp v17, v110, v108, vcc row_ror:8 row_mask:0xf bank_mask:0xf
  v_mfma_f32_16x16x32_bf16 v[228:231], a[36:39], v[44:47], v[228:231]
  v_mov_b32_dpp v110, v108 row_ror:8 row_mask:0xf bank_mask:0x3
  ds_read_b128 a[20:23], v7 offset:10240
  buffer_load_dwordx4 v[88:91], v3, s[32:35], s68 offen
  buffer_load_dwordx4 a[68:71], v13, s[36:39], s99 offen offset:1024 sc1
  v_mfma_f32_16x16x32_bf16 v[200:203], a[40:43], v[40:43], v[200:203]
  v_cndmask_b32_dpp v108, v111, v109, vcc row_ror:8 row_mask:0xf bank_mask:0xf
  v_mov_b32_dpp v111, v109 row_ror:8 row_mask:0xf bank_mask:0x3
  v_mfma_f32_16x16x32_bf16 v[232:235], a[40:43], v[44:47], v[232:235]
  s_mov_b64 vcc, s[74:75]
  v_cndmask_b32_dpp v105, v104, v16, vcc row_ror:4 row_mask:0xf bank_mask:0xf
  buffer_load_dwordx4 v[92:95], v4, s[32:35], s68 offen
  v_mfma_f32_16x16x32_bf16 v[204:207], a[44:47], v[40:43], v[204:207]
  v_mov_b32_dpp v104, v16 row_ror:12 row_mask:0xf bank_mask:0x5
  v_cndmask_b32_dpp v16, v107, v106, vcc row_ror:4 row_mask:0xf bank_mask:0xf
  ds_read_b128 a[24:27], v7 offset:12288
  buffer_load_dwordx4 a[72:75], v13, s[36:39], s99 offen offset:2048 sc1
  v_mfma_f32_16x16x32_bf16 v[236:239], a[44:47], v[44:47], v[236:239]
  v_mov_b32_dpp v107, v106 row_ror:12 row_mask:0xf bank_mask:0x5
  v_mfma_f32_16x16x32_bf16 v[208:211], a[48:51], v[40:43], v[208:211]
  v_cndmask_b32_dpp v109, v108, v17, vcc row_ror:4 row_mask:0xf bank_mask:0xf
  v_mov_b32_dpp v108, v17 row_ror:12 row_mask:0xf bank_mask:0x5
  ds_read_b128 a[28:31], v7 offset:14336
  v_mfma_f32_16x16x32_bf16 v[240:243], a[48:51], v[44:47], v[240:243]
  v_cndmask_b32_dpp v17, v111, v110, vcc row_ror:4 row_mask:0xf bank_mask:0xf
  v_mov_b32_dpp v111, v110 row_ror:12 row_mask:0xf bank_mask:0x5
  buffer_load_dwordx4 a[76:79], v13, s[36:39], s99 offen offset:3072 sc1
  v_mfma_f32_16x16x32_bf16 v[212:215], a[52:55], v[40:43], v[212:215]
  v_perm_b32 v32, v14, v97, s70
  v_perm_b32 v36, v14, v97, s71
  v_mfma_f32_16x16x32_bf16 v[244:247], a[52:55], v[44:47], v[244:247]
  v_perm_b32 v33, v15, v101, s70
  v_mfma_f32_16x16x32_bf16 v[216:219], a[56:59], v[40:43], v[216:219]
  v_perm_b32 v37, v15, v101, s71
  v_perm_b32 v34, v16, v105, s70
  s_add_u32 s99, s99, 4096
  v_mfma_f32_16x16x32_bf16 v[248:251], a[56:59], v[44:47], v[248:251]
  v_perm_b32 v38, v16, v105, s71
  v_perm_b32 v35, v17, v109, s70
  v_mfma_f32_16x16x32_bf16 v[220:223], a[60:63], v[40:43], v[220:223]
  v_perm_b32 v39, v17, v109, s71
  v_mfma_f32_16x16x32_bf16 v[252:255], a[60:63], v[44:47], v[252:255]
  v_mfma_f32_16x16x32_bf16 a[248:251], v[24:27], v[40:43], a[248:251]
  v_mfma_f32_16x16x32_bf16 a[252:255], v[24:27], v[44:47], a[252:255]
  s_waitcnt lgkmcnt(7)
  v_mfma_f32_16x16x32_bf16 v[128:131], a[0:3], v[32:35], v[128:131]
  v_perm_b32 v40, v99, v96, s70
  v_perm_b32 v44, v99, v96, s71
  buffer_load_dwordx4 a[80:83], v13, s[36:39], s99 offen offset:0 sc1
  v_mfma_f32_16x16x32_bf16 v[160:163], a[0:3], v[36:39], v[160:163]
  v_perm_b32 v41, v103, v100, s70
  v_perm_b32 v45, v103, v100, s71
  s_waitcnt lgkmcnt(6)
  v_mfma_f32_16x16x32_bf16 v[132:135], a[4:7], v[32:35], v[132:135]
  v_perm_b32 v42, v107, v104, s70
  v_perm_b32 v46, v107, v104, s71
  ds_read_b128 a[32:35], v8 offset:0
  v_mfma_f32_16x16x32_bf16 v[164:167], a[4:7], v[36:39], v[164:167]
  v_perm_b32 v43, v111, v108, s70
  buffer_load_dwordx4 a[84:87], v13, s[36:39], s99 offen offset:1024 sc1
  s_waitcnt lgkmcnt(6)
  v_mfma_f32_16x16x32_bf16 v[136:139], a[8:11], v[32:35], v[136:139]
  v_perm_b32 v47, v111, v108, s71
  s_mov_b64 vcc, s[72:73]
  v_mfma_f32_16x16x32_bf16 v[168:171], a[8:11], v[36:39], v[168:171]
  v_cndmask_b32_dpp v14, v114, v112, vcc row_ror:8 row_mask:0xf bank_mask:0xf
  v_mov_b32_dpp v114, v112 row_ror:8 row_mask:0xf bank_mask:0x3
  ds_read_b128 a[36:39], v8 offset:2048
  s_waitcnt lgkmcnt(6)
  v_mfma_f32_16x16x32_bf16 v[140:143], a[12:15], v[32:35], v[140:143]
  v_cndmask_b32_dpp v112, v115, v113, vcc row_ror:8 row_mask:0xf bank_mask:0xf
  v_mov_b32_dpp v115, v113 row_ror:8 row_mask:0xf bank_mask:0x3
  buffer_load_dwordx4 a[88:91], v13, s[36:39], s99 offen offset:2048 sc1
  v_mfma_f32_16x16x32_bf16 v[172:175], a[12:15], v[36:39], v[172:175]
  v_cndmask_b32_dpp v15, v118, v116, vcc row_ror:8 row_mask:0xf bank_mask:0xf
  s_waitcnt lgkmcnt(5)
  v_mfma_f32_16x16x32_bf16 v[144:147], a[16:19], v[32:35], v[144:147]
  v_mov_b32_dpp v118, v116 row_ror:8 row_mask:0xf bank_mask:0x3
  v_cndmask_b32_dpp v116, v119, v117, vcc row_ror:8 row_mask:0xf bank_mask:0xf
  ds_read_b128 a[40:43], v8 offset:4096
  v_mfma_f32_16x16x32_bf16 v[176:179], a[16:19], v[36:39], v[176:179]
  v_mov_b32_dpp v119, v117 row_ror:8 row_mask:0xf bank_mask:0x3
  s_mov_b64 vcc, s[74:75]
  buffer_load_dwordx4 a[92:95], v13, s[36:39], s99 offen offset:3072 sc1
  s_waitcnt lgkmcnt(5)
  v_mfma_f32_16x16x32_bf16 v[148:151], a[20:23], v[32:35], v[148:151]
  v_cndmask_b32_dpp v113, v112, v14, vcc row_ror:4 row_mask:0xf bank_mask:0xf
  v_mov_b32_dpp v112, v14 row_ror:12 row_mask:0xf bank_mask:0x5
  v_mfma_f32_16x16x32_bf16 v[180:183], a[20:23], v[36:39], v[180:183]
  v_cndmask_b32_dpp v14, v115, v114, vcc row_ror:4 row_mask:0xf bank_mask:0xf
  ds_read_b128 a[44:47], v8 offset:6144
  s_waitcnt lgkmcnt(5)
  v_mfma_f32_16x16x32_bf16 v[152:155], a[24:27], v[32:35], v[152:155]
  v_mov_b32_dpp v115, v114 row_ror:12 row_mask:0xf bank_mask:0x5
  v_cndmask_b32_dpp v117, v116, v15, vcc row_ror:4 row_mask:0xf bank_mask:0xf
  s_add_u32 s99, s99, 4096
  v_mfma_f32_16x16x32_bf16 v[184:187], a[24:27], v[36:39], v[184:187]
  v_mov_b32_dpp v116, v15 row_ror:12 row_mask:0xf bank_mask:0x5
  v_cndmask_b32_dpp v15, v119, v118, vcc row_ror:4 row_mask:0xf bank_mask:0xf
  s_waitcnt lgkmcnt(4)
  v_mfma_f32_16x16x32_bf16 v[156:159], a[28:31], v[32:35], v[156:159]
  v_mov_b32_dpp v119, v118 row_ror:12 row_mask:0xf bank_mask:0x5
  v_mfma_f32_16x16x32_bf16 v[188:191], a[28:31], v[36:39], v[188:191]
  v_mfma_f32_16x16x32_bf16 a[240:243], v[24:27], v[32:35], a[240:243]
  v_mfma_f32_16x16x32_bf16 a[244:247], v[24:27], v[36:39], a[244:247]
  v_mfma_f32_16x16x32_bf16 v[192:195], a[0:3], v[40:43], v[192:195]
  s_mov_b64 vcc, s[72:73]
  v_cndmask_b32_dpp v16, v122, v120, vcc row_ror:8 row_mask:0xf bank_mask:0xf
  buffer_load_dwordx4 v[96:99], v1, s[32:35], s69 offen
  buffer_load_dwordx4 a[96:99], v13, s[36:39], s99 offen offset:0 sc1
  v_mfma_f32_16x16x32_bf16 v[224:227], a[0:3], v[44:47], v[224:227]
  v_mov_b32_dpp v122, v120 row_ror:8 row_mask:0xf bank_mask:0x3
  v_cndmask_b32_dpp v120, v123, v121, vcc row_ror:8 row_mask:0xf bank_mask:0xf
  ds_read_b128 a[48:51], v8 offset:8192
  buffer_load_dwordx4 v[100:103], v2, s[32:35], s69 offen
  v_mfma_f32_16x16x32_bf16 v[196:199], a[4:7], v[40:43], v[196:199]
  v_mov_b32_dpp v123, v121 row_ror:8 row_mask:0xf bank_mask:0x3
  v_cndmask_b32_dpp v17, v126, v124, vcc row_ror:8 row_mask:0xf bank_mask:0xf
  v_mfma_f32_16x16x32_bf16 v[228:231], a[4:7], v[44:47], v[228:231]
  v_mov_b32_dpp v126, v124 row_ror:8 row_mask:0xf bank_mask:0x3
  ds_read_b128 a[52:55], v8 offset:10240
  buffer_load_dwordx4 v[104:107], v3, s[32:35], s69 offen
  buffer_load_dwordx4 a[100:103], v13, s[36:39], s99 offen offset:1024 sc1
  v_mfma_f32_16x16x32_bf16 v[200:203], a[8:11], v[40:43], v[200:203]
  v_cndmask_b32_dpp v124, v127, v125, vcc row_ror:8 row_mask:0xf bank_mask:0xf
  v_mov_b32_dpp v127, v125 row_ror:8 row_mask:0xf bank_mask:0x3
  v_mfma_f32_16x16x32_bf16 v[232:235], a[8:11], v[44:47], v[232:235]
  s_mov_b64 vcc, s[74:75]
  v_cndmask_b32_dpp v121, v120, v16, vcc row_ror:4 row_mask:0xf bank_mask:0xf
  buffer_load_dwordx4 v[108:111], v4, s[32:35], s69 offen
  v_mfma_f32_16x16x32_bf16 v[204:207], a[12:15], v[40:43], v[204:207]
  v_mov_b32_dpp v120, v16 row_ror:12 row_mask:0xf bank_mask:0x5
  v_cndmask_b32_dpp v16, v123, v122, vcc row_ror:4 row_mask:0xf bank_mask:0xf
  ds_read_b128 a[56:59], v8 offset:12288
  buffer_load_dwordx4 a[104:107], v13, s[36:39], s99 offen offset:2048 sc1
  v_mfma_f32_16x16x32_bf16 v[236:239], a[12:15], v[44:47], v[236:239]
  v_mov_b32_dpp v123, v122 row_ror:12 row_mask:0xf bank_mask:0x5
  v_mfma_f32_16x16x32_bf16 v[208:211], a[16:19], v[40:43], v[208:211]
  v_cndmask_b32_dpp v125, v124, v17, vcc row_ror:4 row_mask:0xf bank_mask:0xf
  v_mov_b32_dpp v124, v17 row_ror:12 row_mask:0xf bank_mask:0x5
  ds_read_b128 a[60:63], v8 offset:14336
  v_mfma_f32_16x16x32_bf16 v[240:243], a[16:19], v[44:47], v[240:243]
  v_cndmask_b32_dpp v17, v127, v126, vcc row_ror:4 row_mask:0xf bank_mask:0xf
  v_mov_b32_dpp v127, v126 row_ror:12 row_mask:0xf bank_mask:0x5
  buffer_load_dwordx4 a[108:111], v13, s[36:39], s99 offen offset:3072 sc1
  v_mfma_f32_16x16x32_bf16 v[212:215], a[20:23], v[40:43], v[212:215]
  v_perm_b32 v32, v14, v113, s70
  v_perm_b32 v36, v14, v113, s71
  v_mfma_f32_16x16x32_bf16 v[244:247], a[20:23], v[44:47], v[244:247]
  v_perm_b32 v33, v15, v117, s70
  v_mfma_f32_16x16x32_bf16 v[216:219], a[24:27], v[40:43], v[216:219]
  v_perm_b32 v37, v15, v117, s71
  v_perm_b32 v34, v16, v121, s70
  s_add_u32 s99, s99, 4096
  v_mfma_f32_16x16x32_bf16 v[248:251], a[24:27], v[44:47], v[248:251]
  v_perm_b32 v38, v16, v121, s71
  v_perm_b32 v35, v17, v125, s70
  v_mfma_f32_16x16x32_bf16 v[220:223], a[28:31], v[40:43], v[220:223]
  v_perm_b32 v39, v17, v125, s71
  v_mfma_f32_16x16x32_bf16 v[252:255], a[28:31], v[44:47], v[252:255]
  v_mfma_f32_16x16x32_bf16 a[248:251], v[24:27], v[40:43], a[248:251]
  v_mfma_f32_16x16x32_bf16 a[252:255], v[24:27], v[44:47], a[252:255]
  s_waitcnt lgkmcnt(7)
  v_mfma_f32_16x16x32_bf16 v[128:131], a[32:35], v[32:35], v[128:131]
  v_perm_b32 v40, v115, v112, s70
  v_perm_b32 v44, v115, v112, s71
  buffer_load_dwordx4 a[112:115], v13, s[36:39], s99 offen offset:0 sc1
  v_mfma_f32_16x16x32_bf16 v[160:163], a[32:35], v[36:39], v[160:163]
  v_perm_b32 v41, v119, v116, s70
  v_perm_b32 v45, v119, v116, s71
  s_waitcnt lgkmcnt(6)
  v_mfma_f32_16x16x32_bf16 v[132:135], a[36:39], v[32:35], v[132:135]
  v_perm_b32 v42, v123, v120, s70
  v_perm_b32 v46, v123, v120, s71
  s_barrier
  v_mfma_f32_16x16x32_bf16 v[164:167], a[36:39], v[36:39], v[164:167]
  v_perm_b32 v43, v127, v124, s70
  buffer_load_dwordx4 a[116:119], v13, s[36:39], s99 offen offset:1024 sc1
  s_waitcnt lgkmcnt(5)
  v_mfma_f32_16x16x32_bf16 v[136:139], a[40:43], v[32:35], v[136:139]
  v_perm_b32 v47, v127, v124, s71
  s_mov_b64 vcc, s[72:73]
  ds_read_b128 a[0:3], v7 offset:16384
  v_mfma_f32_16x16x32_bf16 v[168:171], a[40:43], v[36:39], v[168:171]
  s_waitcnt vmcnt(29)
  v_cndmask_b32_dpp v14, v50, v48, vcc row_ror:8 row_mask:0xf bank_mask:0xf
  v_mov_b32_dpp v50, v48 row_ror:8 row_mask:0xf bank_mask:0x3
  s_waitcnt lgkmcnt(5)
  v_mfma_f32_16x16x32_bf16 v[140:143], a[44:47], v[32:35], v[140:143]
  v_cndmask_b32_dpp v48, v51, v49, vcc row_ror:8 row_mask:0xf bank_mask:0xf
  v_mov_b32_dpp v51, v49 row_ror:8 row_mask:0xf bank_mask:0x3
  ds_read_b128 a[4:7], v7 offset:18432
  buffer_load_dwordx4 a[120:123], v13, s[36:39], s99 offen offset:2048 sc1
  v_mfma_f32_16x16x32_bf16 v[172:175], a[44:47], v[36:39], v[172:175]
  s_waitcnt vmcnt(29)
  v_cndmask_b32_dpp v15, v54, v52, vcc row_ror:8 row_mask:0xf bank_mask:0xf
  s_waitcnt lgkmcnt(5)
  v_mfma_f32_16x16x32_bf16 v[144:147], a[48:51], v[32:35], v[144:147]
  v_mov_b32_dpp v54, v52 row_ror:8 row_mask:0xf bank_mask:0x3
  v_cndmask_b32_dpp v52, v55, v53, vcc row_ror:8 row_mask:0xf bank_mask:0xf
  v_mfma_f32_16x16x32_bf16 v[176:179], a[48:51], v[36:39], v[176:179]
  v_mov_b32_dpp v55, v53 row_ror:8 row_mask:0xf bank_mask:0x3
  s_mov_b64 vcc, s[74:75]
  ds_read_b128 a[8:11], v7 offset:20480
  buffer_load_dwordx4 a[124:127], v13, s[36:39], s99 offen offset:3072 sc1
  s_waitcnt lgkmcnt(5)
  v_mfma_f32_16x16x32_bf16 v[148:151], a[52:55], v[32:35], v[148:151]
  v_cndmask_b32_dpp v49, v48, v14, vcc row_ror:4 row_mask:0xf bank_mask:0xf
  v_mov_b32_dpp v48, v14 row_ror:12 row_mask:0xf bank_mask:0x5
  v_mfma_f32_16x16x32_bf16 v[180:183], a[52:55], v[36:39], v[180:183]
  v_cndmask_b32_dpp v14, v51, v50, vcc row_ror:4 row_mask:0xf bank_mask:0xf
  ds_read_b128 a[12:15], v7 offset:22528
  s_waitcnt lgkmcnt(5)
  v_mfma_f32_16x16x32_bf16 v[152:155], a[56:59], v[32:35], v[152:155]
  v_mov_b32_dpp v51, v50 row_ror:12 row_mask:0xf bank_mask:0x5
  v_cndmask_b32_dpp v53, v52, v15, vcc row_ror:4 row_mask:0xf bank_mask:0xf
  s_add_u32 s99, s99, 4096
  v_mfma_f32_16x16x32_bf16 v[184:187], a[56:59], v[36:39], v[184:187]
  v_mov_b32_dpp v52, v15 row_ror:12 row_mask:0xf bank_mask:0x5
  v_cndmask_b32_dpp v15, v55, v54, vcc row_ror:4 row_mask:0xf bank_mask:0xf
  s_waitcnt lgkmcnt(4)
  v_mfma_f32_16x16x32_bf16 v[156:159], a[60:63], v[32:35], v[156:159]
  v_mov_b32_dpp v55, v54 row_ror:12 row_mask:0xf bank_mask:0x5
  v_mfma_f32_16x16x32_bf16 v[188:191], a[60:63], v[36:39], v[188:191]
  v_mfma_f32_16x16x32_bf16 a[240:243], v[24:27], v[32:35], a[240:243]
  v_mfma_f32_16x16x32_bf16 a[244:247], v[24:27], v[36:39], a[244:247]
  v_mfma_f32_16x16x32_bf16 v[192:195], a[32:35], v[40:43], v[192:195]
  s_mov_b64 vcc, s[72:73]
  s_waitcnt vmcnt(29)
  v_cndmask_b32_dpp v16, v58, v56, vcc row_ror:8 row_mask:0xf bank_mask:0xf
  buffer_load_dwordx4 a[128:131], v13, s[36:39], s99 offen offset:0 sc1
  v_mfma_f32_16x16x32_bf16 v[224:227], a[32:35], v[44:47], v[224:227]
  v_mov_b32_dpp v58, v56 row_ror:8 row_mask:0xf bank_mask:0x3
  v_cndmask_b32_dpp v56, v59, v57, vcc row_ror:8 row_mask:0xf bank_mask:0xf
  ds_read_b128 a[16:19], v7 offset:24576
  v_mfma_f32_16x16x32_bf16 v[196:199], a[36:39], v[40:43], v[196:199]
  v_mov_b32_dpp v59, v57 row_ror:8 row_mask:0xf bank_mask:0x3
  s_waitcnt vmcnt(29)
  v_cndmask_b32_dpp v17, v62, v60, vcc row_ror:8 row_mask:0xf bank_mask:0xf
  v_mfma_f32_16x16x32_bf16 v[228:231], a[36:39], v[44:47], v[228:231]
  v_mov_b32_dpp v62, v60 row_ror:8 row_mask:0xf bank_mask:0x3
  ds_read_b128 a[20:23], v7 offset:26624
  buffer_load_dwordx4 a[132:135], v13, s[36:39], s99 offen offset:1024 sc1
  v_mfma_f32_16x16x32_bf16 v[200:203], a[40:43], v[40:43], v[200:203]
  v_cndmask_b32_dpp v60, v63, v61, vcc row_ror:8 row_mask:0xf bank_mask:0xf
  v_mov_b32_dpp v63, v61 row_ror:8 row_mask:0xf bank_mask:0x3
  v_mfma_f32_16x16x32_bf16 v[232:235], a[40:43], v[44:47], v[232:235]
  s_mov_b64 vcc, s[74:75]
  v_cndmask_b32_dpp v57, v56, v16, vcc row_ror:4 row_mask:0xf bank_mask:0xf
  v_mfma_f32_16x16x32_bf16 v[204:207], a[44:47], v[40:43], v[204:207]
  v_mov_b32_dpp v56, v16 row_ror:12 row_mask:0xf bank_mask:0x5
  v_cndmask_b32_dpp v16, v59, v58, vcc row_ror:4 row_mask:0xf bank_mask:0xf
  ds_read_b128 a[24:27], v7 offset:28672
  buffer_load_dwordx4 a[136:139], v13, s[36:39], s99 offen offset:2048 sc1
  v_mfma_f32_16x16x32_bf16 v[236:239], a[44:47], v[44:47], v[236:239]
  v_mov_b32_dpp v59, v58 row_ror:12 row_mask:0xf bank_mask:0x5
  v_mfma_f32_16x16x32_bf16 v[208:211], a[48:51], v[40:43], v[208:211]
  v_cndmask_b32_dpp v61, v60, v17, vcc row_ror:4 row_mask:0xf bank_mask:0xf
  v_mov_b32_dpp v60, v17 row_ror:12 row_mask:0xf bank_mask:0x5
  ds_read_b128 a[28:31], v7 offset:30720
  v_mfma_f32_16x16x32_bf16 v[240:243], a[48:51], v[44:47], v[240:243]
  v_cndmask_b32_dpp v17, v63, v62, vcc row_ror:4 row_mask:0xf bank_mask:0xf
  v_mov_b32_dpp v63, v62 row_ror:12 row_mask:0xf bank_mask:0x5
  buffer_load_dwordx4 a[140:143], v13, s[36:39], s99 offen offset:3072 sc1
  v_mfma_f32_16x16x32_bf16 v[212:215], a[52:55], v[40:43], v[212:215]
  v_perm_b32 v32, v14, v49, s70
  v_perm_b32 v36, v14, v49, s71
  v_mfma_f32_16x16x32_bf16 v[244:247], a[52:55], v[44:47], v[244:247]
  v_perm_b32 v33, v15, v53, s70
  v_mfma_f32_16x16x32_bf16 v[216:219], a[56:59], v[40:43], v[216:219]
  v_perm_b32 v37, v15, v53, s71
  v_perm_b32 v34, v16, v57, s70
  s_add_u32 s99, s99, 4096
  v_mfma_f32_16x16x32_bf16 v[248:251], a[56:59], v[44:47], v[248:251]
  v_perm_b32 v38, v16, v57, s71
  v_perm_b32 v35, v17, v61, s70
  v_mfma_f32_16x16x32_bf16 v[220:223], a[60:63], v[40:43], v[220:223]
  v_perm_b32 v39, v17, v61, s71
  v_mfma_f32_16x16x32_bf16 v[252:255], a[60:63], v[44:47], v[252:255]
  v_mfma_f32_16x16x32_bf16 a[248:251], v[24:27], v[40:43], a[248:251]
  v_mfma_f32_16x16x32_bf16 a[252:255], v[24:27], v[44:47], a[252:255]
  s_waitcnt lgkmcnt(7)
  v_mfma_f32_16x16x32_bf16 v[128:131], a[0:3], v[32:35], v[128:131]
  v_perm_b32 v40, v51, v48, s70
  v_perm_b32 v44, v51, v48, s71
  buffer_load_dwordx4 a[144:147], v13, s[36:39], s99 offen offset:0 sc1
  v_mfma_f32_16x16x32_bf16 v[160:163], a[0:3], v[36:39], v[160:163]
  v_perm_b32 v41, v55, v52, s70
  v_perm_b32 v45, v55, v52, s71
  s_waitcnt lgkmcnt(6)
  v_mfma_f32_16x16x32_bf16 v[132:135], a[4:7], v[32:35], v[132:135]
  v_perm_b32 v42, v59, v56, s70
  v_perm_b32 v46, v59, v56, s71
  ds_read_b128 a[32:35], v8 offset:16384
  v_mfma_f32_16x16x32_bf16 v[164:167], a[4:7], v[36:39], v[164:167]
  v_perm_b32 v43, v63, v60, s70
  buffer_load_dwordx4 a[148:151], v13, s[36:39], s99 offen offset:1024 sc1
  s_waitcnt lgkmcnt(6)
  v_mfma_f32_16x16x32_bf16 v[136:139], a[8:11], v[32:35], v[136:139]
  v_perm_b32 v47, v63, v60, s71
  s_mov_b64 vcc, s[72:73]
  v_mfma_f32_16x16x32_bf16 v[168:171], a[8:11], v[36:39], v[168:171]
  s_waitcnt vmcnt(33)
  v_cndmask_b32_dpp v14, v66, v64, vcc row_ror:8 row_mask:0xf bank_mask:0xf
  v_mov_b32_dpp v66, v64 row_ror:8 row_mask:0xf bank_mask:0x3
  ds_read_b128 a[36:39], v8 offset:18432
  s_waitcnt lgkmcnt(6)
  v_mfma_f32_16x16x32_bf16 v[140:143], a[12:15], v[32:35], v[140:143]
  v_cndmask_b32_dpp v64, v67, v65, vcc row_ror:8 row_mask:0xf bank_mask:0xf
  v_mov_b32_dpp v67, v65 row_ror:8 row_mask:0xf bank_mask:0x3
  buffer_load_dwordx4 a[152:155], v13, s[36:39], s99 offen offset:2048 sc1
  v_mfma_f32_16x16x32_bf16 v[172:175], a[12:15], v[36:39], v[172:175]
  s_waitcnt vmcnt(33)
  v_cndmask_b32_dpp v15, v70, v68, vcc row_ror:8 row_mask:0xf bank_mask:0xf
  s_waitcnt lgkmcnt(5)
  v_mfma_f32_16x16x32_bf16 v[144:147], a[16:19], v[32:35], v[144:147]
  v_mov_b32_dpp v70, v68 row_ror:8 row_mask:0xf bank_mask:0x3
  v_cndmask_b32_dpp v68, v71, v69, vcc row_ror:8 row_mask:0xf bank_mask:0xf
  ds_read_b128 a[40:43], v8 offset:20480
  v_mfma_f32_16x16x32_bf16 v[176:179], a[16:19], v[36:39], v[176:179]
  v_mov_b32_dpp v71, v69 row_ror:8 row_mask:0xf bank_mask:0x3
  s_mov_b64 vcc, s[74:75]
  buffer_load_dwordx4 a[156:159], v13, s[36:39], s99 offen offset:3072 sc1
  s_waitcnt lgkmcnt(5)
  v_mfma_f32_16x16x32_bf16 v[148:151], a[20:23], v[32:35], v[148:151]
  v_cndmask_b32_dpp v65, v64, v14, vcc row_ror:4 row_mask:0xf bank_mask:0xf
  v_mov_b32_dpp v64, v14 row_ror:12 row_mask:0xf bank_mask:0x5
  v_mfma_f32_16x16x32_bf16 v[180:183], a[20:23], v[36:39], v[180:183]
  v_cndmask_b32_dpp v14, v67, v66, vcc row_ror:4 row_mask:0xf bank_mask:0xf
  ds_read_b128 a[44:47], v8 offset:22528
  s_waitcnt lgkmcnt(5)
  v_mfma_f32_16x16x32_bf16 v[152:155], a[24:27], v[32:35], v[152:155]
  v_mov_b32_dpp v67, v66 row_ror:12 row_mask:0xf bank_mask:0x5
  v_cndmask_b32_dpp v69, v68, v15, vcc row_ror:4 row_mask:0xf bank_mask:0xf
  s_add_u32 s99, s99, 4096
  v_mfma_f32_16x16x32_bf16 v[184:187], a[24:27], v[36:39], v[184:187]
  v_mov_b32_dpp v68, v15 row_ror:12 row_mask:0xf bank_mask:0x5
  v_cndmask_b32_dpp v15, v71, v70, vcc row_ror:4 row_mask:0xf bank_mask:0xf
  s_waitcnt lgkmcnt(4)
  v_mfma_f32_16x16x32_bf16 v[156:159], a[28:31], v[32:35], v[156:159]
  v_mov_b32_dpp v71, v70 row_ror:12 row_mask:0xf bank_mask:0x5
  v_mfma_f32_16x16x32_bf16 v[188:191], a[28:31], v[36:39], v[188:191]
  v_mfma_f32_16x16x32_bf16 a[240:243], v[24:27], v[32:35], a[240:243]
  v_mfma_f32_16x16x32_bf16 a[244:247], v[24:27], v[36:39], a[244:247]
  v_mfma_f32_16x16x32_bf16 v[192:195], a[0:3], v[40:43], v[192:195]
  s_mov_b64 vcc, s[72:73]
  s_waitcnt vmcnt(33)
  v_cndmask_b32_dpp v16, v74, v72, vcc row_ror:8 row_mask:0xf bank_mask:0xf
  buffer_load_dwordx4 a[160:163], v13, s[36:39], s99 offen offset:0 sc1
  v_mfma_f32_16x16x32_bf16 v[224:227], a[0:3], v[44:47], v[224:227]
  v_mov_b32_dpp v74, v72 row_ror:8 row_mask:0xf bank_mask:0x3
  v_cndmask_b32_dpp v72, v75, v73, vcc row_ror:8 row_mask:0xf bank_mask:0xf
  ds_read_b128 a[48:51], v8 offset:24576
  v_mfma_f32_16x16x32_bf16 v[196:199], a[4:7], v[40:43], v[196:199]
  v_mov_b32_dpp v75, v73 row_ror:8 row_mask:0xf bank_mask:0x3
  s_waitcnt vmcnt(33)
  v_cndmask_b32_dpp v17, v78, v76, vcc row_ror:8 row_mask:0xf bank_mask:0xf
  v_mfma_f32_16x16x32_bf16 v[228:231], a[4:7], v[44:47], v[228:231]
  v_mov_b32_dpp v78, v76 row_ror:8 row_mask:0xf bank_mask:0x3
  ds_read_b128 a[52:55], v8 offset:26624
  buffer_load_dwordx4 a[164:167], v13, s[36:39], s99 offen offset:1024 sc1
  v_mfma_f32_16x16x32_bf16 v[200:203], a[8:11], v[40:43], v[200:203]
  v_cndmask_b32_dpp v76, v79, v77, vcc row_ror:8 row_mask:0xf bank_mask:0xf
  v_mov_b32_dpp v79, v77 row_ror:8 row_mask:0xf bank_mask:0x3
  v_mfma_f32_16x16x32_bf16 v[232:235], a[8:11], v[44:47], v[232:235]
  s_mov_b64 vcc, s[74:75]
  v_cndmask_b32_dpp v73, v72, v16, vcc row_ror:4 row_mask:0xf bank_mask:0xf
  v_mfma_f32_16x16x32_bf16 v[204:207], a[12:15], v[40:43], v[204:207]
  v_mov_b32_dpp v72, v16 row_ror:12 row_mask:0xf bank_mask:0x5
  v_cndmask_b32_dpp v16, v75, v74, vcc row_ror:4 row_mask:0xf bank_mask:0xf
  ds_read_b128 a[56:59], v8 offset:28672
  buffer_load_dwordx4 a[168:171], v13, s[36:39], s99 offen offset:2048 sc1
  v_mfma_f32_16x16x32_bf16 v[236:239], a[12:15], v[44:47], v[236:239]
  v_mov_b32_dpp v75, v74 row_ror:12 row_mask:0xf bank_mask:0x5
  v_mfma_f32_16x16x32_bf16 v[208:211], a[16:19], v[40:43], v[208:211]
  v_cndmask_b32_dpp v77, v76, v17, vcc row_ror:4 row_mask:0xf bank_mask:0xf
  v_mov_b32_dpp v76, v17 row_ror:12 row_mask:0xf bank_mask:0x5
  ds_read_b128 a[60:63], v8 offset:30720
  v_mfma_f32_16x16x32_bf16 v[240:243], a[16:19], v[44:47], v[240:243]
  v_cndmask_b32_dpp v17, v79, v78, vcc row_ror:4 row_mask:0xf bank_mask:0xf
  v_mov_b32_dpp v79, v78 row_ror:12 row_mask:0xf bank_mask:0x5
  buffer_load_dwordx4 a[172:175], v13, s[36:39], s99 offen offset:3072 sc1
  v_mfma_f32_16x16x32_bf16 v[212:215], a[20:23], v[40:43], v[212:215]
  v_perm_b32 v32, v14, v65, s70
  v_perm_b32 v36, v14, v65, s71
  v_mfma_f32_16x16x32_bf16 v[244:247], a[20:23], v[44:47], v[244:247]
  v_perm_b32 v33, v15, v69, s70
  v_mfma_f32_16x16x32_bf16 v[216:219], a[24:27], v[40:43], v[216:219]
  v_perm_b32 v37, v15, v69, s71
  v_perm_b32 v34, v16, v73, s70
  s_add_u32 s99, s99, 4096
  v_mfma_f32_16x16x32_bf16 v[248:251], a[24:27], v[44:47], v[248:251]
  v_perm_b32 v38, v16, v73, s71
  v_perm_b32 v35, v17, v77, s70
  v_mfma_f32_16x16x32_bf16 v[220:223], a[28:31], v[40:43], v[220:223]
  v_perm_b32 v39, v17, v77, s71
  v_mfma_f32_16x16x32_bf16 v[252:255], a[28:31], v[44:47], v[252:255]
  v_mfma_f32_16x16x32_bf16 a[248:251], v[24:27], v[40:43], a[248:251]
  v_mfma_f32_16x16x32_bf16 a[252:255], v[24:27], v[44:47], a[252:255]
  s_waitcnt lgkmcnt(7)
  v_mfma_f32_16x16x32_bf16 v[128:131], a[32:35], v[32:35], v[128:131]
  v_perm_b32 v40, v67, v64, s70
  v_perm_b32 v44, v67, v64, s71
  buffer_load_dwordx4 a[176:179], v13, s[36:39], s99 offen offset:0 sc1
  v_mfma_f32_16x16x32_bf16 v[160:163], a[32:35], v[36:39], v[160:163]
  v_perm_b32 v41, v71, v68, s70
  v_perm_b32 v45, v71, v68, s71
  s_waitcnt lgkmcnt(6)
  v_mfma_f32_16x16x32_bf16 v[132:135], a[36:39], v[32:35], v[132:135]
  v_perm_b32 v42, v75, v72, s70
  v_perm_b32 v46, v75, v72, s71
  s_barrier
  v_mfma_f32_16x16x32_bf16 v[164:167], a[36:39], v[36:39], v[164:167]
  v_perm_b32 v43, v79, v76, s70
  buffer_load_dwordx4 a[180:183], v13, s[36:39], s99 offen offset:1024 sc1
  s_waitcnt lgkmcnt(5)
  v_mfma_f32_16x16x32_bf16 v[136:139], a[40:43], v[32:35], v[136:139]
  v_perm_b32 v47, v79, v76, s71
  s_mov_b64 vcc, s[72:73]
  ds_read_b128 a[0:3], v7 offset:32768
  v_mfma_f32_16x16x32_bf16 v[168:171], a[40:43], v[36:39], v[168:171]
  s_waitcnt vmcnt(37)
  v_cndmask_b32_dpp v14, v82, v80, vcc row_ror:8 row_mask:0xf bank_mask:0xf
  v_mov_b32_dpp v82, v80 row_ror:8 row_mask:0xf bank_mask:0x3
  s_waitcnt lgkmcnt(5)
  v_mfma_f32_16x16x32_bf16 v[140:143], a[44:47], v[32:35], v[140:143]
  v_cndmask_b32_dpp v80, v83, v81, vcc row_ror:8 row_mask:0xf bank_mask:0xf
  v_mov_b32_dpp v83, v81 row_ror:8 row_mask:0xf bank_mask:0x3
  ds_read_b128 a[4:7], v7 offset:34816
  buffer_load_dwordx4 a[184:187], v13, s[36:39], s99 offen offset:2048 sc1
  v_mfma_f32_16x16x32_bf16 v[172:175], a[44:47], v[36:39], v[172:175]
  s_waitcnt vmcnt(36)
  v_cndmask_b32_dpp v15, v86, v84, vcc row_ror:8 row_mask:0xf bank_mask:0xf
  s_waitcnt lgkmcnt(5)
  v_mfma_f32_16x16x32_bf16 v[144:147], a[48:51], v[32:35], v[144:147]
  v_mov_b32_dpp v86, v84 row_ror:8 row_mask:0xf bank_mask:0x3
  v_cndmask_b32_dpp v84, v87, v85, vcc row_ror:8 row_mask:0xf bank_mask:0xf
  v_mfma_f32_16x16x32_bf16 v[176:179], a[48:51], v[36:39], v[176:179]
  v_mov_b32_dpp v87, v85 row_ror:8 row_mask:0xf bank_mask:0x3
  s_mov_b64 vcc, s[74:75]
  ds_read_b128 a[8:11], v7 offset:36864
  buffer_load_dwordx4 a[188:191], v13, s[36:39], s99 offen offset:3072 sc1
  s_waitcnt lgkmcnt(5)
  v_mfma_f32_16x16x32_bf16 v[148:151], a[52:55], v[32:35], v[148:151]
  v_cndmask_b32_dpp v81, v80, v14, vcc row_ror:4 row_mask:0xf bank_mask:0xf
  v_mov_b32_dpp v80, v14 row_ror:12 row_mask:0xf bank_mask:0x5
  v_mfma_f32_16x16x32_bf16 v[180:183], a[52:55], v[36:39], v[180:183]
  v_cndmask_b32_dpp v14, v83, v82, vcc row_ror:4 row_mask:0xf bank_mask:0xf
  ds_read_b128 a[12:15], v7 offset:38912
  s_waitcnt lgkmcnt(5)
  v_mfma_f32_16x16x32_bf16 v[152:155], a[56:59], v[32:35], v[152:155]
  v_mov_b32_dpp v83, v82 row_ror:12 row_mask:0xf bank_mask:0x5
  v_cndmask_b32_dpp v85, v84, v15, vcc row_ror:4 row_mask:0xf bank_mask:0xf
  s_add_u32 s99, s99, 4096
  v_mfma_f32_16x16x32_bf16 v[184:187], a[56:59], v[36:39], v[184:187]
  v_mov_b32_dpp v84, v15 row_ror:12 row_mask:0xf bank_mask:0x5
  v_cndmask_b32_dpp v15, v87, v86, vcc row_ror:4 row_mask:0xf bank_mask:0xf
  s_waitcnt lgkmcnt(4)
  v_mfma_f32_16x16x32_bf16 v[156:159], a[60:63], v[32:35], v[156:159]
  v_mov_b32_dpp v87, v86 row_ror:12 row_mask:0xf bank_mask:0x5
  v_mfma_f32_16x16x32_bf16 v[188:191], a[60:63], v[36:39], v[188:191]
  v_mfma_f32_16x16x32_bf16 a[240:243], v[24:27], v[32:35], a[240:243]
  v_mfma_f32_16x16x32_bf16 a[244:247], v[24:27], v[36:39], a[244:247]
  v_mfma_f32_16x16x32_bf16 v[192:195], a[32:35], v[40:43], v[192:195]
  s_mov_b64 vcc, s[72:73]
  s_waitcnt vmcnt(36)
  v_cndmask_b32_dpp v16, v90, v88, vcc row_ror:8 row_mask:0xf bank_mask:0xf
  s_lshl_b32 s80, s94, 9
  s_add_u32 s80, s80, 14680064
  v_lshrrev_b32 v9, 4, v0
  v_lshl_add_u32 v9, v9, 4, s80
  v_and_b32 v11, 11, v0
  v_cmp_eq_u32 s[82:83], 11, v11
  v_mov_b32 v11, 0xf0000000
  s_nop 0
  v_cndmask_b32 v9, v9, v11, s[82:83]
  v_cndmask_b32 v28, 0, 1.0, s[82:83]
  s_mov_b32 s84, 8192
  buffer_load_dwordx4 v[112:115], v9, s[36:39], 0 offen offset:0 sc1
  v_mfma_f32_16x16x32_bf16 v[224:227], a[32:35], v[44:47], v[224:227]
  v_mov_b32_dpp v90, v88 row_ror:8 row_mask:0xf bank_mask:0x3
  v_cndmask_b32_dpp v88, v91, v89, vcc row_ror:8 row_mask:0xf bank_mask:0xf
  ds_read_b128 a[16:19], v7 offset:40960
  buffer_load_dwordx4 v[64:67], v9, s[36:39], s84 offen offset:0 sc1
  v_mfma_f32_16x16x32_bf16 v[196:199], a[36:39], v[40:43], v[196:199]
  v_mov_b32_dpp v91, v89 row_ror:8 row_mask:0xf bank_mask:0x3
  s_waitcnt vmcnt(36)
  v_cndmask_b32_dpp v17, v94, v92, vcc row_ror:8 row_mask:0xf bank_mask:0xf
  buffer_load_dwordx4 v[116:119], v9, s[36:39], 0 offen offset:64 sc1
  v_mfma_f32_16x16x32_bf16 v[228:231], a[36:39], v[44:47], v[228:231]
  v_mov_b32_dpp v94, v92 row_ror:8 row_mask:0xf bank_mask:0x3
  ds_read_b128 a[20:23], v7 offset:43008
  buffer_load_dwordx4 v[68:71], v9, s[36:39], s84 offen offset:64 sc1
  v_mfma_f32_16x16x32_bf16 v[200:203], a[40:43], v[40:43], v[200:203]
  v_cndmask_b32_dpp v92, v95, v93, vcc row_ror:8 row_mask:0xf bank_mask:0xf
  v_mov_b32_dpp v95, v93 row_ror:8 row_mask:0xf bank_mask:0x3
  buffer_load_dwordx4 v[120:123], v9, s[36:39], 0 offen offset:128 sc1
  v_mfma_f32_16x16x32_bf16 v[232:235], a[40:43], v[44:47], v[232:235]
  s_mov_b64 vcc, s[74:75]
  v_cndmask_b32_dpp v89, v88, v16, vcc row_ror:4 row_mask:0xf bank_mask:0xf
  buffer_load_dwordx4 v[72:75], v9, s[36:39], s84 offen offset:128 sc1
  v_mfma_f32_16x16x32_bf16 v[204:207], a[44:47], v[40:43], v[204:207]
  v_mov_b32_dpp v88, v16 row_ror:12 row_mask:0xf bank_mask:0x5
  v_cndmask_b32_dpp v16, v91, v90, vcc row_ror:4 row_mask:0xf bank_mask:0xf
  ds_read_b128 a[24:27], v7 offset:45056
  buffer_load_dwordx4 v[124:127], v9, s[36:39], 0 offen offset:192 sc1
  v_mfma_f32_16x16x32_bf16 v[236:239], a[44:47], v[44:47], v[236:239]
  v_mov_b32_dpp v91, v90 row_ror:12 row_mask:0xf bank_mask:0x5
  buffer_load_dwordx4 v[76:79], v9, s[36:39], s84 offen offset:192 sc1
  v_mfma_f32_16x16x32_bf16 v[208:211], a[48:51], v[40:43], v[208:211]
  v_cndmask_b32_dpp v93, v92, v17, vcc row_ror:4 row_mask:0xf bank_mask:0xf
  v_mov_b32_dpp v92, v17 row_ror:12 row_mask:0xf bank_mask:0x5
  ds_read_b128 a[28:31], v7 offset:47104
  buffer_load_dwordx4 v[48:51], v9, s[36:39], 0 offen offset:256 sc1
  buffer_load_dwordx4 v[52:55], v9, s[36:39], 0 offen offset:320 sc1
  v_mfma_f32_16x16x32_bf16 v[240:243], a[48:51], v[44:47], v[240:243]
  v_cndmask_b32_dpp v17, v95, v94, vcc row_ror:4 row_mask:0xf bank_mask:0xf
  v_mov_b32_dpp v95, v94 row_ror:12 row_mask:0xf bank_mask:0x5
  buffer_load_dwordx4 v[56:59], v9, s[36:39], 0 offen offset:384 sc1
  v_mfma_f32_16x16x32_bf16 v[212:215], a[52:55], v[40:43], v[212:215]
  v_perm_b32 v32, v14, v81, s70
  v_perm_b32 v36, v14, v81, s71
  buffer_load_dwordx4 v[60:63], v9, s[36:39], 0 offen offset:448 sc1
  v_mfma_f32_16x16x32_bf16 v[244:247], a[52:55], v[44:47], v[244:247]
  v_perm_b32 v33, v15, v85, s70
  buffer_load_dwordx4 a[192:195], v13, s[36:39], s99 offen offset:0 sc1
  v_mfma_f32_16x16x32_bf16 v[216:219], a[56:59], v[40:43], v[216:219]
  v_perm_b32 v37, v15, v85, s71
  v_perm_b32 v34, v16, v89, s70
  buffer_load_dwordx4 a[196:199], v13, s[36:39], s99 offen offset:1024 sc1
  v_mfma_f32_16x16x32_bf16 v[248:251], a[56:59], v[44:47], v[248:251]
  v_perm_b32 v38, v16, v89, s71
  v_perm_b32 v35, v17, v93, s70
  buffer_load_dwordx4 a[200:203], v13, s[36:39], s99 offen offset:2048 sc1
  v_mfma_f32_16x16x32_bf16 v[220:223], a[60:63], v[40:43], v[220:223]
  v_perm_b32 v39, v17, v93, s71
  buffer_load_dwordx4 a[204:207], v13, s[36:39], s99 offen offset:3072 sc1
  v_mfma_f32_16x16x32_bf16 v[252:255], a[60:63], v[44:47], v[252:255]
  s_add_u32 s99, s99, 4096
  v_mfma_f32_16x16x32_bf16 a[248:251], v[24:27], v[40:43], a[248:251]
  v_mfma_f32_16x16x32_bf16 a[252:255], v[24:27], v[44:47], a[252:255]
  s_waitcnt lgkmcnt(7)
  v_mfma_f32_16x16x32_bf16 v[128:131], a[0:3], v[32:35], v[128:131]
  v_perm_b32 v40, v83, v80, s70
  v_perm_b32 v44, v83, v80, s71
  buffer_load_dwordx4 a[208:211], v13, s[36:39], s99 offen offset:0 sc1
  v_mfma_f32_16x16x32_bf16 v[160:163], a[0:3], v[36:39], v[160:163]
  v_perm_b32 v41, v87, v84, s70
  v_perm_b32 v45, v87, v84, s71
  s_waitcnt lgkmcnt(6)
  v_mfma_f32_16x16x32_bf16 v[132:135], a[4:7], v[32:35], v[132:135]
  v_perm_b32 v42, v91, v88, s70
  v_perm_b32 v46, v91, v88, s71
  ds_read_b128 a[32:35], v8 offset:32768
  v_mfma_f32_16x16x32_bf16 v[164:167], a[4:7], v[36:39], v[164:167]
  v_perm_b32 v43, v95, v92, s70
  buffer_load_dwordx4 a[212:215], v13, s[36:39], s99 offen offset:1024 sc1
  s_waitcnt lgkmcnt(6)
  v_mfma_f32_16x16x32_bf16 v[136:139], a[8:11], v[32:35], v[136:139]
  v_perm_b32 v47, v95, v92, s71
  s_mov_b64 vcc, s[72:73]
  v_mfma_f32_16x16x32_bf16 v[168:171], a[8:11], v[36:39], v[168:171]
  s_waitcnt vmcnt(45)
  v_cndmask_b32_dpp v14, v98, v96, vcc row_ror:8 row_mask:0xf bank_mask:0xf
  v_mov_b32_dpp v98, v96 row_ror:8 row_mask:0xf bank_mask:0x3
  ds_read_b128 a[36:39], v8 offset:34816
  s_waitcnt lgkmcnt(6)
  v_mfma_f32_16x16x32_bf16 v[140:143], a[12:15], v[32:35], v[140:143]
  v_cndmask_b32_dpp v96, v99, v97, vcc row_ror:8 row_mask:0xf bank_mask:0xf
  v_mov_b32_dpp v99, v97 row_ror:8 row_mask:0xf bank_mask:0x3
  buffer_load_dwordx4 a[216:219], v13, s[36:39], s99 offen offset:2048 sc1
  v_mfma_f32_16x16x32_bf16 v[172:175], a[12:15], v[36:39], v[172:175]
  s_waitcnt vmcnt(44)
  v_cndmask_b32_dpp v15, v102, v100, vcc row_ror:8 row_mask:0xf bank_mask:0xf
  s_waitcnt lgkmcnt(5)
  v_mfma_f32_16x16x32_bf16 v[144:147], a[16:19], v[32:35], v[144:147]
  v_mov_b32_dpp v102, v100 row_ror:8 row_mask:0xf bank_mask:0x3
  v_cndmask_b32_dpp v100, v103, v101, vcc row_ror:8 row_mask:0xf bank_mask:0xf
  ds_read_b128 a[40:43], v8 offset:36864
  v_mfma_f32_16x16x32_bf16 v[176:179], a[16:19], v[36:39], v[176:179]
  v_mov_b32_dpp v103, v101 row_ror:8 row_mask:0xf bank_mask:0x3
  s_mov_b64 vcc, s[74:75]
  buffer_load_dwordx4 a[220:223], v13, s[36:39], s99 offen offset:3072 sc1
  s_waitcnt lgkmcnt(5)
  v_mfma_f32_16x16x32_bf16 v[148:151], a[20:23], v[32:35], v[148:151]
  v_cndmask_b32_dpp v97, v96, v14, vcc row_ror:4 row_mask:0xf bank_mask:0xf
  v_mov_b32_dpp v96, v14 row_ror:12 row_mask:0xf bank_mask:0x5
  v_mfma_f32_16x16x32_bf16 v[180:183], a[20:23], v[36:39], v[180:183]
  v_cndmask_b32_dpp v14, v99, v98, vcc row_ror:4 row_mask:0xf bank_mask:0xf
  ds_read_b128 a[44:47], v8 offset:38912
  s_waitcnt lgkmcnt(5)
  v_mfma_f32_16x16x32_bf16 v[152:155], a[24:27], v[32:35], v[152:155]
  v_mov_b32_dpp v99, v98 row_ror:12 row_mask:0xf bank_mask:0x5
  v_cndmask_b32_dpp v101, v100, v15, vcc row_ror:4 row_mask:0xf bank_mask:0xf
  s_add_u32 s99, s99, 4096
  v_mfma_f32_16x16x32_bf16 v[184:187], a[24:27], v[36:39], v[184:187]
  v_mov_b32_dpp v100, v15 row_ror:12 row_mask:0xf bank_mask:0x5
  v_cndmask_b32_dpp v15, v103, v102, vcc row_ror:4 row_mask:0xf bank_mask:0xf
  s_waitcnt lgkmcnt(4)
  v_mfma_f32_16x16x32_bf16 v[156:159], a[28:31], v[32:35], v[156:159]
  v_mov_b32_dpp v103, v102 row_ror:12 row_mask:0xf bank_mask:0x5
  v_mfma_f32_16x16x32_bf16 v[188:191], a[28:31], v[36:39], v[188:191]
  v_mfma_f32_16x16x32_bf16 a[240:243], v[24:27], v[32:35], a[240:243]
  v_mfma_f32_16x16x32_bf16 a[244:247], v[24:27], v[36:39], a[244:247]
  v_mfma_f32_16x16x32_bf16 v[192:195], a[0:3], v[40:43], v[192:195]
  s_mov_b64 vcc, s[72:73]
  s_waitcnt vmcnt(44)
  v_cndmask_b32_dpp v16, v106, v104, vcc row_ror:8 row_mask:0xf bank_mask:0xf
  buffer_load_dwordx4 v[80:83], v9, s[36:39], s84 offen offset:256 sc1
  v_mfma_f32_16x16x32_bf16 v[224:227], a[0:3], v[44:47], v[224:227]
  v_mov_b32_dpp v106, v104 row_ror:8 row_mask:0xf bank_mask:0x3
  v_cndmask_b32_dpp v104, v107, v105, vcc row_ror:8 row_mask:0xf bank_mask:0xf
  ds_read_b128 a[48:51], v8 offset:40960
  buffer_load_dwordx4 v[84:87], v9, s[36:39], s84 offen offset:320 sc1
  v_mfma_f32_16x16x32_bf16 v[196:199], a[4:7], v[40:43], v[196:199]
  v_mov_b32_dpp v107, v105 row_ror:8 row_mask:0xf bank_mask:0x3
  s_waitcnt vmcnt(44)
  v_cndmask_b32_dpp v17, v110, v108, vcc row_ror:8 row_mask:0xf bank_mask:0xf
  v_mfma_f32_16x16x32_bf16 v[228:231], a[4:7], v[44:47], v[228:231]
  v_mov_b32_dpp v110, v108 row_ror:8 row_mask:0xf bank_mask:0x3
  ds_read_b128 a[52:55], v8 offset:43008
  buffer_load_dwordx4 v[88:91], v9, s[36:39], s84 offen offset:384 sc1
  v_mfma_f32_16x16x32_bf16 v[200:203], a[8:11], v[40:43], v[200:203]
  v_cndmask_b32_dpp v108, v111, v109, vcc row_ror:8 row_mask:0xf bank_mask:0xf
  v_mov_b32_dpp v111, v109 row_ror:8 row_mask:0xf bank_mask:0x3
  v_mfma_f32_16x16x32_bf16 v[232:235], a[8:11], v[44:47], v[232:235]
  s_mov_b64 vcc, s[74:75]
  v_cndmask_b32_dpp v105, v104, v16, vcc row_ror:4 row_mask:0xf bank_mask:0xf
  buffer_load_dwordx4 v[92:95], v9, s[36:39], s84 offen offset:448 sc1
  v_mfma_f32_16x16x32_bf16 v[204:207], a[12:15], v[40:43], v[204:207]
  v_mov_b32_dpp v104, v16 row_ror:12 row_mask:0xf bank_mask:0x5
  v_cndmask_b32_dpp v16, v107, v106, vcc row_ror:4 row_mask:0xf bank_mask:0xf
  ds_read_b128 a[56:59], v8 offset:45056
  v_mfma_f32_16x16x32_bf16 v[236:239], a[12:15], v[44:47], v[236:239]
  v_mov_b32_dpp v107, v106 row_ror:12 row_mask:0xf bank_mask:0x5
  buffer_load_dwordx4 a[224:227], v13, s[36:39], s99 offen offset:0 sc1
  v_mfma_f32_16x16x32_bf16 v[208:211], a[16:19], v[40:43], v[208:211]
  v_cndmask_b32_dpp v109, v108, v17, vcc row_ror:4 row_mask:0xf bank_mask:0xf
  v_mov_b32_dpp v108, v17 row_ror:12 row_mask:0xf bank_mask:0x5
  ds_read_b128 a[60:63], v8 offset:47104
  buffer_load_dwordx4 a[228:231], v13, s[36:39], s99 offen offset:1024 sc1
  v_mfma_f32_16x16x32_bf16 v[240:243], a[16:19], v[44:47], v[240:243]
  v_cndmask_b32_dpp v17, v111, v110, vcc row_ror:4 row_mask:0xf bank_mask:0xf
  v_mov_b32_dpp v111, v110 row_ror:12 row_mask:0xf bank_mask:0x5
  v_mfma_f32_16x16x32_bf16 v[212:215], a[20:23], v[40:43], v[212:215]
  v_perm_b32 v32, v14, v97, s70
  v_perm_b32 v36, v14, v97, s71
  buffer_load_dwordx4 a[232:235], v13, s[36:39], s99 offen offset:2048 sc1
  v_mfma_f32_16x16x32_bf16 v[244:247], a[20:23], v[44:47], v[244:247]
  v_perm_b32 v33, v15, v101, s70
  v_mfma_f32_16x16x32_bf16 v[216:219], a[24:27], v[40:43], v[216:219]
  v_perm_b32 v37, v15, v101, s71
  v_perm_b32 v34, v16, v105, s70
  buffer_load_dwordx4 a[236:239], v13, s[36:39], s99 offen offset:3072 sc1
  v_mfma_f32_16x16x32_bf16 v[248:251], a[24:27], v[44:47], v[248:251]
  v_perm_b32 v38, v16, v105, s71
  v_perm_b32 v35, v17, v109, s70
  v_mfma_f32_16x16x32_bf16 v[220:223], a[28:31], v[40:43], v[220:223]
  v_perm_b32 v39, v17, v109, s71
  s_add_u32 s99, s99, 4096
  v_mfma_f32_16x16x32_bf16 v[252:255], a[28:31], v[44:47], v[252:255]
  v_mfma_f32_16x16x32_bf16 a[248:251], v[24:27], v[40:43], a[248:251]
  v_mfma_f32_16x16x32_bf16 a[252:255], v[24:27], v[44:47], a[252:255]
  s_waitcnt lgkmcnt(7)
  v_mfma_f32_16x16x32_bf16 v[128:131], a[32:35], v[32:35], v[128:131]
  v_perm_b32 v40, v99, v96, s70
  s_lshl_b32 s99, s101, 4
  v_mfma_f32_16x16x32_bf16 v[160:163], a[32:35], v[36:39], v[160:163]
  v_perm_b32 v44, v99, v96, s71
  s_lshl_b32 s85, s97, 2
  s_waitcnt lgkmcnt(6)
  v_mfma_f32_16x16x32_bf16 v[132:135], a[36:39], v[32:35], v[132:135]
  s_add_u32 s99, s99, s85
  v_mfma_f32_16x16x32_bf16 v[164:167], a[36:39], v[36:39], v[164:167]
  v_perm_b32 v41, v103, v100, s70
  s_waitcnt lgkmcnt(5)
  v_mfma_f32_16x16x32_bf16 v[136:139], a[40:43], v[32:35], v[136:139]
  s_add_u32 s99, s99, 394
  v_mfma_f32_16x16x32_bf16 v[168:171], a[40:43], v[36:39], v[168:171]
  v_perm_b32 v45, v103, v100, s71
  s_lshl_b32 s99, s99, 12
  s_waitcnt lgkmcnt(4)
  v_mfma_f32_16x16x32_bf16 v[140:143], a[44:47], v[32:35], v[140:143]
  v_mfma_f32_16x16x32_bf16 v[172:175], a[44:47], v[36:39], v[172:175]
  v_perm_b32 v42, v107, v104, s70
  s_add_u32 s99, s99, 16777216
  s_waitcnt lgkmcnt(3)
  v_mfma_f32_16x16x32_bf16 v[144:147], a[48:51], v[32:35], v[144:147]
  s_lshl_b32 s85, s97, 13
  v_mfma_f32_16x16x32_bf16 v[176:179], a[48:51], v[36:39], v[176:179]
  v_perm_b32 v46, v107, v104, s71
  s_waitcnt lgkmcnt(2)
  v_mfma_f32_16x16x32_bf16 v[148:151], a[52:55], v[32:35], v[148:151]
  s_add_u32 m0, s85, 115200
  v_mfma_f32_16x16x32_bf16 v[180:183], a[52:55], v[36:39], v[180:183]
  v_perm_b32 v43, v111, v108, s70
  s_nop 1
  s_waitcnt lgkmcnt(1)
  v_mfma_f32_16x16x32_bf16 v[152:155], a[56:59], v[32:35], v[152:155]
  v_mfma_f32_16x16x32_bf16 v[184:187], a[56:59], v[36:39], v[184:187]
  v_perm_b32 v47, v111, v108, s71
  buffer_load_dwordx4 v13, s[36:39], s99 offen offset:0 sc1 lds
  s_waitcnt lgkmcnt(0)
  v_mfma_f32_16x16x32_bf16 v[156:159], a[60:63], v[32:35], v[156:159]
  buffer_load_dwordx4 v13, s[36:39], s99 offen offset:1024 sc1 lds
  v_mfma_f32_16x16x32_bf16 v[188:191], a[60:63], v[36:39], v[188:191]
  v_mfma_f32_16x16x32_bf16 a[240:243], v[24:27], v[32:35], a[240:243]
  v_mfma_f32_16x16x32_bf16 a[244:247], v[24:27], v[36:39], a[244:247]
  v_mfma_f32_16x16x32_bf16 v[192:195], a[32:35], v[40:43], v[192:195]
  buffer_load_dwordx4 v13, s[36:39], s99 offen offset:2048 sc1 lds
  v_mfma_f32_16x16x32_bf16 v[224:227], a[32:35], v[44:47], v[224:227]
  buffer_load_dwordx4 v13, s[36:39], s99 offen offset:3072 sc1 lds
  v_mfma_f32_16x16x32_bf16 v[196:199], a[36:39], v[40:43], v[196:199]
  s_add_u32 s99, s99, 4096
  v_mfma_f32_16x16x32_bf16 v[228:231], a[36:39], v[44:47], v[228:231]
  v_mfma_f32_16x16x32_bf16 v[200:203], a[40:43], v[40:43], v[200:203]
  s_lshl_b32 s85, s97, 13
  v_mfma_f32_16x16x32_bf16 v[232:235], a[40:43], v[44:47], v[232:235]
  s_add_u32 m0, s85, 119296
  v_mfma_f32_16x16x32_bf16 v[204:207], a[44:47], v[40:43], v[204:207]
  v_mfma_f32_16x16x32_bf16 v[236:239], a[44:47], v[44:47], v[236:239]
  s_nop 1
  v_mfma_f32_16x16x32_bf16 v[208:211], a[48:51], v[40:43], v[208:211]
  buffer_load_dwordx4 v13, s[36:39], s99 offen offset:0 sc1 lds
  v_mfma_f32_16x16x32_bf16 v[240:243], a[48:51], v[44:47], v[240:243]
  v_mfma_f32_16x16x32_bf16 v[212:215], a[52:55], v[40:43], v[212:215]
  buffer_load_dwordx4 v13, s[36:39], s99 offen offset:1024 sc1 lds
  v_mfma_f32_16x16x32_bf16 v[244:247], a[52:55], v[44:47], v[244:247]
  buffer_load_dwordx4 v13, s[36:39], s99 offen offset:2048 sc1 lds
  v_mfma_f32_16x16x32_bf16 v[216:219], a[56:59], v[40:43], v[216:219]
  v_mfma_f32_16x16x32_bf16 v[248:251], a[56:59], v[44:47], v[248:251]
  buffer_load_dwordx4 v13, s[36:39], s99 offen offset:3072 sc1 lds
  v_mfma_f32_16x16x32_bf16 v[220:223], a[60:63], v[40:43], v[220:223]
  s_add_u32 s99, s99, 4096
  v_mfma_f32_16x16x32_bf16 v[252:255], a[60:63], v[44:47], v[252:255]
  v_mfma_f32_16x16x32_bf16 a[248:251], v[24:27], v[40:43], a[248:251]
  v_mfma_f32_16x16x32_bf16 a[252:255], v[24:27], v[44:47], a[252:255]
  v_accvgpr_read_b32 v22, a240
  v_accvgpr_read_b32 v23, a244
  s_nop 4
  v_accvgpr_read_b32 v24, a248
  v_accvgpr_read_b32 v25, a252
  s_mul_i32 s99, s101, 56
  s_mul_i32 s85, s97, 14
  s_add_u32 s99, s99, s85
  s_add_u32 s99, s99, 11
  s_lshl_b32 s99, s99, 12
  s_add_u32 s99, s99, 16777216
  buffer_load_dwordx4 a[240:243], v13, s[36:39], s99 offen offset:0 sc1
  buffer_load_dwordx4 a[244:247], v13, s[36:39], s99 offen offset:1024 sc1
  buffer_load_dwordx4 a[248:251], v13, s[36:39], s99 offen offset:2048 sc1
  buffer_load_dwordx4 a[252:255], v13, s[36:39], s99 offen offset:3072 sc1
  s_add_u32 s99, s99, 4096
  buffer_load_dwordx4 a[0:3], v13, s[36:39], s99 offen offset:0 sc1
  buffer_load_dwordx4 a[4:7], v13, s[36:39], s99 offen offset:1024 sc1
  s_waitcnt vmcnt(62)
  buffer_load_dwordx4 a[8:11], v13, s[36:39], s99 offen offset:2048 sc1
  buffer_load_dwordx4 a[12:15], v13, s[36:39], s99 offen offset:3072 sc1
  s_waitcnt vmcnt(62)
  s_add_u32 s99, s99, 4096
  v_lshlrev_b32 v9, 4, v0
  s_lshl_b32 s80, s94, 16
  s_lshl_b32 s81, s95, 12
  s_add_u32 s80, s80, s81
  s_add_u32 s80, s80, 10485760
  s_waitcnt vmcnt(42)
  v_pk_fma_f32 v[96:97], v[64:65], v[22:23], s[88:89] op_sel:[0,0,0] op_sel_hi:[1,0,1]
  v_pk_fma_f32 v[98:99], v[66:67], v[22:23], s[88:89] op_sel:[0,0,0] op_sel_hi:[1,0,1]
  s_waitcnt vmcnt(40)
  v_pk_fma_f32 v[100:101], v[68:69], v[22:23], s[88:89] op_sel:[0,0,0] op_sel_hi:[1,0,1]
  v_pk_fma_f32 v[102:103], v[70:71], v[22:23], s[88:89] op_sel:[0,0,0] op_sel_hi:[1,0,1]
  v_pk_fma_f32 v[104:105], v[64:65], v[22:23], s[88:89] op_sel:[0,1,0] op_sel_hi:[1,1,1]
  v_pk_fma_f32 v[106:107], v[66:67], v[22:23], s[88:89] op_sel:[0,1,0] op_sel_hi:[1,1,1]
  v_pk_fma_f32 v[108:109], v[68:69], v[22:23], s[88:89] op_sel:[0,1,0] op_sel_hi:[1,1,1]
  v_pk_fma_f32 v[110:111], v[70:71], v[22:23], s[88:89] op_sel:[0,1,0] op_sel_hi:[1,1,1]
  v_pk_fma_f32 v[128:129], v[128:129], v[112:113], v[96:97] op_sel:[0,0,0] op_sel_hi:[1,1,1]
  v_pk_fma_f32 v[130:131], v[130:131], v[114:115], v[98:99] op_sel:[0,0,0] op_sel_hi:[1,1,1]
  v_pk_fma_f32 v[132:133], v[132:133], v[116:117], v[100:101] op_sel:[0,0,0] op_sel_hi:[1,1,1]
  v_pk_fma_f32 v[134:135], v[134:135], v[118:119], v[102:103] op_sel:[0,0,0] op_sel_hi:[1,1,1]
  v_pk_fma_f32 v[160:161], v[160:161], v[112:113], v[104:105] op_sel:[0,0,0] op_sel_hi:[1,1,1]
  v_pk_fma_f32 v[162:163], v[162:163], v[114:115], v[106:107] op_sel:[0,0,0] op_sel_hi:[1,1,1]
  v_pk_fma_f32 v[164:165], v[164:165], v[116:117], v[108:109] op_sel:[0,0,0] op_sel_hi:[1,1,1]
  v_pk_fma_f32 v[166:167], v[166:167], v[118:119], v[110:111] op_sel:[0,0,0] op_sel_hi:[1,1,1]
  v_pk_fma_f32 v[96:97], v[128:129], s[90:91], s[90:91] op_sel:[0,0,0] op_sel_hi:[1,1,1] neg_lo:[0,0,1] neg_hi:[0,0,1]
  v_pk_fma_f32 v[98:99], v[130:131], s[90:91], s[90:91] op_sel:[0,0,0] op_sel_hi:[1,1,1] neg_lo:[0,0,1] neg_hi:[0,0,1]
  v_pk_fma_f32 v[100:101], v[132:133], s[90:91], s[90:91] op_sel:[0,0,0] op_sel_hi:[1,1,1] neg_lo:[0,0,1] neg_hi:[0,0,1]
  v_pk_fma_f32 v[102:103], v[134:135], s[90:91], s[90:91] op_sel:[0,0,0] op_sel_hi:[1,1,1] neg_lo:[0,0,1] neg_hi:[0,0,1]
  v_pk_fma_f32 v[104:105], v[160:161], s[90:91], s[90:91] op_sel:[0,0,0] op_sel_hi:[1,1,1] neg_lo:[0,0,1] neg_hi:[0,0,1]
  v_pk_fma_f32 v[106:107], v[162:163], s[90:91], s[90:91] op_sel:[0,0,0] op_sel_hi:[1,1,1] neg_lo:[0,0,1] neg_hi:[0,0,1]
  v_pk_fma_f32 v[108:109], v[164:165], s[90:91], s[90:91] op_sel:[0,0,0] op_sel_hi:[1,1,1] neg_lo:[0,0,1] neg_hi:[0,0,1]
  v_pk_fma_f32 v[110:111], v[166:167], s[90:91], s[90:91] op_sel:[0,0,0] op_sel_hi:[1,1,1] neg_lo:[0,0,1] neg_hi:[0,0,1]
  v_exp_f32 v96, v96 clamp
  v_exp_f32 v98, v98 clamp
  v_exp_f32 v100, v100 clamp
  v_exp_f32 v102, v102 clamp
  v_exp_f32 v104, v104 clamp
  v_exp_f32 v106, v106 clamp
  v_exp_f32 v108, v108 clamp
  v_exp_f32 v110, v110 clamp
  v_exp_f32 v97, v97 clamp
  v_exp_f32 v99, v99 clamp
  v_exp_f32 v101, v101 clamp
  v_exp_f32 v103, v103 clamp
  v_exp_f32 v105, v105 clamp
  v_exp_f32 v107, v107 clamp
  v_exp_f32 v109, v109 clamp
  v_exp_f32 v111, v111 clamp
  v_pk_add_f32 v[96:97], v[96:97], s[92:93] op_sel:[0,0] op_sel_hi:[1,1]
  v_pk_add_f32 v[98:99], v[98:99], s[92:93] op_sel:[0,0] op_sel_hi:[1,1]
  v_pk_add_f32 v[100:101], v[100:101], s[92:93] op_sel:[0,0] op_sel_hi:[1,1]
  v_pk_add_f32 v[102:103], v[102:103], s[92:93] op_sel:[0,0] op_sel_hi:[1,1]
  v_pk_add_f32 v[104:105], v[104:105], s[92:93] op_sel:[0,0] op_sel_hi:[1,1]
  v_pk_add_f32 v[106:107], v[106:107], s[92:93] op_sel:[0,0] op_sel_hi:[1,1]
  v_pk_add_f32 v[108:109], v[108:109], s[92:93] op_sel:[0,0] op_sel_hi:[1,1]
  v_pk_add_f32 v[110:111], v[110:111], s[92:93] op_sel:[0,0] op_sel_hi:[1,1]
  v_max_f32 v128, v128, v96
  v_max_f32 v130, v130, v98
  v_max_f32 v132, v132, v100
  v_max_f32 v134, v134, v102
  v_max_f32 v160, v160, v104
  v_max_f32 v162, v162, v106
  v_max_f32 v164, v164, v108
  v_max_f32 v166, v166, v110
  v_max_f32 v129, v129, v97
  v_max_f32 v131, v131, v99
  v_max_f32 v133, v133, v101
  v_max_f32 v135, v135, v103
  v_max_f32 v161, v161, v105
  v_max_f32 v163, v163, v107
  v_max_f32 v165, v165, v109
  v_max_f32 v167, v167, v111
  v_cvt_pk_bf16_f32 v32, v128, v129
  v_cvt_pk_bf16_f32 v33, v130, v131
  v_cvt_pk_bf16_f32 v34, v132, v133
  v_cvt_pk_bf16_f32 v35, v134, v135
  v_cvt_pk_bf16_f32 v36, v160, v161
  v_cvt_pk_bf16_f32 v37, v162, v163
  v_cvt_pk_bf16_f32 v38, v164, v165
  v_cvt_pk_bf16_f32 v39, v166, v167
  v_pk_fma_f32 v[96:97], v[64:65], v[24:25], v[28:29] op_sel:[0,0,0] op_sel_hi:[1,0,0]
  v_pk_fma_f32 v[98:99], v[66:67], v[24:25], v[28:29] op_sel:[0,0,0] op_sel_hi:[1,0,0]
  v_pk_fma_f32 v[100:101], v[68:69], v[24:25], v[28:29] op_sel:[0,0,0] op_sel_hi:[1,0,0]
  v_pk_fma_f32 v[102:103], v[70:71], v[24:25], v[28:29] op_sel:[0,0,0] op_sel_hi:[1,0,0]
  v_pk_fma_f32 v[104:105], v[64:65], v[24:25], v[28:29] op_sel:[0,1,0] op_sel_hi:[1,1,0]
  v_pk_fma_f32 v[106:107], v[66:67], v[24:25], v[28:29] op_sel:[0,1,0] op_sel_hi:[1,1,0]
  v_pk_fma_f32 v[108:109], v[68:69], v[24:25], v[28:29] op_sel:[0,1,0] op_sel_hi:[1,1,0]
  v_pk_fma_f32 v[110:111], v[70:71], v[24:25], v[28:29] op_sel:[0,1,0] op_sel_hi:[1,1,0]
  v_pk_fma_f32 v[192:193], v[192:193], v[112:113], v[96:97] op_sel:[0,0,0] op_sel_hi:[1,1,1]
  v_pk_fma_f32 v[194:195], v[194:195], v[114:115], v[98:99] op_sel:[0,0,0] op_sel_hi:[1,1,1]
  v_pk_fma_f32 v[196:197], v[196:197], v[116:117], v[100:101] op_sel:[0,0,0] op_sel_hi:[1,1,1]
  v_pk_fma_f32 v[198:199], v[198:199], v[118:119], v[102:103] op_sel:[0,0,0] op_sel_hi:[1,1,1]
  v_pk_fma_f32 v[224:225], v[224:225], v[112:113], v[104:105] op_sel:[0,0,0] op_sel_hi:[1,1,1]
  v_pk_fma_f32 v[226:227], v[226:227], v[114:115], v[106:107] op_sel:[0,0,0] op_sel_hi:[1,1,1]
  v_pk_fma_f32 v[228:229], v[228:229], v[116:117], v[108:109] op_sel:[0,0,0] op_sel_hi:[1,1,1]
  v_pk_fma_f32 v[230:231], v[230:231], v[118:119], v[110:111] op_sel:[0,0,0] op_sel_hi:[1,1,1]
  v_cvt_pk_bf16_f32 v40, v192, v193
  v_cvt_pk_bf16_f32 v41, v194, v195
  v_cvt_pk_bf16_f32 v42, v196, v197
  v_cvt_pk_bf16_f32 v43, v198, v199
  v_cvt_pk_bf16_f32 v44, v224, v225
  v_cvt_pk_bf16_f32 v45, v226, v227
  v_cvt_pk_bf16_f32 v46, v228, v229
  v_cvt_pk_bf16_f32 v47, v230, v231
  v_mfma_f32_16x16x32_bf16 v[128:131], v[32:35], v[40:43], 0
  s_nop 0
  v_mfma_f32_16x16x32_bf16 v[132:135], v[32:35], v[44:47], 0
  v_mfma_f32_16x16x32_bf16 v[160:163], v[36:39], v[40:43], 0
  v_mfma_f32_16x16x32_bf16 v[164:167], v[36:39], v[44:47], 0
  s_waitcnt vmcnt(38)
  v_pk_fma_f32 v[96:97], v[72:73], v[22:23], s[88:89] op_sel:[0,0,0] op_sel_hi:[1,0,1]
  v_pk_fma_f32 v[98:99], v[74:75], v[22:23], s[88:89] op_sel:[0,0,0] op_sel_hi:[1,0,1]
  s_waitcnt vmcnt(36)
  v_pk_fma_f32 v[100:101], v[76:77], v[22:23], s[88:89] op_sel:[0,0,0] op_sel_hi:[1,0,1]
  v_pk_fma_f32 v[102:103], v[78:79], v[22:23], s[88:89] op_sel:[0,0,0] op_sel_hi:[1,0,1]
  v_pk_fma_f32 v[104:105], v[72:73], v[22:23], s[88:89] op_sel:[0,1,0] op_sel_hi:[1,1,1]
  v_pk_fma_f32 v[106:107], v[74:75], v[22:23], s[88:89] op_sel:[0,1,0] op_sel_hi:[1,1,1]
  v_pk_fma_f32 v[108:109], v[76:77], v[22:23], s[88:89] op_sel:[0,1,0] op_sel_hi:[1,1,1]
  v_pk_fma_f32 v[110:111], v[78:79], v[22:23], s[88:89] op_sel:[0,1,0] op_sel_hi:[1,1,1]
  v_pk_fma_f32 v[136:137], v[136:137], v[120:121], v[96:97] op_sel:[0,0,0] op_sel_hi:[1,1,1]
  v_pk_fma_f32 v[138:139], v[138:139], v[122:123], v[98:99] op_sel:[0,0,0] op_sel_hi:[1,1,1]
  v_pk_fma_f32 v[140:141], v[140:141], v[124:125], v[100:101] op_sel:[0,0,0] op_sel_hi:[1,1,1]
  v_pk_fma_f32 v[142:143], v[142:143], v[126:127], v[102:103] op_sel:[0,0,0] op_sel_hi:[1,1,1]
  v_pk_fma_f32 v[168:169], v[168:169], v[120:121], v[104:105] op_sel:[0,0,0] op_sel_hi:[1,1,1]
  v_pk_fma_f32 v[170:171], v[170:171], v[122:123], v[106:107] op_sel:[0,0,0] op_sel_hi:[1,1,1]
  v_pk_fma_f32 v[172:173], v[172:173], v[124:125], v[108:109] op_sel:[0,0,0] op_sel_hi:[1,1,1]
  v_pk_fma_f32 v[174:175], v[174:175], v[126:127], v[110:111] op_sel:[0,0,0] op_sel_hi:[1,1,1]
  v_pk_fma_f32 v[96:97], v[136:137], s[90:91], s[90:91] op_sel:[0,0,0] op_sel_hi:[1,1,1] neg_lo:[0,0,1] neg_hi:[0,0,1]
  v_pk_fma_f32 v[98:99], v[138:139], s[90:91], s[90:91] op_sel:[0,0,0] op_sel_hi:[1,1,1] neg_lo:[0,0,1] neg_hi:[0,0,1]
  v_pk_fma_f32 v[100:101], v[140:141], s[90:91], s[90:91] op_sel:[0,0,0] op_sel_hi:[1,1,1] neg_lo:[0,0,1] neg_hi:[0,0,1]
  v_pk_fma_f32 v[102:103], v[142:143], s[90:91], s[90:91] op_sel:[0,0,0] op_sel_hi:[1,1,1] neg_lo:[0,0,1] neg_hi:[0,0,1]
  v_pk_fma_f32 v[104:105], v[168:169], s[90:91], s[90:91] op_sel:[0,0,0] op_sel_hi:[1,1,1] neg_lo:[0,0,1] neg_hi:[0,0,1]
  v_pk_fma_f32 v[106:107], v[170:171], s[90:91], s[90:91] op_sel:[0,0,0] op_sel_hi:[1,1,1] neg_lo:[0,0,1] neg_hi:[0,0,1]
  v_pk_fma_f32 v[108:109], v[172:173], s[90:91], s[90:91] op_sel:[0,0,0] op_sel_hi:[1,1,1] neg_lo:[0,0,1] neg_hi:[0,0,1]
  v_pk_fma_f32 v[110:111], v[174:175], s[90:91], s[90:91] op_sel:[0,0,0] op_sel_hi:[1,1,1] neg_lo:[0,0,1] neg_hi:[0,0,1]
  v_exp_f32 v96, v96 clamp
  v_exp_f32 v98, v98 clamp
  v_exp_f32 v100, v100 clamp
  v_exp_f32 v102, v102 clamp
  v_exp_f32 v104, v104 clamp
  v_exp_f32 v106, v106 clamp
  v_exp_f32 v108, v108 clamp
  v_exp_f32 v110, v110 clamp
  v_exp_f32 v97, v97 clamp
  v_exp_f32 v99, v99 clamp
  v_exp_f32 v101, v101 clamp
  v_exp_f32 v103, v103 clamp
  v_exp_f32 v105, v105 clamp
  v_exp_f32 v107, v107 clamp
  v_exp_f32 v109, v109 clamp
  v_exp_f32 v111, v111 clamp
  v_pk_add_f32 v[96:97], v[96:97], s[92:93] op_sel:[0,0] op_sel_hi:[1,1]
  v_pk_add_f32 v[98:99], v[98:99], s[92:93] op_sel:[0,0] op_sel_hi:[1,1]
  v_pk_add_f32 v[100:101], v[100:101], s[92:93] op_sel:[0,0] op_sel_hi:[1,1]
  v_pk_add_f32 v[102:103], v[102:103], s[92:93] op_sel:[0,0] op_sel_hi:[1,1]
  v_pk_add_f32 v[104:105], v[104:105], s[92:93] op_sel:[0,0] op_sel_hi:[1,1]
  v_pk_add_f32 v[106:107], v[106:107], s[92:93] op_sel:[0,0] op_sel_hi:[1,1]
  v_pk_add_f32 v[108:109], v[108:109], s[92:93] op_sel:[0,0] op_sel_hi:[1,1]
  v_pk_add_f32 v[110:111], v[110:111], s[92:93] op_sel:[0,0] op_sel_hi:[1,1]
  v_max_f32 v136, v136, v96
  v_max_f32 v138, v138, v98
  v_max_f32 v140, v140, v100
  v_max_f32 v142, v142, v102
  v_max_f32 v168, v168, v104
  v_max_f32 v170, v170, v106
  v_max_f32 v172, v172, v108
  v_max_f32 v174, v174, v110
  v_max_f32 v137, v137, v97
  v_max_f32 v139, v139, v99
  v_max_f32 v141, v141, v101
  v_max_f32 v143, v143, v103
  v_max_f32 v169, v169, v105
  v_max_f32 v171, v171, v107
  v_max_f32 v173, v173, v109
  v_max_f32 v175, v175, v111
  v_cvt_pk_bf16_f32 v32, v136, v137
  v_cvt_pk_bf16_f32 v33, v138, v139
  v_cvt_pk_bf16_f32 v34, v140, v141
  v_cvt_pk_bf16_f32 v35, v142, v143
  v_cvt_pk_bf16_f32 v36, v168, v169
  v_cvt_pk_bf16_f32 v37, v170, v171
  v_cvt_pk_bf16_f32 v38, v172, v173
  v_cvt_pk_bf16_f32 v39, v174, v175
  v_pk_fma_f32 v[96:97], v[72:73], v[24:25], v[28:29] op_sel:[0,0,0] op_sel_hi:[1,0,0]
  v_pk_fma_f32 v[98:99], v[74:75], v[24:25], v[28:29] op_sel:[0,0,0] op_sel_hi:[1,0,0]
  v_pk_fma_f32 v[100:101], v[76:77], v[24:25], v[28:29] op_sel:[0,0,0] op_sel_hi:[1,0,0]
  v_pk_fma_f32 v[102:103], v[78:79], v[24:25], v[28:29] op_sel:[0,0,0] op_sel_hi:[1,0,0]
  v_pk_fma_f32 v[104:105], v[72:73], v[24:25], v[28:29] op_sel:[0,1,0] op_sel_hi:[1,1,0]
  v_pk_fma_f32 v[106:107], v[74:75], v[24:25], v[28:29] op_sel:[0,1,0] op_sel_hi:[1,1,0]
  v_pk_fma_f32 v[108:109], v[76:77], v[24:25], v[28:29] op_sel:[0,1,0] op_sel_hi:[1,1,0]
  v_pk_fma_f32 v[110:111], v[78:79], v[24:25], v[28:29] op_sel:[0,1,0] op_sel_hi:[1,1,0]
  v_pk_fma_f32 v[200:201], v[200:201], v[120:121], v[96:97] op_sel:[0,0,0] op_sel_hi:[1,1,1]
  v_pk_fma_f32 v[202:203], v[202:203], v[122:123], v[98:99] op_sel:[0,0,0] op_sel_hi:[1,1,1]
  v_pk_fma_f32 v[204:205], v[204:205], v[124:125], v[100:101] op_sel:[0,0,0] op_sel_hi:[1,1,1]
  v_pk_fma_f32 v[206:207], v[206:207], v[126:127], v[102:103] op_sel:[0,0,0] op_sel_hi:[1,1,1]
  v_pk_fma_f32 v[232:233], v[232:233], v[120:121], v[104:105] op_sel:[0,0,0] op_sel_hi:[1,1,1]
  v_pk_fma_f32 v[234:235], v[234:235], v[122:123], v[106:107] op_sel:[0,0,0] op_sel_hi:[1,1,1]
  v_pk_fma_f32 v[236:237], v[236:237], v[124:125], v[108:109] op_sel:[0,0,0] op_sel_hi:[1,1,1]
  v_pk_fma_f32 v[238:239], v[238:239], v[126:127], v[110:111] op_sel:[0,0,0] op_sel_hi:[1,1,1]
  v_cvt_pk_bf16_f32 v40, v200, v201
  v_cvt_pk_bf16_f32 v41, v202, v203
  v_cvt_pk_bf16_f32 v42, v204, v205
  v_cvt_pk_bf16_f32 v43, v206, v207
  v_cvt_pk_bf16_f32 v44, v232, v233
  v_cvt_pk_bf16_f32 v45, v234, v235
  v_cvt_pk_bf16_f32 v46, v236, v237
  v_cvt_pk_bf16_f32 v47, v238, v239
  v_mfma_f32_16x16x32_bf16 v[128:131], v[32:35], v[40:43], v[128:131]
  s_nop 0
  v_mfma_f32_16x16x32_bf16 v[132:135], v[32:35], v[44:47], v[132:135]
  v_mfma_f32_16x16x32_bf16 v[160:163], v[36:39], v[40:43], v[160:163]
  v_mfma_f32_16x16x32_bf16 v[164:167], v[36:39], v[44:47], v[164:167]
  s_waitcnt vmcnt(23)
  v_pk_fma_f32 v[96:97], v[80:81], v[22:23], s[88:89] op_sel:[0,0,0] op_sel_hi:[1,0,1]
  v_pk_fma_f32 v[98:99], v[82:83], v[22:23], s[88:89] op_sel:[0,0,0] op_sel_hi:[1,0,1]
  s_waitcnt vmcnt(22)
  v_pk_fma_f32 v[100:101], v[84:85], v[22:23], s[88:89] op_sel:[0,0,0] op_sel_hi:[1,0,1]
  v_pk_fma_f32 v[102:103], v[86:87], v[22:23], s[88:89] op_sel:[0,0,0] op_sel_hi:[1,0,1]
  v_pk_fma_f32 v[104:105], v[80:81], v[22:23], s[88:89] op_sel:[0,1,0] op_sel_hi:[1,1,1]
  v_pk_fma_f32 v[106:107], v[82:83], v[22:23], s[88:89] op_sel:[0,1,0] op_sel_hi:[1,1,1]
  v_pk_fma_f32 v[108:109], v[84:85], v[22:23], s[88:89] op_sel:[0,1,0] op_sel_hi:[1,1,1]
  v_pk_fma_f32 v[110:111], v[86:87], v[22:23], s[88:89] op_sel:[0,1,0] op_sel_hi:[1,1,1]
  v_pk_fma_f32 v[144:145], v[144:145], v[48:49], v[96:97] op_sel:[0,0,0] op_sel_hi:[1,1,1]
  v_pk_fma_f32 v[146:147], v[146:147], v[50:51], v[98:99] op_sel:[0,0,0] op_sel_hi:[1,1,1]
  v_pk_fma_f32 v[148:149], v[148:149], v[52:53], v[100:101] op_sel:[0,0,0] op_sel_hi:[1,1,1]
  v_pk_fma_f32 v[150:151], v[150:151], v[54:55], v[102:103] op_sel:[0,0,0] op_sel_hi:[1,1,1]
  v_pk_fma_f32 v[176:177], v[176:177], v[48:49], v[104:105] op_sel:[0,0,0] op_sel_hi:[1,1,1]
  v_pk_fma_f32 v[178:179], v[178:179], v[50:51], v[106:107] op_sel:[0,0,0] op_sel_hi:[1,1,1]
  v_pk_fma_f32 v[180:181], v[180:181], v[52:53], v[108:109] op_sel:[0,0,0] op_sel_hi:[1,1,1]
  v_pk_fma_f32 v[182:183], v[182:183], v[54:55], v[110:111] op_sel:[0,0,0] op_sel_hi:[1,1,1]
  v_pk_fma_f32 v[96:97], v[144:145], s[90:91], s[90:91] op_sel:[0,0,0] op_sel_hi:[1,1,1] neg_lo:[0,0,1] neg_hi:[0,0,1]
  v_pk_fma_f32 v[98:99], v[146:147], s[90:91], s[90:91] op_sel:[0,0,0] op_sel_hi:[1,1,1] neg_lo:[0,0,1] neg_hi:[0,0,1]
  v_pk_fma_f32 v[100:101], v[148:149], s[90:91], s[90:91] op_sel:[0,0,0] op_sel_hi:[1,1,1] neg_lo:[0,0,1] neg_hi:[0,0,1]
  v_pk_fma_f32 v[102:103], v[150:151], s[90:91], s[90:91] op_sel:[0,0,0] op_sel_hi:[1,1,1] neg_lo:[0,0,1] neg_hi:[0,0,1]
  v_pk_fma_f32 v[104:105], v[176:177], s[90:91], s[90:91] op_sel:[0,0,0] op_sel_hi:[1,1,1] neg_lo:[0,0,1] neg_hi:[0,0,1]
  v_pk_fma_f32 v[106:107], v[178:179], s[90:91], s[90:91] op_sel:[0,0,0] op_sel_hi:[1,1,1] neg_lo:[0,0,1] neg_hi:[0,0,1]
  v_pk_fma_f32 v[108:109], v[180:181], s[90:91], s[90:91] op_sel:[0,0,0] op_sel_hi:[1,1,1] neg_lo:[0,0,1] neg_hi:[0,0,1]
  v_pk_fma_f32 v[110:111], v[182:183], s[90:91], s[90:91] op_sel:[0,0,0] op_sel_hi:[1,1,1] neg_lo:[0,0,1] neg_hi:[0,0,1]
  v_exp_f32 v96, v96 clamp
  v_exp_f32 v98, v98 clamp
  v_exp_f32 v100, v100 clamp
  v_exp_f32 v102, v102 clamp
  v_exp_f32 v104, v104 clamp
  v_exp_f32 v106, v106 clamp
  v_exp_f32 v108, v108 clamp
  v_exp_f32 v110, v110 clamp
  v_exp_f32 v97, v97 clamp
  v_exp_f32 v99, v99 clamp
  v_exp_f32 v101, v101 clamp
  v_exp_f32 v103, v103 clamp
  v_exp_f32 v105, v105 clamp
  v_exp_f32 v107, v107 clamp
  v_exp_f32 v109, v109 clamp
  v_exp_f32 v111, v111 clamp
  v_pk_add_f32 v[96:97], v[96:97], s[92:93] op_sel:[0,0] op_sel_hi:[1,1]
  v_pk_add_f32 v[98:99], v[98:99], s[92:93] op_sel:[0,0] op_sel_hi:[1,1]
  v_pk_add_f32 v[100:101], v[100:101], s[92:93] op_sel:[0,0] op_sel_hi:[1,1]
  v_pk_add_f32 v[102:103], v[102:103], s[92:93] op_sel:[0,0] op_sel_hi:[1,1]
  v_pk_add_f32 v[104:105], v[104:105], s[92:93] op_sel:[0,0] op_sel_hi:[1,1]
  v_pk_add_f32 v[106:107], v[106:107], s[92:93] op_sel:[0,0] op_sel_hi:[1,1]
  v_pk_add_f32 v[108:109], v[108:109], s[92:93] op_sel:[0,0] op_sel_hi:[1,1]
  v_pk_add_f32 v[110:111], v[110:111], s[92:93] op_sel:[0,0] op_sel_hi:[1,1]
  v_max_f32 v144, v144, v96
  v_max_f32 v146, v146, v98
  v_max_f32 v148, v148, v100
  v_max_f32 v150, v150, v102
  v_max_f32 v176, v176, v104
  v_max_f32 v178, v178, v106
  v_max_f32 v180, v180, v108
  v_max_f32 v182, v182, v110
  v_max_f32 v145, v145, v97
  v_max_f32 v147, v147, v99
  v_max_f32 v149, v149, v101
  v_max_f32 v151, v151, v103
  v_max_f32 v177, v177, v105
  v_max_f32 v179, v179, v107
  v_max_f32 v181, v181, v109
  v_max_f32 v183, v183, v111
  v_cvt_pk_bf16_f32 v32, v144, v145
  v_cvt_pk_bf16_f32 v33, v146, v147
  v_cvt_pk_bf16_f32 v34, v148, v149
  v_cvt_pk_bf16_f32 v35, v150, v151
  v_cvt_pk_bf16_f32 v36, v176, v177
  v_cvt_pk_bf16_f32 v37, v178, v179
  v_cvt_pk_bf16_f32 v38, v180, v181
  v_cvt_pk_bf16_f32 v39, v182, v183
  v_pk_fma_f32 v[96:97], v[80:81], v[24:25], v[28:29] op_sel:[0,0,0] op_sel_hi:[1,0,0]
  v_pk_fma_f32 v[98:99], v[82:83], v[24:25], v[28:29] op_sel:[0,0,0] op_sel_hi:[1,0,0]
  v_pk_fma_f32 v[100:101], v[84:85], v[24:25], v[28:29] op_sel:[0,0,0] op_sel_hi:[1,0,0]
  v_pk_fma_f32 v[102:103], v[86:87], v[24:25], v[28:29] op_sel:[0,0,0] op_sel_hi:[1,0,0]
  v_pk_fma_f32 v[104:105], v[80:81], v[24:25], v[28:29] op_sel:[0,1,0] op_sel_hi:[1,1,0]
  v_pk_fma_f32 v[106:107], v[82:83], v[24:25], v[28:29] op_sel:[0,1,0] op_sel_hi:[1,1,0]
  v_pk_fma_f32 v[108:109], v[84:85], v[24:25], v[28:29] op_sel:[0,1,0] op_sel_hi:[1,1,0]
  v_pk_fma_f32 v[110:111], v[86:87], v[24:25], v[28:29] op_sel:[0,1,0] op_sel_hi:[1,1,0]
  v_pk_fma_f32 v[208:209], v[208:209], v[48:49], v[96:97] op_sel:[0,0,0] op_sel_hi:[1,1,1]
  v_pk_fma_f32 v[210:211], v[210:211], v[50:51], v[98:99] op_sel:[0,0,0] op_sel_hi:[1,1,1]
  v_pk_fma_f32 v[212:213], v[212:213], v[52:53], v[100:101] op_sel:[0,0,0] op_sel_hi:[1,1,1]
  v_pk_fma_f32 v[214:215], v[214:215], v[54:55], v[102:103] op_sel:[0,0,0] op_sel_hi:[1,1,1]
  v_pk_fma_f32 v[240:241], v[240:241], v[48:49], v[104:105] op_sel:[0,0,0] op_sel_hi:[1,1,1]
  v_pk_fma_f32 v[242:243], v[242:243], v[50:51], v[106:107] op_sel:[0,0,0] op_sel_hi:[1,1,1]
  v_pk_fma_f32 v[244:245], v[244:245], v[52:53], v[108:109] op_sel:[0,0,0] op_sel_hi:[1,1,1]
  v_pk_fma_f32 v[246:247], v[246:247], v[54:55], v[110:111] op_sel:[0,0,0] op_sel_hi:[1,1,1]
  v_cvt_pk_bf16_f32 v40, v208, v209
  v_cvt_pk_bf16_f32 v41, v210, v211
  v_cvt_pk_bf16_f32 v42, v212, v213
  v_cvt_pk_bf16_f32 v43, v214, v215
  v_cvt_pk_bf16_f32 v44, v240, v241
  v_cvt_pk_bf16_f32 v45, v242, v243
  v_cvt_pk_bf16_f32 v46, v244, v245
  v_cvt_pk_bf16_f32 v47, v246, v247
  v_mfma_f32_16x16x32_bf16 v[128:131], v[32:35], v[40:43], v[128:131]
  s_nop 0
  v_mfma_f32_16x16x32_bf16 v[132:135], v[32:35], v[44:47], v[132:135]
  v_mfma_f32_16x16x32_bf16 v[160:163], v[36:39], v[40:43], v[160:163]
  v_mfma_f32_16x16x32_bf16 v[164:167], v[36:39], v[44:47], v[164:167]
  s_waitcnt vmcnt(21)
  v_pk_fma_f32 v[96:97], v[88:89], v[22:23], s[88:89] op_sel:[0,0,0] op_sel_hi:[1,0,1]
  v_pk_fma_f32 v[98:99], v[90:91], v[22:23], s[88:89] op_sel:[0,0,0] op_sel_hi:[1,0,1]
  s_waitcnt vmcnt(20)
  v_pk_fma_f32 v[100:101], v[92:93], v[22:23], s[88:89] op_sel:[0,0,0] op_sel_hi:[1,0,1]
  v_pk_fma_f32 v[102:103], v[94:95], v[22:23], s[88:89] op_sel:[0,0,0] op_sel_hi:[1,0,1]
  v_pk_fma_f32 v[104:105], v[88:89], v[22:23], s[88:89] op_sel:[0,1,0] op_sel_hi:[1,1,1]
  v_pk_fma_f32 v[106:107], v[90:91], v[22:23], s[88:89] op_sel:[0,1,0] op_sel_hi:[1,1,1]
  v_pk_fma_f32 v[108:109], v[92:93], v[22:23], s[88:89] op_sel:[0,1,0] op_sel_hi:[1,1,1]
  v_pk_fma_f32 v[110:111], v[94:95], v[22:23], s[88:89] op_sel:[0,1,0] op_sel_hi:[1,1,1]
  v_pk_fma_f32 v[152:153], v[152:153], v[56:57], v[96:97] op_sel:[0,0,0] op_sel_hi:[1,1,1]
  v_pk_fma_f32 v[154:155], v[154:155], v[58:59], v[98:99] op_sel:[0,0,0] op_sel_hi:[1,1,1]
  v_pk_fma_f32 v[156:157], v[156:157], v[60:61], v[100:101] op_sel:[0,0,0] op_sel_hi:[1,1,1]
  v_pk_fma_f32 v[158:159], v[158:159], v[62:63], v[102:103] op_sel:[0,0,0] op_sel_hi:[1,1,1]
  v_pk_fma_f32 v[184:185], v[184:185], v[56:57], v[104:105] op_sel:[0,0,0] op_sel_hi:[1,1,1]
  v_pk_fma_f32 v[186:187], v[186:187], v[58:59], v[106:107] op_sel:[0,0,0] op_sel_hi:[1,1,1]
  v_pk_fma_f32 v[188:189], v[188:189], v[60:61], v[108:109] op_sel:[0,0,0] op_sel_hi:[1,1,1]
  v_pk_fma_f32 v[190:191], v[190:191], v[62:63], v[110:111] op_sel:[0,0,0] op_sel_hi:[1,1,1]
  v_pk_fma_f32 v[96:97], v[152:153], s[90:91], s[90:91] op_sel:[0,0,0] op_sel_hi:[1,1,1] neg_lo:[0,0,1] neg_hi:[0,0,1]
  v_pk_fma_f32 v[98:99], v[154:155], s[90:91], s[90:91] op_sel:[0,0,0] op_sel_hi:[1,1,1] neg_lo:[0,0,1] neg_hi:[0,0,1]
  v_pk_fma_f32 v[100:101], v[156:157], s[90:91], s[90:91] op_sel:[0,0,0] op_sel_hi:[1,1,1] neg_lo:[0,0,1] neg_hi:[0,0,1]
  v_pk_fma_f32 v[102:103], v[158:159], s[90:91], s[90:91] op_sel:[0,0,0] op_sel_hi:[1,1,1] neg_lo:[0,0,1] neg_hi:[0,0,1]
  v_pk_fma_f32 v[104:105], v[184:185], s[90:91], s[90:91] op_sel:[0,0,0] op_sel_hi:[1,1,1] neg_lo:[0,0,1] neg_hi:[0,0,1]
  v_pk_fma_f32 v[106:107], v[186:187], s[90:91], s[90:91] op_sel:[0,0,0] op_sel_hi:[1,1,1] neg_lo:[0,0,1] neg_hi:[0,0,1]
  v_pk_fma_f32 v[108:109], v[188:189], s[90:91], s[90:91] op_sel:[0,0,0] op_sel_hi:[1,1,1] neg_lo:[0,0,1] neg_hi:[0,0,1]
  v_pk_fma_f32 v[110:111], v[190:191], s[90:91], s[90:91] op_sel:[0,0,0] op_sel_hi:[1,1,1] neg_lo:[0,0,1] neg_hi:[0,0,1]
  v_exp_f32 v96, v96 clamp
  v_exp_f32 v98, v98 clamp
  v_exp_f32 v100, v100 clamp
  v_exp_f32 v102, v102 clamp
  v_exp_f32 v104, v104 clamp
  v_exp_f32 v106, v106 clamp
  v_exp_f32 v108, v108 clamp
  v_exp_f32 v110, v110 clamp
  v_exp_f32 v97, v97 clamp
  v_exp_f32 v99, v99 clamp
  v_exp_f32 v101, v101 clamp
  v_exp_f32 v103, v103 clamp
  v_exp_f32 v105, v105 clamp
  v_exp_f32 v107, v107 clamp
  v_exp_f32 v109, v109 clamp
  v_exp_f32 v111, v111 clamp
  v_pk_add_f32 v[96:97], v[96:97], s[92:93] op_sel:[0,0] op_sel_hi:[1,1]
  v_pk_add_f32 v[98:99], v[98:99], s[92:93] op_sel:[0,0] op_sel_hi:[1,1]
  v_pk_add_f32 v[100:101], v[100:101], s[92:93] op_sel:[0,0] op_sel_hi:[1,1]
  v_pk_add_f32 v[102:103], v[102:103], s[92:93] op_sel:[0,0] op_sel_hi:[1,1]
  v_pk_add_f32 v[104:105], v[104:105], s[92:93] op_sel:[0,0] op_sel_hi:[1,1]
  v_pk_add_f32 v[106:107], v[106:107], s[92:93] op_sel:[0,0] op_sel_hi:[1,1]
  v_pk_add_f32 v[108:109], v[108:109], s[92:93] op_sel:[0,0] op_sel_hi:[1,1]
  v_pk_add_f32 v[110:111], v[110:111], s[92:93] op_sel:[0,0] op_sel_hi:[1,1]
  v_max_f32 v152, v152, v96
  v_max_f32 v154, v154, v98
  v_max_f32 v156, v156, v100
  v_max_f32 v158, v158, v102
  v_max_f32 v184, v184, v104
  v_max_f32 v186, v186, v106
  v_max_f32 v188, v188, v108
  v_max_f32 v190, v190, v110
  v_max_f32 v153, v153, v97
  v_max_f32 v155, v155, v99
  v_max_f32 v157, v157, v101
  v_max_f32 v159, v159, v103
  v_max_f32 v185, v185, v105
  v_max_f32 v187, v187, v107
  v_max_f32 v189, v189, v109
  v_max_f32 v191, v191, v111
  v_cvt_pk_bf16_f32 v32, v152, v153
  v_cvt_pk_bf16_f32 v33, v154, v155
  v_cvt_pk_bf16_f32 v34, v156, v157
  v_cvt_pk_bf16_f32 v35, v158, v159
  v_cvt_pk_bf16_f32 v36, v184, v185
  v_cvt_pk_bf16_f32 v37, v186, v187
  v_cvt_pk_bf16_f32 v38, v188, v189
  v_cvt_pk_bf16_f32 v39, v190, v191
  v_pk_fma_f32 v[96:97], v[88:89], v[24:25], v[28:29] op_sel:[0,0,0] op_sel_hi:[1,0,0]
  v_pk_fma_f32 v[98:99], v[90:91], v[24:25], v[28:29] op_sel:[0,0,0] op_sel_hi:[1,0,0]
  v_pk_fma_f32 v[100:101], v[92:93], v[24:25], v[28:29] op_sel:[0,0,0] op_sel_hi:[1,0,0]
  v_pk_fma_f32 v[102:103], v[94:95], v[24:25], v[28:29] op_sel:[0,0,0] op_sel_hi:[1,0,0]
  v_pk_fma_f32 v[104:105], v[88:89], v[24:25], v[28:29] op_sel:[0,1,0] op_sel_hi:[1,1,0]
  v_pk_fma_f32 v[106:107], v[90:91], v[24:25], v[28:29] op_sel:[0,1,0] op_sel_hi:[1,1,0]
  v_pk_fma_f32 v[108:109], v[92:93], v[24:25], v[28:29] op_sel:[0,1,0] op_sel_hi:[1,1,0]
  v_pk_fma_f32 v[110:111], v[94:95], v[24:25], v[28:29] op_sel:[0,1,0] op_sel_hi:[1,1,0]
  v_pk_fma_f32 v[216:217], v[216:217], v[56:57], v[96:97] op_sel:[0,0,0] op_sel_hi:[1,1,1]
  v_pk_fma_f32 v[218:219], v[218:219], v[58:59], v[98:99] op_sel:[0,0,0] op_sel_hi:[1,1,1]
  v_pk_fma_f32 v[220:221], v[220:221], v[60:61], v[100:101] op_sel:[0,0,0] op_sel_hi:[1,1,1]
  v_pk_fma_f32 v[222:223], v[222:223], v[62:63], v[102:103] op_sel:[0,0,0] op_sel_hi:[1,1,1]
  v_pk_fma_f32 v[248:249], v[248:249], v[56:57], v[104:105] op_sel:[0,0,0] op_sel_hi:[1,1,1]
  v_pk_fma_f32 v[250:251], v[250:251], v[58:59], v[106:107] op_sel:[0,0,0] op_sel_hi:[1,1,1]
  v_pk_fma_f32 v[252:253], v[252:253], v[60:61], v[108:109] op_sel:[0,0,0] op_sel_hi:[1,1,1]
  v_pk_fma_f32 v[254:255], v[254:255], v[62:63], v[110:111] op_sel:[0,0,0] op_sel_hi:[1,1,1]
  v_cvt_pk_bf16_f32 v40, v216, v217
  v_cvt_pk_bf16_f32 v41, v218, v219
  v_cvt_pk_bf16_f32 v42, v220, v221
  v_cvt_pk_bf16_f32 v43, v222, v223
  v_cvt_pk_bf16_f32 v44, v248, v249
  v_cvt_pk_bf16_f32 v45, v250, v251
  v_cvt_pk_bf16_f32 v46, v252, v253
  v_cvt_pk_bf16_f32 v47, v254, v255
  v_mfma_f32_16x16x32_bf16 v[128:131], v[32:35], v[40:43], v[128:131]
  s_nop 0
  v_mfma_f32_16x16x32_bf16 v[132:135], v[32:35], v[44:47], v[132:135]
  v_mfma_f32_16x16x32_bf16 v[160:163], v[36:39], v[40:43], v[160:163]
  v_mfma_f32_16x16x32_bf16 v[164:167], v[36:39], v[44:47], v[164:167]
  s_nop 3
  buffer_store_dwordx4 v[128:131], v9, s[36:39], s80 offen offset:0 sc1
  s_nop 0
  buffer_store_dwordx4 v[132:135], v9, s[36:39], s80 offen offset:1024 sc1
  buffer_store_dwordx4 v[160:163], v9, s[36:39], s80 offen offset:2048 sc1
  buffer_store_dwordx4 v[164:167], v9, s[36:39], s80 offen offset:3072 sc1
  s_branch k_tail
k1_prod:
  s_waitcnt lgkmcnt(0)
  s_mov_b32 s40, s22
  s_mov_b32 s41, s23
  s_mov_b32 s42, 256
  s_mov_b32 s43, 0x00020000
  s_mov_b32 s44, s16
  s_mov_b32 s45, s17
  s_mov_b32 s46, 1605632
  s_mov_b32 s47, 0x00020000
  s_lshl_b32 s48, s2, 2
  s_add_u32 s48, s48, s97
  s_cmp_lg_u32 s48, 0
  s_cbranch_scc1 k1_nonon
  s_memrealtime s[10:11]
  s_waitcnt lgkmcnt(0)
  s_or_b32 s10, s10, 1
  v_mov_b32 v2, s10
  v_mov_b32 v3, s11
  s_mov_b64 exec, 1
  buffer_store_dwordx2 v[2:3], off, s[40:43], 0 sc1
  s_mov_b64 exec, -1
  s_nop 1
k1_nonon:
  v_lshrrev_b32 v1, 4, v0
  v_bfe_u32 v2, v0, 3, 1
  v_and_b32 v3, 7, v0
  v_lshlrev_b32 v3, 4, v3
  v_and_b32 v4, 1, v1
  v_lshrrev_b32 v5, 1, v1
  v_lshlrev_b32 v6, 5, v4
  v_lshl_add_u32 v6, v5, 2, v6
  v_add_u32 v6, v6, v2
  s_movk_i32 s49, 896
  v_mad_u32_u24 v212, v6, s49, v3
  v_add_u32 v213, 7168, v212
  v_lshl_add_u32 v6, v1, 1, v2
  v_mad_u32_u24 v214, v6, s49, v3
  v_lshl_add_u32 v6, v4, 1, v5
  v_add_u32 v6, 24, v6
  v_mad_u32_u24 v215, v6, s49, v3
  s_mov_b32 s56, s48
  s_add_u32 s57, s48, 192
  s_mul_i32 s50, s56, 1171
  s_lshr_b32 s50, s50, 16
  s_mul_i32 s51, s50, 56
  s_sub_u32 s51, s56, s51
  s_lshr_b32 s52, s51, 1
  s_lshl_b32 s52, s52, 2
  s_and_b32 s51, s51, 1
  s_add_u32 s51, s51, s52
  s_mul_i32 s51, s51, 14336
  s_lshl_b32 s50, s50, 7
  s_add_u32 s50, s50, s51
  buffer_load_dwordx4 v[128:131], v212, s[44:47], s50 offen offset:0
  buffer_load_dwordx4 v[132:135], v212, s[44:47], s50 offen offset:1792
  buffer_load_dwordx4 v[136:139], v213, s[44:47], s50 offen offset:0
  buffer_load_dwordx4 v[140:143], v213, s[44:47], s50 offen offset:1792
  s_mul_i32 s50, s57, 1171
  s_lshr_b32 s50, s50, 16
  s_mul_i32 s51, s50, 56
  s_sub_u32 s51, s57, s51
  s_lshr_b32 s52, s51, 1
  s_lshl_b32 s52, s52, 2
  s_and_b32 s51, s51, 1
  s_add_u32 s51, s51, s52
  s_mul_i32 s51, s51, 14336
  s_lshl_b32 s50, s50, 7
  s_add_u32 s50, s50, s51
  buffer_load_dwordx4 v[144:147], v212, s[44:47], s50 offen offset:0
  buffer_load_dwordx4 v[148:151], v212, s[44:47], s50 offen offset:1792
  buffer_load_dwordx4 v[152:155], v213, s[44:47], s50 offen offset:0
  buffer_load_dwordx4 v[156:159], v213, s[44:47], s50 offen offset:1792
  s_cmp_lt_u32 s48, 112
  s_cbranch_scc1 k1_two
  s_add_u32 s58, s48, 272
  s_mul_i32 s50, s58, 1171
  s_lshr_b32 s50, s50, 16
  s_mul_i32 s51, s50, 56
  s_sub_u32 s51, s58, s51
  s_lshr_b32 s52, s51, 1
  s_lshl_b32 s52, s52, 2
  s_and_b32 s51, s51, 1
  s_add_u32 s51, s51, s52
  s_mul_i32 s51, s51, 14336
  s_lshl_b32 s50, s50, 7
  s_add_u32 s50, s50, s51
  buffer_load_dwordx4 v[160:163], v212, s[44:47], s50 offen offset:0
  buffer_load_dwordx4 v[164:167], v212, s[44:47], s50 offen offset:1792
  buffer_load_dwordx4 v[168:171], v213, s[44:47], s50 offen offset:0
  buffer_load_dwordx4 v[172:175], v213, s[44:47], s50 offen offset:1792
  s_branch k1_tdone
k1_two:
  s_mov_b32 s32, s8
  s_mov_b32 s33, s9
  s_mov_b32 s34, 401408
  s_mov_b32 s35, 0x00020000
  s_add_u32 s58, s48, 392
  s_and_b32 s50, s48, 15
  s_mul_i32 s50, s50, 25088
  s_lshr_b32 s51, s48, 4
  s_lshl_b32 s51, s51, 7
  s_add_u32 s50, s50, s51
  buffer_load_dwordx4 v[172:175], v215, s[32:35], s50 offen
  buffer_load_dwordx4 v[160:163], v214, s[32:35], s50 offen
  s_add_u32 s50, s50, 7168
  buffer_load_dwordx4 v[164:167], v214, s[32:35], s50 offen
  s_add_u32 s50, s50, 7168
  buffer_load_dwordx4 v[168:171], v214, s[32:35], s50 offen
k1_tdone:
  s_mov_b32 s36, s24
  s_mov_b32 s37, s25
  s_mov_b32 s38, 268435456
  s_mov_b32 s39, 0x00020000
  s_mov_b32 s28, s4
  s_mov_b32 s29, s5
  s_mov_b32 s30, 1835008
  s_mov_b32 s31, 0x00020000
  s_sub_u32 s76, s48, 64
  s_lshl_b32 s76, s76, 4
  v_lshrrev_b32 v1, 3, v0
  v_add_u32 v1, s76, v1
  v_mul_u32_u24 v2, 896, v1
  v_and_b32 v3, 7, v0
  v_lshl_add_u32 v2, v3, 4, v2
  s_mov_b32 s77, 7168
  s_cmp_lt_u32 s48, 64
  s_cselect_b32 s80, 0, -1
  s_cselect_b32 s81, 0, -1
  s_mov_b64 exec, s[80:81]
  buffer_load_dwordx4 v[16:19], v2, s[28:31], 0 offen offset:0
  buffer_load_dwordx4 v[20:23], v2, s[28:31], 0 offen offset:128
  buffer_load_dwordx4 v[24:27], v2, s[28:31], 0 offen offset:256
  buffer_load_dwordx4 v[28:31], v2, s[28:31], 0 offen offset:384
  buffer_load_dwordx4 v[32:35], v2, s[28:31], 0 offen offset:512
  buffer_load_dwordx4 v[36:39], v2, s[28:31], 0 offen offset:640
  buffer_load_dwordx4 v[40:43], v2, s[28:31], 0 offen offset:768
  buffer_load_dwordx4 v[44:47], v2, s[28:31], s77 offen offset:0
  buffer_load_dwordx4 v[48:51], v2, s[28:31], s77 offen offset:128
  buffer_load_dwordx4 v[52:55], v2, s[28:31], s77 offen offset:256
  buffer_load_dwordx4 v[56:59], v2, s[28:31], s77 offen offset:384
  buffer_load_dwordx4 v[60:63], v2, s[28:31], s77 offen offset:512
  buffer_load_dwordx4 v[64:67], v2, s[28:31], s77 offen offset:640
  buffer_load_dwordx4 v[68:71], v2, s[28:31], s77 offen offset:768
  s_mov_b64 exec, -1
  s_mov_b64 exec, s[26:27]
  buffer_load_dwordx2 v[224:225], off, s[40:43], 0 sc1
  s_mov_b64 exec, -1
  s_mov_b64 vcc, s[72:73]
  s_cmp_ge_u32 s48, 120
  s_cselect_b32 s50, 0, -1
  s_cselect_b32 s51, 0, -1
  s_lshl_b32 s56, s56, 12
  s_add_u32 s56, s56, 16777216
  s_waitcnt vmcnt(26)
  v_cndmask_b32_dpp v176, v130, v128, vcc row_ror:8 row_mask:0xf bank_mask:0xf
  v_mov_b32_dpp v130, v128 row_ror:8 row_mask:0xf bank_mask:0x3
  s_waitcnt vmcnt(25)
  v_cndmask_b32_dpp v177, v134, v132, vcc row_ror:8 row_mask:0xf bank_mask:0xf
  v_mov_b32_dpp v134, v132 row_ror:8 row_mask:0xf bank_mask:0x3
  s_waitcnt vmcnt(24)
  v_cndmask_b32_dpp v178, v138, v136, vcc row_ror:8 row_mask:0xf bank_mask:0xf
  v_mov_b32_dpp v138, v136 row_ror:8 row_mask:0xf bank_mask:0x3
  s_waitcnt vmcnt(23)
  v_cndmask_b32_dpp v179, v142, v140, vcc row_ror:8 row_mask:0xf bank_mask:0xf
  v_mov_b32_dpp v142, v140 row_ror:8 row_mask:0xf bank_mask:0x3
  v_perm_b32 v180, v130, v176, s70
  v_perm_b32 v184, v130, v176, s71
  v_perm_b32 v181, v134, v177, s70
  v_perm_b32 v185, v134, v177, s71
  v_perm_b32 v182, v138, v178, s70
  v_perm_b32 v186, v138, v178, s71
  v_perm_b32 v183, v142, v179, s70
  v_perm_b32 v187, v142, v179, s71
  v_cndmask_b32_dpp v176, v131, v129, vcc row_ror:8 row_mask:0xf bank_mask:0xf
  v_mov_b32_dpp v131, v129 row_ror:8 row_mask:0xf bank_mask:0x3
  v_cndmask_b32_dpp v177, v135, v133, vcc row_ror:8 row_mask:0xf bank_mask:0xf
  v_mov_b32_dpp v135, v133 row_ror:8 row_mask:0xf bank_mask:0x3
  v_cndmask_b32_dpp v178, v139, v137, vcc row_ror:8 row_mask:0xf bank_mask:0xf
  v_mov_b32_dpp v139, v137 row_ror:8 row_mask:0xf bank_mask:0x3
  v_cndmask_b32_dpp v179, v143, v141, vcc row_ror:8 row_mask:0xf bank_mask:0xf
  v_mov_b32_dpp v143, v141 row_ror:8 row_mask:0xf bank_mask:0x3
  v_perm_b32 v188, v131, v176, s70
  v_perm_b32 v192, v131, v176, s71
  v_perm_b32 v189, v135, v177, s70
  v_perm_b32 v193, v135, v177, s71
  v_perm_b32 v190, v139, v178, s70
  v_perm_b32 v194, v139, v178, s71
  v_perm_b32 v191, v143, v179, s70
  v_perm_b32 v195, v143, v179, s71
  buffer_store_dwordx4 v[180:183], v13, s[36:39], s56 offen offset:0 sc1
  buffer_store_dwordx4 v[184:187], v13, s[36:39], s56 offen offset:1024 sc1
  buffer_store_dwordx4 v[188:191], v13, s[36:39], s56 offen offset:2048 sc1
  buffer_store_dwordx4 v[192:195], v13, s[36:39], s56 offen offset:3072 sc1
  s_lshl_b32 s57, s57, 12
  s_add_u32 s57, s57, 16777216
  s_waitcnt vmcnt(26)
  v_cndmask_b32_dpp v176, v146, v144, vcc row_ror:8 row_mask:0xf bank_mask:0xf
  v_mov_b32_dpp v146, v144 row_ror:8 row_mask:0xf bank_mask:0x3
  s_waitcnt vmcnt(25)
  v_cndmask_b32_dpp v177, v150, v148, vcc row_ror:8 row_mask:0xf bank_mask:0xf
  v_mov_b32_dpp v150, v148 row_ror:8 row_mask:0xf bank_mask:0x3
  s_waitcnt vmcnt(24)
  v_cndmask_b32_dpp v178, v154, v152, vcc row_ror:8 row_mask:0xf bank_mask:0xf
  v_mov_b32_dpp v154, v152 row_ror:8 row_mask:0xf bank_mask:0x3
  s_waitcnt vmcnt(23)
  v_cndmask_b32_dpp v179, v158, v156, vcc row_ror:8 row_mask:0xf bank_mask:0xf
  v_mov_b32_dpp v158, v156 row_ror:8 row_mask:0xf bank_mask:0x3
  v_perm_b32 v196, v146, v176, s70
  v_perm_b32 v200, v146, v176, s71
  v_perm_b32 v197, v150, v177, s70
  v_perm_b32 v201, v150, v177, s71
  v_perm_b32 v198, v154, v178, s70
  v_perm_b32 v202, v154, v178, s71
  v_perm_b32 v199, v158, v179, s70
  v_perm_b32 v203, v158, v179, s71
  v_cndmask_b32_dpp v176, v147, v145, vcc row_ror:8 row_mask:0xf bank_mask:0xf
  v_mov_b32_dpp v147, v145 row_ror:8 row_mask:0xf bank_mask:0x3
  v_cndmask_b32_dpp v177, v151, v149, vcc row_ror:8 row_mask:0xf bank_mask:0xf
  v_mov_b32_dpp v151, v149 row_ror:8 row_mask:0xf bank_mask:0x3
  v_cndmask_b32_dpp v178, v155, v153, vcc row_ror:8 row_mask:0xf bank_mask:0xf
  v_mov_b32_dpp v155, v153 row_ror:8 row_mask:0xf bank_mask:0x3
  v_cndmask_b32_dpp v179, v159, v157, vcc row_ror:8 row_mask:0xf bank_mask:0xf
  v_mov_b32_dpp v159, v157 row_ror:8 row_mask:0xf bank_mask:0x3
  v_perm_b32 v204, v147, v176, s70
  v_perm_b32 v208, v147, v176, s71
  v_perm_b32 v205, v151, v177, s70
  v_perm_b32 v209, v151, v177, s71
  v_perm_b32 v206, v155, v178, s70
  v_perm_b32 v210, v155, v178, s71
  v_perm_b32 v207, v159, v179, s70
  v_perm_b32 v211, v159, v179, s71
  buffer_store_dwordx4 v[196:199], v13, s[36:39], s57 offen offset:0 sc1
  buffer_store_dwordx4 v[200:203], v13, s[36:39], s57 offen offset:1024 sc1
  buffer_store_dwordx4 v[204:207], v13, s[36:39], s57 offen offset:2048 sc1
  buffer_store_dwordx4 v[208:211], v13, s[36:39], s57 offen offset:3072 sc1
  s_lshl_b32 s58, s58, 12
  s_add_u32 s58, s58, 16777216
  s_waitcnt vmcnt(25)
  v_cndmask_b32_dpp v176, v162, v160, vcc row_ror:8 row_mask:0xf bank_mask:0xf
  v_mov_b32_dpp v162, v160 row_ror:8 row_mask:0xf bank_mask:0x3
  s_waitcnt vmcnt(24)
  v_cndmask_b32_dpp v177, v166, v164, vcc row_ror:8 row_mask:0xf bank_mask:0xf
  v_mov_b32_dpp v166, v164 row_ror:8 row_mask:0xf bank_mask:0x3
  s_waitcnt vmcnt(23)
  v_cndmask_b32_dpp v178, v170, v168, vcc row_ror:8 row_mask:0xf bank_mask:0xf
  v_mov_b32_dpp v170, v168 row_ror:8 row_mask:0xf bank_mask:0x3
  v_cndmask_b32_dpp v179, v174, v172, vcc row_ror:8 row_mask:0xf bank_mask:0xf
  v_mov_b32_dpp v174, v172 row_ror:8 row_mask:0xf bank_mask:0x3
  v_perm_b32 v180, v162, v176, s70
  v_perm_b32 v184, v162, v176, s71
  v_perm_b32 v181, v166, v177, s70
  v_perm_b32 v185, v166, v177, s71
  v_perm_b32 v182, v170, v178, s70
  v_perm_b32 v186, v170, v178, s71
  v_perm_b32 v183, v174, v179, s70
  v_perm_b32 v187, v174, v179, s71
  v_cndmask_b32_dpp v176, v163, v161, vcc row_ror:8 row_mask:0xf bank_mask:0xf
  v_mov_b32_dpp v163, v161 row_ror:8 row_mask:0xf bank_mask:0x3
  v_cndmask_b32_dpp v177, v167, v165, vcc row_ror:8 row_mask:0xf bank_mask:0xf
  v_mov_b32_dpp v167, v165 row_ror:8 row_mask:0xf bank_mask:0x3
  v_cndmask_b32_dpp v178, v171, v169, vcc row_ror:8 row_mask:0xf bank_mask:0xf
  v_mov_b32_dpp v171, v169 row_ror:8 row_mask:0xf bank_mask:0x3
  v_cndmask_b32_dpp v179, v175, v173, vcc row_ror:8 row_mask:0xf bank_mask:0xf
  v_mov_b32_dpp v175, v173 row_ror:8 row_mask:0xf bank_mask:0x3
  v_perm_b32 v188, v163, v176, s70
  v_perm_b32 v192, v163, v176, s71
  v_perm_b32 v189, v167, v177, s70
  v_perm_b32 v193, v167, v177, s71
  v_perm_b32 v190, v171, v178, s70
  v_perm_b32 v194, v171, v178, s71
  v_perm_b32 v191, v175, v179, s70
  v_perm_b32 v195, v175, v179, s71
  s_mov_b64 exec, s[50:51]
  buffer_store_dwordx4 v[180:183], v13, s[36:39], s58 offen offset:0 sc1
  buffer_store_dwordx4 v[184:187], v13, s[36:39], s58 offen offset:1024 sc1
  buffer_store_dwordx4 v[188:191], v13, s[36:39], s58 offen offset:2048 sc1
  buffer_store_dwordx4 v[192:195], v13, s[36:39], s58 offen offset:3072 sc1
  s_mov_b64 exec, -1
  s_cmp_lt_u32 s48, 64
  s_cbranch_scc1 k1_flag
  s_mov_b32 s79, 0x3f803f80
  v_lshlrev_b32 v1, 2, v1
  s_waitcnt vmcnt(26)
  v_dot2_f32_bf16 v4, v16, s79, 0
  s_waitcnt vmcnt(19)
  v_dot2_f32_bf16 v8, v44, s79, 0
  v_dot2_f32_bf16 v6, v16, v16, 0
  v_dot2_f32_bf16 v10, v44, v44, 0
  v_dot2_f32_bf16 v5, v17, s79, 0
  v_dot2_f32_bf16 v9, v45, s79, 0
  v_dot2_f32_bf16 v7, v17, v17, 0
  v_dot2_f32_bf16 v11, v45, v45, 0
  v_dot2_f32_bf16 v4, v18, s79, v4
  v_dot2_f32_bf16 v8, v46, s79, v8
  v_dot2_f32_bf16 v6, v18, v18, v6
  v_dot2_f32_bf16 v10, v46, v46, v10
  v_dot2_f32_bf16 v5, v19, s79, v5
  v_dot2_f32_bf16 v9, v47, s79, v9
  v_dot2_f32_bf16 v7, v19, v19, v7
  v_dot2_f32_bf16 v11, v47, v47, v11
  v_dot2_f32_bf16 v4, v20, s79, v4
  s_waitcnt vmcnt(18)
  v_dot2_f32_bf16 v8, v48, s79, v8
  v_dot2_f32_bf16 v6, v20, v20, v6
  v_dot2_f32_bf16 v10, v48, v48, v10
  v_dot2_f32_bf16 v5, v21, s79, v5
  v_dot2_f32_bf16 v9, v49, s79, v9
  v_dot2_f32_bf16 v7, v21, v21, v7
  v_dot2_f32_bf16 v11, v49, v49, v11
  v_dot2_f32_bf16 v4, v22, s79, v4
  v_dot2_f32_bf16 v8, v50, s79, v8
  v_dot2_f32_bf16 v6, v22, v22, v6
  v_dot2_f32_bf16 v10, v50, v50, v10
  v_dot2_f32_bf16 v5, v23, s79, v5
  v_dot2_f32_bf16 v9, v51, s79, v9
  v_dot2_f32_bf16 v7, v23, v23, v7
  v_dot2_f32_bf16 v11, v51, v51, v11
  v_dot2_f32_bf16 v4, v24, s79, v4
  s_waitcnt vmcnt(17)
  v_dot2_f32_bf16 v8, v52, s79, v8
  v_dot2_f32_bf16 v6, v24, v24, v6
  v_dot2_f32_bf16 v10, v52, v52, v10
  v_dot2_f32_bf16 v5, v25, s79, v5
  v_dot2_f32_bf16 v9, v53, s79, v9
  v_dot2_f32_bf16 v7, v25, v25, v7
  v_dot2_f32_bf16 v11, v53, v53, v11
  v_dot2_f32_bf16 v4, v26, s79, v4
  v_dot2_f32_bf16 v8, v54, s79, v8
  v_dot2_f32_bf16 v6, v26, v26, v6
  v_dot2_f32_bf16 v10, v54, v54, v10
  v_dot2_f32_bf16 v5, v27, s79, v5
  v_dot2_f32_bf16 v9, v55, s79, v9
  v_dot2_f32_bf16 v7, v27, v27, v7
  v_dot2_f32_bf16 v11, v55, v55, v11
  v_dot2_f32_bf16 v4, v28, s79, v4
  s_waitcnt vmcnt(16)
  v_dot2_f32_bf16 v8, v56, s79, v8
  v_dot2_f32_bf16 v6, v28, v28, v6
  v_dot2_f32_bf16 v10, v56, v56, v10
  v_dot2_f32_bf16 v5, v29, s79, v5
  v_dot2_f32_bf16 v9, v57, s79, v9
  v_dot2_f32_bf16 v7, v29, v29, v7
  v_dot2_f32_bf16 v11, v57, v57, v11
  v_dot2_f32_bf16 v4, v30, s79, v4
  v_dot2_f32_bf16 v8, v58, s79, v8
  v_dot2_f32_bf16 v6, v30, v30, v6
  v_dot2_f32_bf16 v10, v58, v58, v10
  v_dot2_f32_bf16 v5, v31, s79, v5
  v_dot2_f32_bf16 v9, v59, s79, v9
  v_dot2_f32_bf16 v7, v31, v31, v7
  v_dot2_f32_bf16 v11, v59, v59, v11
  v_dot2_f32_bf16 v4, v32, s79, v4
  s_waitcnt vmcnt(15)
  v_dot2_f32_bf16 v8, v60, s79, v8
  v_dot2_f32_bf16 v6, v32, v32, v6
  v_dot2_f32_bf16 v10, v60, v60, v10
  v_dot2_f32_bf16 v5, v33, s79, v5
  v_dot2_f32_bf16 v9, v61, s79, v9
  v_dot2_f32_bf16 v7, v33, v33, v7
  v_dot2_f32_bf16 v11, v61, v61, v11
  v_dot2_f32_bf16 v4, v34, s79, v4
  v_dot2_f32_bf16 v8, v62, s79, v8
  v_dot2_f32_bf16 v6, v34, v34, v6
  v_dot2_f32_bf16 v10, v62, v62, v10
  v_dot2_f32_bf16 v5, v35, s79, v5
  v_dot2_f32_bf16 v9, v63, s79, v9
  v_dot2_f32_bf16 v7, v35, v35, v7
  v_dot2_f32_bf16 v11, v63, v63, v11
  v_dot2_f32_bf16 v4, v36, s79, v4
  s_waitcnt vmcnt(14)
  v_dot2_f32_bf16 v8, v64, s79, v8
  v_dot2_f32_bf16 v6, v36, v36, v6
  v_dot2_f32_bf16 v10, v64, v64, v10
  v_dot2_f32_bf16 v5, v37, s79, v5
  v_dot2_f32_bf16 v9, v65, s79, v9
  v_dot2_f32_bf16 v7, v37, v37, v7
  v_dot2_f32_bf16 v11, v65, v65, v11
  v_dot2_f32_bf16 v4, v38, s79, v4
  v_dot2_f32_bf16 v8, v66, s79, v8
  v_dot2_f32_bf16 v6, v38, v38, v6
  v_dot2_f32_bf16 v10, v66, v66, v10
  v_dot2_f32_bf16 v5, v39, s79, v5
  v_dot2_f32_bf16 v9, v67, s79, v9
  v_dot2_f32_bf16 v7, v39, v39, v7
  v_dot2_f32_bf16 v11, v67, v67, v11
  v_dot2_f32_bf16 v4, v40, s79, v4
  s_waitcnt vmcnt(13)
  v_dot2_f32_bf16 v8, v68, s79, v8
  v_dot2_f32_bf16 v6, v40, v40, v6
  v_dot2_f32_bf16 v10, v68, v68, v10
  v_dot2_f32_bf16 v5, v41, s79, v5
  v_dot2_f32_bf16 v9, v69, s79, v9
  v_dot2_f32_bf16 v7, v41, v41, v7
  v_dot2_f32_bf16 v11, v69, v69, v11
  v_dot2_f32_bf16 v4, v42, s79, v4
  v_dot2_f32_bf16 v8, v70, s79, v8
  v_dot2_f32_bf16 v6, v42, v42, v6
  v_dot2_f32_bf16 v10, v70, v70, v10
  v_dot2_f32_bf16 v5, v43, s79, v5
  v_dot2_f32_bf16 v9, v71, s79, v9
  v_dot2_f32_bf16 v7, v43, v43, v7
  v_dot2_f32_bf16 v11, v71, v71, v11
  v_add_f32 v4, v4, v5
  v_add_f32 v8, v8, v9
  v_add_f32 v6, v6, v7
  v_add_f32 v10, v10, v11
  v_add_f32_dpp v4, v4, v4 quad_perm:[1,0,3,2] row_mask:0xf bank_mask:0xf
  v_add_f32_dpp v8, v8, v8 quad_perm:[1,0,3,2] row_mask:0xf bank_mask:0xf
  v_add_f32_dpp v6, v6, v6 quad_perm:[1,0,3,2] row_mask:0xf bank_mask:0xf
  v_add_f32_dpp v10, v10, v10 quad_perm:[1,0,3,2] row_mask:0xf bank_mask:0xf
  v_add_f32_dpp v4, v4, v4 quad_perm:[2,3,0,1] row_mask:0xf bank_mask:0xf
  v_add_f32_dpp v8, v8, v8 quad_perm:[2,3,0,1] row_mask:0xf bank_mask:0xf
  v_add_f32_dpp v6, v6, v6 quad_perm:[2,3,0,1] row_mask:0xf bank_mask:0xf
  v_add_f32_dpp v10, v10, v10 quad_perm:[2,3,0,1] row_mask:0xf bank_mask:0xf
  v_add_f32_dpp v4, v4, v4 row_half_mirror row_mask:0xf bank_mask:0xf
  v_add_f32_dpp v8, v8, v8 row_half_mirror row_mask:0xf bank_mask:0xf
  v_add_f32_dpp v6, v6, v6 row_half_mirror row_mask:0xf bank_mask:0xf
  v_add_f32_dpp v10, v10, v10 row_half_mirror row_mask:0xf bank_mask:0xf
  v_mul_f32 v4, 0x3b124925, v4
  v_mul_f32 v8, 0x3b124925, v8
  v_mul_f32 v6, 0x3b124925, v6
  v_mul_f32 v10, 0x3b124925, v10
  v_fma_f32 v6, -v4, v4, v6
  v_fma_f32 v10, -v8, v8, v10
  v_max_f32 v6, 0, v6
  v_max_f32 v10, 0, v10
  v_cvt_pk_bf16_f32 v5, v4, v6
  v_cvt_pk_bf16_f32 v9, v8, v10
  v_lshlrev_b32 v4, 16, v5
  v_lshlrev_b32 v8, 16, v9
  v_and_b32 v6, 0xffff0000, v5
  v_and_b32 v10, 0xffff0000, v9
  v_add_f32 v6, 0x3727c5ac, v6
  v_add_f32 v10, 0x3727c5ac, v10
  v_cvt_pk_bf16_f32 v6, v6, v6
  v_cvt_pk_bf16_f32 v10, v10, v10
  v_lshlrev_b32 v6, 16, v6
  v_lshlrev_b32 v10, 16, v10
  v_sqrt_f32 v6, v6
  v_sqrt_f32 v10, v10
  v_cvt_pk_bf16_f32 v6, v6, v6
  v_cvt_pk_bf16_f32 v10, v10, v10
  v_lshlrev_b32 v6, 16, v6
  v_lshlrev_b32 v10, 16, v10
  v_rcp_f32 v100, v6
  v_rcp_f32 v102, v10
  v_mul_f32 v101, -v4, v100
  v_mul_f32 v103, -v8, v102
  s_mov_b32 s80, 0x01010101
  s_mov_b32 s81, 0x01010101
  s_mov_b32 s77, 14680064
  s_mov_b32 s78, 14688256
  s_mov_b64 exec, s[80:81]
  buffer_store_dword v100, v1, s[36:39], s77 offen offset:0 sc1
  buffer_store_dword v101, v1, s[36:39], s78 offen offset:0 sc1
  buffer_store_dword v102, v1, s[36:39], s77 offen offset:32 sc1
  buffer_store_dword v103, v1, s[36:39], s78 offen offset:32 sc1
  s_mov_b64 exec, -1
k1_flag:
  s_waitcnt vmcnt(0) lgkmcnt(0)
  v_cmp_ne_u32 s[76:77], 0, v224
  s_mov_b32 s78, 0
  s_and_b64 s[76:77], s[76:77], s[26:27]
  s_cmp_eq_u64 s[76:77], s[26:27]
  s_cbranch_scc0 k1n_slow
k1n_ok:
  v_readfirstlane_b32 s6, v224
  v_readfirstlane_b32 s7, v225
  v_mov_b32 v226, 114688
  s_mov_b64 exec, s[26:27]
  ds_write_b64 v226, v[224:225]
  s_mov_b64 exec, -1
  s_waitcnt lgkmcnt(0)
  s_barrier
  s_lshl_b32 s50, s2, 3
  s_add_u32 s50, s50, 15728640
  v_lshlrev_b32 v226, 9, v0
  s_and_b32 s52, s26, 0xff
  s_mov_b32 s53, 0
  v_mov_b32 v18, v224
  v_mov_b32 v19, v225
  s_mov_b64 exec, s[52:53]
  buffer_store_dwordx2 v[224:225], v226, s[36:39], s50 offen sc1
  s_mov_b64 exec, -1
  s_cmp_ge_u32 s2, 32
  s_cbranch_scc1 k1_exp
  s_cmp_eq_u32 s97, 0
  s_cbranch_scc1 k_red
k1_exit:
  s_endpgm
k1_exp:
  v_lshlrev_b32 v30, 3, v0
  s_mov_b64 exec, s[26:27]
  buffer_load_dwordx2 v[20:21], v30, s[36:39], s55 offen sc1
  s_mov_b64 exec, -1
  s_waitcnt vmcnt(0)
  v_cmp_eq_u64 s[76:77], s[6:7], v[20:21]
  s_mov_b32 s78, 0
  s_and_b64 s[76:77], s[76:77], s[26:27]
  s_cmp_eq_u64 s[76:77], s[26:27]
  s_cbranch_scc0 k1pp_slow
k1pp_ok:
  s_barrier
  buffer_load_dwordx4 a[64:67], v13, s[36:39], s99 offen offset:0 sc1
  buffer_load_dwordx4 a[68:71], v13, s[36:39], s99 offen offset:1024 sc1
  buffer_load_dwordx4 a[72:75], v13, s[36:39], s99 offen offset:2048 sc1
  buffer_load_dwordx4 a[76:79], v13, s[36:39], s99 offen offset:3072 sc1
  s_add_u32 s99, s99, 4096
  buffer_load_dwordx4 a[80:83], v13, s[36:39], s99 offen offset:0 sc1
  buffer_load_dwordx4 a[84:87], v13, s[36:39], s99 offen offset:1024 sc1
  buffer_load_dwordx4 a[88:91], v13, s[36:39], s99 offen offset:2048 sc1
  buffer_load_dwordx4 a[92:95], v13, s[36:39], s99 offen offset:3072 sc1
  s_add_u32 s99, s99, 4096
  buffer_load_dwordx4 a[96:99], v13, s[36:39], s99 offen offset:0 sc1
  buffer_load_dwordx4 a[100:103], v13, s[36:39], s99 offen offset:1024 sc1
  buffer_load_dwordx4 a[104:107], v13, s[36:39], s99 offen offset:2048 sc1
  buffer_load_dwordx4 a[108:111], v13, s[36:39], s99 offen offset:3072 sc1
  s_add_u32 s99, s99, 4096
  buffer_load_dwordx4 a[112:115], v13, s[36:39], s99 offen offset:0 sc1
  buffer_load_dwordx4 a[116:119], v13, s[36:39], s99 offen offset:1024 sc1
  buffer_load_dwordx4 a[120:123], v13, s[36:39], s99 offen offset:2048 sc1
  buffer_load_dwordx4 a[124:127], v13, s[36:39], s99 offen offset:3072 sc1
  s_add_u32 s99, s99, 4096
  buffer_load_dwordx4 a[128:131], v13, s[36:39], s99 offen offset:0 sc1
  buffer_load_dwordx4 a[132:135], v13, s[36:39], s99 offen offset:1024 sc1
  buffer_load_dwordx4 a[136:139], v13, s[36:39], s99 offen offset:2048 sc1
  buffer_load_dwordx4 a[140:143], v13, s[36:39], s99 offen offset:3072 sc1
  s_add_u32 s99, s99, 4096
  buffer_load_dwordx4 a[144:147], v13, s[36:39], s99 offen offset:0 sc1
  buffer_load_dwordx4 a[148:151], v13, s[36:39], s99 offen offset:1024 sc1
  buffer_load_dwordx4 a[152:155], v13, s[36:39], s99 offen offset:2048 sc1
  buffer_load_dwordx4 a[156:159], v13, s[36:39], s99 offen offset:3072 sc1
  s_add_u32 s99, s99, 4096
  buffer_load_dwordx4 a[160:163], v13, s[36:39], s99 offen offset:0 sc1
  buffer_load_dwordx4 a[164:167], v13, s[36:39], s99 offen offset:1024 sc1
  buffer_load_dwordx4 a[168:171], v13, s[36:39], s99 offen offset:2048 sc1
  buffer_load_dwordx4 a[172:175], v13, s[36:39], s99 offen offset:3072 sc1
  s_add_u32 s99, s99, 4096
  buffer_load_dwordx4 a[176:179], v13, s[36:39], s99 offen offset:0 sc1
  buffer_load_dwordx4 a[180:183], v13, s[36:39], s99 offen offset:1024 sc1
  buffer_load_dwordx4 a[184:187], v13, s[36:39], s99 offen offset:2048 sc1
  buffer_load_dwordx4 a[188:191], v13, s[36:39], s99 offen offset:3072 sc1
  s_add_u32 s99, s99, 4096
  buffer_load_dwordx4 a[192:195], v13, s[36:39], s99 offen offset:0 sc1
  buffer_load_dwordx4 a[196:199], v13, s[36:39], s99 offen offset:1024 sc1
  buffer_load_dwordx4 a[200:203], v13, s[36:39], s99 offen offset:2048 sc1
  buffer_load_dwordx4 a[204:207], v13, s[36:39], s99 offen offset:3072 sc1
  s_add_u32 s99, s99, 4096
  buffer_load_dwordx4 a[208:211], v13, s[36:39], s99 offen offset:0 sc1
  buffer_load_dwordx4 a[212:215], v13, s[36:39], s99 offen offset:1024 sc1
  buffer_load_dwordx4 a[216:219], v13, s[36:39], s99 offen offset:2048 sc1
  buffer_load_dwordx4 a[220:223], v13, s[36:39], s99 offen offset:3072 sc1
  s_add_u32 s99, s99, 4096
  buffer_load_dwordx4 a[224:227], v13, s[36:39], s99 offen offset:0 sc1
  buffer_load_dwordx4 a[228:231], v13, s[36:39], s99 offen offset:1024 sc1
  buffer_load_dwordx4 a[232:235], v13, s[36:39], s99 offen offset:2048 sc1
  buffer_load_dwordx4 a[236:239], v13, s[36:39], s99 offen offset:3072 sc1
  s_add_u32 s99, s99, 4096
  s_lshl_b32 s99, s101, 4
  s_lshl_b32 s85, s97, 2
  s_add_u32 s99, s99, s85
  s_add_u32 s99, s99, 394
  s_lshl_b32 s99, s99, 12
  s_add_u32 s99, s99, 16777216
  s_lshl_b32 s85, s97, 13
  s_add_u32 m0, s85, 115200
  s_nop 1
  buffer_load_dwordx4 v13, s[36:39], s99 offen offset:0 sc1 lds
  buffer_load_dwordx4 v13, s[36:39], s99 offen offset:1024 sc1 lds
  buffer_load_dwordx4 v13, s[36:39], s99 offen offset:2048 sc1 lds
  buffer_load_dwordx4 v13, s[36:39], s99 offen offset:3072 sc1 lds
  s_add_u32 s99, s99, 4096
  s_lshl_b32 s85, s97, 13
  s_add_u32 m0, s85, 119296
  s_nop 1
  buffer_load_dwordx4 v13, s[36:39], s99 offen offset:0 sc1 lds
  buffer_load_dwordx4 v13, s[36:39], s99 offen offset:1024 sc1 lds
  buffer_load_dwordx4 v13, s[36:39], s99 offen offset:2048 sc1 lds
  buffer_load_dwordx4 v13, s[36:39], s99 offen offset:3072 sc1 lds
  s_add_u32 s99, s99, 4096
  s_mul_i32 s99, s101, 56
  s_mul_i32 s85, s97, 14
  s_add_u32 s99, s99, s85
  s_add_u32 s99, s99, 11
  s_lshl_b32 s99, s99, 12
  s_add_u32 s99, s99, 16777216
  buffer_load_dwordx4 a[240:243], v13, s[36:39], s99 offen offset:0 sc1
  buffer_load_dwordx4 a[244:247], v13, s[36:39], s99 offen offset:1024 sc1
  buffer_load_dwordx4 a[248:251], v13, s[36:39], s99 offen offset:2048 sc1
  buffer_load_dwordx4 a[252:255], v13, s[36:39], s99 offen offset:3072 sc1
  s_add_u32 s99, s99, 4096
  buffer_load_dwordx4 a[0:3], v13, s[36:39], s99 offen offset:0 sc1
  buffer_load_dwordx4 a[4:7], v13, s[36:39], s99 offen offset:1024 sc1
  buffer_load_dwordx4 a[8:11], v13, s[36:39], s99 offen offset:2048 sc1
  buffer_load_dwordx4 a[12:15], v13, s[36:39], s99 offen offset:3072 sc1
  s_add_u32 s99, s99, 4096
  buffer_load_dwordx4 a[16:19], v13, s[36:39], s99 offen offset:0 sc1
  buffer_load_dwordx4 a[20:23], v13, s[36:39], s99 offen offset:1024 sc1
  buffer_load_dwordx4 a[24:27], v13, s[36:39], s99 offen offset:2048 sc1
  buffer_load_dwordx4 a[28:31], v13, s[36:39], s99 offen offset:3072 sc1
  s_waitcnt vmcnt(62)
  s_add_u32 s99, s99, 4096
  s_lshl_b32 s99, s101, 4
  s_lshl_b32 s85, s97, 2
  s_add_u32 s99, s99, s85
  s_add_u32 s99, s99, 392
  s_lshl_b32 s99, s99, 12
  s_add_u32 s99, s99, 16777216
  buffer_load_dwordx4 a[32:35], v13, s[36:39], s99 offen offset:0 sc1
  buffer_load_dwordx4 a[36:39], v13, s[36:39], s99 offen offset:1024 sc1
  s_waitcnt vmcnt(62)
  buffer_load_dwordx4 a[40:43], v13, s[36:39], s99 offen offset:2048 sc1
  buffer_load_dwordx4 a[44:47], v13, s[36:39], s99 offen offset:3072 sc1
  s_waitcnt vmcnt(62)
  s_add_u32 s99, s99, 4096
  buffer_load_dwordx4 a[48:51], v13, s[36:39], s99 offen offset:0 sc1
  buffer_load_dwordx4 a[52:55], v13, s[36:39], s99 offen offset:1024 sc1
  s_waitcnt vmcnt(62)
  buffer_load_dwordx4 a[56:59], v13, s[36:39], s99 offen offset:2048 sc1
  buffer_load_dwordx4 a[60:63], v13, s[36:39], s99 offen offset:3072 sc1
  s_waitcnt vmcnt(62)
  s_add_u32 s99, s99, 4096
  s_mov_b32 s3, -1
  s_mov_b32 s96, 3
  s_branch k_tail
k_red:
  s_lshr_b32 s80, s2, 3
  s_lshl_b32 s55, s80, 7
  s_add_u32 s55, s55, 15736832
  s_mov_b32 s26, 0xffff
  s_mov_b32 s27, 0
  s_lshr_b32 s81, s2, 1
  s_and_b32 s82, s2, 1
  s_lshl_b32 s83, s81, 12
  s_lshl_b32 s84, s82, 10
  s_add_u32 s83, s83, s84
  s_add_u32 s83, s83, 10485760
  v_and_b32 v1, 15, v0
  s_lshl_b32 s85, s82, 3
  v_xor_b32 v1, s85, v1
  v_and_b32 v1, 11, v1
  v_cmp_eq_u32 vcc, 11, v1
  v_add_u32 v2, s84, v13
  v_xor_b32 v3, 0x480, v2
  v_cndmask_b32 v2, v2, v3, vcc
  s_lshl_b32 s85, s81, 11
  s_add_u32 s85, s85, 12582912
  v_lshlrev_b32 v30, 3, v0
  s_mov_b64 exec, s[26:27]
  buffer_load_dwordx2 v[20:21], v30, s[36:39], s55 offen sc1
  s_mov_b64 exec, -1
  s_waitcnt vmcnt(0)
  v_cmp_eq_u64 s[76:77], s[6:7], v[20:21]
  s_mov_b32 s78, 0
  s_and_b64 s[76:77], s[76:77], s[26:27]
  s_cmp_eq_u64 s[76:77], s[26:27]
  s_cbranch_scc0 kred_slow
kred_ok:
  buffer_load_dwordx4 v[32:35], v13, s[36:39], s83 offen offset:0 sc1
  buffer_load_dwordx4 v[36:39], v13, s[36:39], s83 offen offset:2048 sc1
  s_add_u32 s83, s83, 65536
  buffer_load_dwordx4 v[40:43], v13, s[36:39], s83 offen offset:0 sc1
  buffer_load_dwordx4 v[44:47], v13, s[36:39], s83 offen offset:2048 sc1
  s_add_u32 s83, s83, 65536
  buffer_load_dwordx4 v[48:51], v13, s[36:39], s83 offen offset:0 sc1
  buffer_load_dwordx4 v[52:55], v13, s[36:39], s83 offen offset:2048 sc1
  s_add_u32 s83, s83, 65536
  buffer_load_dwordx4 v[56:59], v13, s[36:39], s83 offen offset:0 sc1
  buffer_load_dwordx4 v[60:63], v13, s[36:39], s83 offen offset:2048 sc1
  s_add_u32 s83, s83, 65536
  buffer_load_dwordx4 v[64:67], v13, s[36:39], s83 offen offset:0 sc1
  buffer_load_dwordx4 v[68:71], v13, s[36:39], s83 offen offset:2048 sc1
  s_add_u32 s83, s83, 65536
  buffer_load_dwordx4 v[72:75], v13, s[36:39], s83 offen offset:0 sc1
  buffer_load_dwordx4 v[76:79], v13, s[36:39], s83 offen offset:2048 sc1
  s_add_u32 s83, s83, 65536
  buffer_load_dwordx4 v[80:83], v13, s[36:39], s83 offen offset:0 sc1
  buffer_load_dwordx4 v[84:87], v13, s[36:39], s83 offen offset:2048 sc1
  s_add_u32 s83, s83, 65536
  buffer_load_dwordx4 v[88:91], v13, s[36:39], s83 offen offset:0 sc1
  buffer_load_dwordx4 v[92:95], v13, s[36:39], s83 offen offset:2048 sc1
  s_add_u32 s83, s83, 65536
  buffer_load_dwordx4 v[96:99], v13, s[36:39], s83 offen offset:0 sc1
  buffer_load_dwordx4 v[100:103], v13, s[36:39], s83 offen offset:2048 sc1
  s_add_u32 s83, s83, 65536
  buffer_load_dwordx4 v[104:107], v13, s[36:39], s83 offen offset:0 sc1
  buffer_load_dwordx4 v[108:111], v13, s[36:39], s83 offen offset:2048 sc1
  s_add_u32 s83, s83, 65536
  buffer_load_dwordx4 v[112:115], v13, s[36:39], s83 offen offset:0 sc1
  buffer_load_dwordx4 v[116:119], v13, s[36:39], s83 offen offset:2048 sc1
  s_add_u32 s83, s83, 65536
  buffer_load_dwordx4 v[120:123], v13, s[36:39], s83 offen offset:0 sc1
  buffer_load_dwordx4 v[124:127], v13, s[36:39], s83 offen offset:2048 sc1
  s_add_u32 s83, s83, 65536
  buffer_load_dwordx4 v[128:131], v13, s[36:39], s83 offen offset:0 sc1
  buffer_load_dwordx4 v[132:135], v13, s[36:39], s83 offen offset:2048 sc1
  s_add_u32 s83, s83, 65536
  buffer_load_dwordx4 v[136:139], v13, s[36:39], s83 offen offset:0 sc1
  buffer_load_dwordx4 v[140:143], v13, s[36:39], s83 offen offset:2048 sc1
  s_add_u32 s83, s83, 65536
  buffer_load_dwordx4 v[144:147], v13, s[36:39], s83 offen offset:0 sc1
  buffer_load_dwordx4 v[148:151], v13, s[36:39], s83 offen offset:2048 sc1
  s_add_u32 s83, s83, 65536
  buffer_load_dwordx4 v[152:155], v13, s[36:39], s83 offen offset:0 sc1
  buffer_load_dwordx4 v[156:159], v13, s[36:39], s83 offen offset:2048 sc1
  s_waitcnt vmcnt(29)
  v_pk_add_f32 v[32:33], v[32:33], v[40:41] op_sel:[0,0] op_sel_hi:[1,1]
  v_pk_add_f32 v[34:35], v[34:35], v[42:43] op_sel:[0,0] op_sel_hi:[1,1]
  s_waitcnt vmcnt(28)
  v_pk_add_f32 v[36:37], v[36:37], v[44:45] op_sel:[0,0] op_sel_hi:[1,1]
  v_pk_add_f32 v[38:39], v[38:39], v[46:47] op_sel:[0,0] op_sel_hi:[1,1]
  s_waitcnt vmcnt(27)
  v_pk_add_f32 v[32:33], v[32:33], v[48:49] op_sel:[0,0] op_sel_hi:[1,1]
  v_pk_add_f32 v[34:35], v[34:35], v[50:51] op_sel:[0,0] op_sel_hi:[1,1]
  s_waitcnt vmcnt(26)
  v_pk_add_f32 v[36:37], v[36:37], v[52:53] op_sel:[0,0] op_sel_hi:[1,1]
  v_pk_add_f32 v[38:39], v[38:39], v[54:55] op_sel:[0,0] op_sel_hi:[1,1]
  s_waitcnt vmcnt(25)
  v_pk_add_f32 v[32:33], v[32:33], v[56:57] op_sel:[0,0] op_sel_hi:[1,1]
  v_pk_add_f32 v[34:35], v[34:35], v[58:59] op_sel:[0,0] op_sel_hi:[1,1]
  s_waitcnt vmcnt(24)
  v_pk_add_f32 v[36:37], v[36:37], v[60:61] op_sel:[0,0] op_sel_hi:[1,1]
  v_pk_add_f32 v[38:39], v[38:39], v[62:63] op_sel:[0,0] op_sel_hi:[1,1]
  s_waitcnt vmcnt(23)
  v_pk_add_f32 v[32:33], v[32:33], v[64:65] op_sel:[0,0] op_sel_hi:[1,1]
  v_pk_add_f32 v[34:35], v[34:35], v[66:67] op_sel:[0,0] op_sel_hi:[1,1]
  s_waitcnt vmcnt(22)
  v_pk_add_f32 v[36:37], v[36:37], v[68:69] op_sel:[0,0] op_sel_hi:[1,1]
  v_pk_add_f32 v[38:39], v[38:39], v[70:71] op_sel:[0,0] op_sel_hi:[1,1]
  s_waitcnt vmcnt(21)
  v_pk_add_f32 v[32:33], v[32:33], v[72:73] op_sel:[0,0] op_sel_hi:[1,1]
  v_pk_add_f32 v[34:35], v[34:35], v[74:75] op_sel:[0,0] op_sel_hi:[1,1]
  s_waitcnt vmcnt(20)
  v_pk_add_f32 v[36:37], v[36:37], v[76:77] op_sel:[0,0] op_sel_hi:[1,1]
  v_pk_add_f32 v[38:39], v[38:39], v[78:79] op_sel:[0,0] op_sel_hi:[1,1]
  s_waitcnt vmcnt(19)
  v_pk_add_f32 v[32:33], v[32:33], v[80:81] op_sel:[0,0] op_sel_hi:[1,1]
  v_pk_add_f32 v[34:35], v[34:35], v[82:83] op_sel:[0,0] op_sel_hi:[1,1]
  s_waitcnt vmcnt(18)
  v_pk_add_f32 v[36:37], v[36:37], v[84:85] op_sel:[0,0] op_sel_hi:[1,1]
  v_pk_add_f32 v[38:39], v[38:39], v[86:87] op_sel:[0,0] op_sel_hi:[1,1]
  s_waitcnt vmcnt(17)
  v_pk_add_f32 v[32:33], v[32:33], v[88:89] op_sel:[0,0] op_sel_hi:[1,1]
  v_pk_add_f32 v[34:35], v[34:35], v[90:91] op_sel:[0,0] op_sel_hi:[1,1]
  s_waitcnt vmcnt(16)
  v_pk_add_f32 v[36:37], v[36:37], v[92:93] op_sel:[0,0] op_sel_hi:[1,1]
  v_pk_add_f32 v[38:39], v[38:39], v[94:95] op_sel:[0,0] op_sel_hi:[1,1]
  s_waitcnt vmcnt(15)
  v_pk_add_f32 v[32:33], v[32:33], v[96:97] op_sel:[0,0] op_sel_hi:[1,1]
  v_pk_add_f32 v[34:35], v[34:35], v[98:99] op_sel:[0,0] op_sel_hi:[1,1]
  s_waitcnt vmcnt(14)
  v_pk_add_f32 v[36:37], v[36:37], v[100:101] op_sel:[0,0] op_sel_hi:[1,1]
  v_pk_add_f32 v[38:39], v[38:39], v[102:103] op_sel:[0,0] op_sel_hi:[1,1]
  s_waitcnt vmcnt(13)
  v_pk_add_f32 v[32:33], v[32:33], v[104:105] op_sel:[0,0] op_sel_hi:[1,1]
  v_pk_add_f32 v[34:35], v[34:35], v[106:107] op_sel:[0,0] op_sel_hi:[1,1]
  s_waitcnt vmcnt(12)
  v_pk_add_f32 v[36:37], v[36:37], v[108:109] op_sel:[0,0] op_sel_hi:[1,1]
  v_pk_add_f32 v[38:39], v[38:39], v[110:111] op_sel:[0,0] op_sel_hi:[1,1]
  s_waitcnt vmcnt(11)
  v_pk_add_f32 v[32:33], v[32:33], v[112:113] op_sel:[0,0] op_sel_hi:[1,1]
  v_pk_add_f32 v[34:35], v[34:35], v[114:115] op_sel:[0,0] op_sel_hi:[1,1]
  s_waitcnt vmcnt(10)
  v_pk_add_f32 v[36:37], v[36:37], v[116:117] op_sel:[0,0] op_sel_hi:[1,1]
  v_pk_add_f32 v[38:39], v[38:39], v[118:119] op_sel:[0,0] op_sel_hi:[1,1]
  s_waitcnt vmcnt(9)
  v_pk_add_f32 v[32:33], v[32:33], v[120:121] op_sel:[0,0] op_sel_hi:[1,1]
  v_pk_add_f32 v[34:35], v[34:35], v[122:123] op_sel:[0,0] op_sel_hi:[1,1]
  s_waitcnt vmcnt(8)
  v_pk_add_f32 v[36:37], v[36:37], v[124:125] op_sel:[0,0] op_sel_hi:[1,1]
  v_pk_add_f32 v[38:39], v[38:39], v[126:127] op_sel:[0,0] op_sel_hi:[1,1]
  s_waitcnt vmcnt(7)
  v_pk_add_f32 v[32:33], v[32:33], v[128:129] op_sel:[0,0] op_sel_hi:[1,1]
  v_pk_add_f32 v[34:35], v[34:35], v[130:131] op_sel:[0,0] op_sel_hi:[1,1]
  s_waitcnt vmcnt(6)
  v_pk_add_f32 v[36:37], v[36:37], v[132:133] op_sel:[0,0] op_sel_hi:[1,1]
  v_pk_add_f32 v[38:39], v[38:39], v[134:135] op_sel:[0,0] op_sel_hi:[1,1]
  s_waitcnt vmcnt(5)
  v_pk_add_f32 v[32:33], v[32:33], v[136:137] op_sel:[0,0] op_sel_hi:[1,1]
  v_pk_add_f32 v[34:35], v[34:35], v[138:139] op_sel:[0,0] op_sel_hi:[1,1]
  s_waitcnt vmcnt(4)
  v_pk_add_f32 v[36:37], v[36:37], v[140:141] op_sel:[0,0] op_sel_hi:[1,1]
  v_pk_add_f32 v[38:39], v[38:39], v[142:143] op_sel:[0,0] op_sel_hi:[1,1]
  s_waitcnt vmcnt(3)
  v_pk_add_f32 v[32:33], v[32:33], v[144:145] op_sel:[0,0] op_sel_hi:[1,1]
  v_pk_add_f32 v[34:35], v[34:35], v[146:147] op_sel:[0,0] op_sel_hi:[1,1]
  s_waitcnt vmcnt(2)
  v_pk_add_f32 v[36:37], v[36:37], v[148:149] op_sel:[0,0] op_sel_hi:[1,1]
  v_pk_add_f32 v[38:39], v[38:39], v[150:151] op_sel:[0,0] op_sel_hi:[1,1]
  s_waitcnt vmcnt(1)
  v_pk_add_f32 v[32:33], v[32:33], v[152:153] op_sel:[0,0] op_sel_hi:[1,1]
  v_pk_add_f32 v[34:35], v[34:35], v[154:155] op_sel:[0,0] op_sel_hi:[1,1]
  s_waitcnt vmcnt(0)
  v_pk_add_f32 v[36:37], v[36:37], v[156:157] op_sel:[0,0] op_sel_hi:[1,1]
  v_pk_add_f32 v[38:39], v[38:39], v[158:159] op_sel:[0,0] op_sel_hi:[1,1]
  v_cvt_pk_bf16_f32 v4, v32, v36
  v_cvt_pk_bf16_f32 v5, v33, v37
  v_cvt_pk_bf16_f32 v6, v34, v38
  v_cvt_pk_bf16_f32 v7, v35, v39
  s_mov_b32 s80, 0
  s_mov_b32 s81, -1
  v_cndmask_b32 v7, v7, 0, s[80:81]
  buffer_store_dwordx4 v[4:7], v2, s[36:39], s85 offen sc1
  s_lshl_b32 s76, s2, 3
  s_add_u32 s76, s76, 15740928
  v_lshlrev_b32 v3, 8, v0
  s_waitcnt vmcnt(0) lgkmcnt(0)
  s_mov_b64 exec, 0xffff
  buffer_store_dwordx2 v[18:19], v3, s[36:39], s76 offen sc1
  s_endpgm
k_tail:
  v_mov_b32 v4, 114688
  ds_read_b64 v[6:7], v4
  s_mov_b32 s44, s18
  s_mov_b32 s45, s19
  s_mov_b32 s46, 896
  s_mov_b32 s47, 0x00020000
  s_mov_b32 s32, s20
  s_mov_b32 s33, s21
  s_mov_b32 s34, 1835008
  s_mov_b32 s35, 0x00020000
  v_bfe_u32 v3, v0, 4, 1
  v_lshlrev_b32 v3, 6, v3
  v_lshrrev_b32 v2, 5, v0
  v_lshl_add_u32 v3, v2, 3, v3
  s_lshl_b32 s76, s101, 7
  v_add_u32 v3, s76, v3
  s_lshl_b32 s76, s100, 2
  s_add_u32 s76, s76, s97
  s_lshl_b32 s76, s76, 4
  v_and_b32 v2, 15, v0
  v_add_u32 v2, s76, v2
  v_mul_u32_u24 v2, 896, v2
  v_add_u32 v2, v2, v3
  s_add_u32 s76, s97, 0
  s_and_b32 s76, s76, 3
  s_lshl_b32 s77, s100, 2
  s_add_u32 s76, s76, s77
  s_mul_i32 s56, s76, 57344
  s_mul_i32 s77, s97, 14336
  s_add_u32 s56, s56, s77
  s_lshl_b32 s60, s76, 14
  s_lshl_b32 s77, s97, 12
  s_add_u32 s60, s60, s77
  s_add_u32 s60, s60, 8388608
  s_add_u32 s76, s97, 1
  s_and_b32 s76, s76, 3
  s_mul_i32 s78, s76, 12288
  s_add_u32 s78, s78, 0
  v_add_u32 v8, s78, v13
  s_lshl_b32 s77, s100, 2
  s_add_u32 s76, s76, s77
  s_mul_i32 s57, s76, 57344
  s_mul_i32 s77, s97, 14336
  s_add_u32 s57, s57, s77
  s_lshl_b32 s61, s76, 14
  s_lshl_b32 s77, s97, 12
  s_add_u32 s61, s61, s77
  s_add_u32 s61, s61, 8388608
  s_add_u32 s76, s97, 2
  s_and_b32 s76, s76, 3
  s_mul_i32 s78, s76, 12288
  s_add_u32 s78, s78, 4096
  v_add_u32 v9, s78, v13
  s_lshl_b32 s77, s100, 2
  s_add_u32 s76, s76, s77
  s_mul_i32 s58, s76, 57344
  s_mul_i32 s77, s97, 14336
  s_add_u32 s58, s58, s77
  s_lshl_b32 s62, s76, 14
  s_lshl_b32 s77, s97, 12
  s_add_u32 s62, s62, s77
  s_add_u32 s62, s62, 8388608
  s_add_u32 s76, s97, 3
  s_and_b32 s76, s76, 3
  s_mul_i32 s78, s76, 12288
  s_add_u32 s78, s78, 8192
  v_add_u32 v10, s78, v13
  s_lshl_b32 s77, s100, 2
  s_add_u32 s76, s76, s77
  s_mul_i32 s59, s76, 57344
  s_mul_i32 s77, s97, 14336
  s_add_u32 s59, s59, s77
  s_lshl_b32 s63, s76, 14
  s_lshl_b32 s77, s97, 12
  s_add_u32 s63, s63, s77
  s_add_u32 s63, s63, 8388608
  s_mul_i32 s76, s97, 12288
  v_add_u32 v5, s76, v13
  s_lshl_b32 s64, s97, 13
  s_add_u32 s64, s64, 12582912
  s_add_u32 s65, s64, 4096
  s_waitcnt lgkmcnt(0)
  v_readfirstlane_b32 s6, v6
  v_readfirstlane_b32 s7, v7
  s_lshr_b32 s76, s100, 1
  s_lshl_b32 s55, s76, 7
  s_add_u32 s55, s55, 15732736
  s_mov_b32 s26, 0x7f
  s_mov_b32 s27, 0
  s_waitcnt vmcnt(0) lgkmcnt(0)
  s_barrier
  s_cmp_lg_u32 s97, 0
  s_cbranch_scc1 k_nocnt
  s_cmp_lt_i32 s3, 0
  s_cbranch_scc1 k_nocnt
  s_mov_b64 exec, 1
  buffer_store_dwordx2 v[6:7], off, s[36:39], s3 sc1
  s_mov_b64 exec, -1
  s_nop 1
k_nocnt:
  s_cmp_eq_u32 s96, 3
  s_cbranch_scc1 k_nopf
  s_cmp_lg_u32 s96, 1
  s_cbranch_scc1 k_nokv
  buffer_load_dwordx4 a[16:19], v13, s[36:39], s99 offen offset:0 sc1
  buffer_load_dwordx4 a[20:23], v13, s[36:39], s99 offen offset:1024 sc1
  buffer_load_dwordx4 a[24:27], v13, s[36:39], s99 offen offset:2048 sc1
  buffer_load_dwordx4 a[28:31], v13, s[36:39], s99 offen offset:3072 sc1
  s_add_u32 s99, s99, 4096
  s_lshl_b32 s99, s101, 4
  s_lshl_b32 s85, s97, 2
  s_add_u32 s99, s99, s85
  s_add_u32 s99, s99, 392
  s_lshl_b32 s99, s99, 12
  s_add_u32 s99, s99, 16777216
  buffer_load_dwordx4 a[32:35], v13, s[36:39], s99 offen offset:0 sc1
  buffer_load_dwordx4 a[36:39], v13, s[36:39], s99 offen offset:1024 sc1
  buffer_load_dwordx4 a[40:43], v13, s[36:39], s99 offen offset:2048 sc1
  buffer_load_dwordx4 a[44:47], v13, s[36:39], s99 offen offset:3072 sc1
  s_add_u32 s99, s99, 4096
  buffer_load_dwordx4 a[48:51], v13, s[36:39], s99 offen offset:0 sc1
  buffer_load_dwordx4 a[52:55], v13, s[36:39], s99 offen offset:1024 sc1
  buffer_load_dwordx4 a[56:59], v13, s[36:39], s99 offen offset:2048 sc1
  buffer_load_dwordx4 a[60:63], v13, s[36:39], s99 offen offset:3072 sc1
  s_add_u32 s99, s99, 4096
k_nokv:
k_nopf:
  buffer_load_dwordx2 v[240:241], v2, s[28:31], 0 offen offset:0
  buffer_load_dwordx2 v[248:249], v3, s[44:47], 0 offen offset:0
  buffer_load_dwordx2 v[242:243], v2, s[28:31], 0 offen offset:16
  buffer_load_dwordx2 v[250:251], v3, s[44:47], 0 offen offset:16
  buffer_load_dwordx2 v[244:245], v2, s[28:31], 0 offen offset:32
  buffer_load_dwordx2 v[252:253], v3, s[44:47], 0 offen offset:32
  buffer_load_dwordx2 v[246:247], v2, s[28:31], 0 offen offset:48
  buffer_load_dwordx2 v[254:255], v3, s[44:47], 0 offen offset:48
  s_cmp_lg_u32 s97, 0
  s_cbranch_scc1 k_go
  v_lshlrev_b32 v1, 3, v0
  s_mov_b64 exec, s[26:27]
  buffer_load_dwordx2 v[6:7], v1, s[36:39], s55 offen sc1
  s_mov_b64 exec, -1
  s_waitcnt vmcnt(0)
  v_cmp_eq_u64 s[76:77], s[6:7], v[6:7]
  s_mov_b32 s78, 0
  s_and_b64 s[76:77], s[76:77], s[26:27]
  s_cmp_eq_u64 s[76:77], s[26:27]
  s_cbranch_scc0 kp2_slow
kp2_ok:
k_go:
  s_barrier
  s_and_b32 s76, s2, 15
  s_lshl_b32 s76, s76, 2
  s_add_u32 s76, s76, s97
  s_lshl_b32 s66, s76, 6
  s_add_u32 s66, s66, 15740928
  s_lshr_b32 s77, s97, 1
  s_lshl_b32 s77, s77, 3
  s_add_u32 s55, s77, s55
  s_add_u32 s55, s55, 56
  s_mov_b32 s26, 1
  s_lshl_b32 s76, s97, 13
  s_add_u32 s76, s76, 115200
  v_add_u32 v11, s76, v13
  buffer_load_dwordx4 v[16:19], v13, s[36:39], s56 offen offset:0 sc1
  buffer_load_dwordx4 v[20:23], v13, s[36:39], s57 offen offset:0 sc1
  buffer_load_dwordx4 v[24:27], v13, s[36:39], s58 offen offset:0 sc1
  buffer_load_dwordx4 v[28:31], v13, s[36:39], s59 offen offset:0 sc1
  buffer_load_dwordx4 v[32:35], v13, s[36:39], s56 offen offset:1024 sc1
  buffer_load_dwordx4 v[36:39], v13, s[36:39], s57 offen offset:1024 sc1
  buffer_load_dwordx4 v[40:43], v13, s[36:39], s58 offen offset:1024 sc1
  buffer_load_dwordx4 v[44:47], v13, s[36:39], s59 offen offset:1024 sc1
  buffer_load_dwordx4 v[48:51], v13, s[36:39], s56 offen offset:2048 sc1
  buffer_load_dwordx4 v[52:55], v13, s[36:39], s57 offen offset:2048 sc1
  buffer_load_dwordx4 v[56:59], v13, s[36:39], s58 offen offset:2048 sc1
  buffer_load_dwordx4 v[60:63], v13, s[36:39], s59 offen offset:2048 sc1
  buffer_load_dwordx4 v[64:67], v13, s[36:39], s56 offen offset:3072 sc1
  buffer_load_dwordx4 v[68:71], v13, s[36:39], s57 offen offset:3072 sc1
  buffer_load_dwordx4 v[72:75], v13, s[36:39], s58 offen offset:3072 sc1
  buffer_load_dwordx4 v[76:79], v13, s[36:39], s59 offen offset:3072 sc1
  s_add_u32 s56, s56, 4096
  buffer_load_dwordx4 v[80:83], v13, s[36:39], s56 offen offset:0 sc1
  s_add_u32 s57, s57, 4096
  buffer_load_dwordx4 v[84:87], v13, s[36:39], s57 offen offset:0 sc1
  s_add_u32 s58, s58, 4096
  buffer_load_dwordx4 v[88:91], v13, s[36:39], s58 offen offset:0 sc1
  s_add_u32 s59, s59, 4096
  buffer_load_dwordx4 v[92:95], v13, s[36:39], s59 offen offset:0 sc1
  buffer_load_dwordx4 v[96:99], v13, s[36:39], s56 offen offset:1024 sc1
  buffer_load_dwordx4 v[100:103], v13, s[36:39], s57 offen offset:1024 sc1
  buffer_load_dwordx4 v[104:107], v13, s[36:39], s58 offen offset:1024 sc1
  buffer_load_dwordx4 v[108:111], v13, s[36:39], s59 offen offset:1024 sc1
  buffer_load_dwordx4 v[112:115], v13, s[36:39], s56 offen offset:2048 sc1
  buffer_load_dwordx4 v[116:119], v13, s[36:39], s57 offen offset:2048 sc1
  buffer_load_dwordx4 v[120:123], v13, s[36:39], s58 offen offset:2048 sc1
  buffer_load_dwordx4 v[124:127], v13, s[36:39], s59 offen offset:2048 sc1
  buffer_load_dwordx4 v[208:211], v13, s[36:39], s56 offen offset:3072 sc1
  buffer_load_dwordx4 v[212:215], v13, s[36:39], s57 offen offset:3072 sc1
  buffer_load_dwordx4 v[216:219], v13, s[36:39], s58 offen offset:3072 sc1
  buffer_load_dwordx4 v[220:223], v13, s[36:39], s59 offen offset:3072 sc1
  s_add_u32 s56, s56, 4096
  buffer_load_dwordx4 v[224:227], v13, s[36:39], s56 offen offset:0 sc1
  s_add_u32 s57, s57, 4096
  buffer_load_dwordx4 v[228:231], v13, s[36:39], s57 offen offset:0 sc1
  s_add_u32 s58, s58, 4096
  buffer_load_dwordx4 v[232:235], v13, s[36:39], s58 offen offset:0 sc1
  s_add_u32 s59, s59, 4096
  buffer_load_dwordx4 v[236:239], v13, s[36:39], s59 offen offset:0 sc1
  s_waitcnt vmcnt(35)
  v_mfma_f32_16x16x32_bf16 v[128:131], a[64:67], v[16:19], 0
  v_mfma_f32_16x16x32_bf16 v[132:135], a[68:71], v[16:19], 0
  v_mfma_f32_16x16x32_bf16 v[136:139], a[72:75], v[16:19], 0
  v_mfma_f32_16x16x32_bf16 v[140:143], a[76:79], v[16:19], 0
  s_waitcnt vmcnt(34)
  v_mfma_f32_16x16x32_bf16 v[144:147], a[64:67], v[20:23], 0
  v_mfma_f32_16x16x32_bf16 v[148:151], a[68:71], v[20:23], 0
  v_mfma_f32_16x16x32_bf16 v[152:155], a[72:75], v[20:23], 0
  v_mfma_f32_16x16x32_bf16 v[156:159], a[76:79], v[20:23], 0
  s_waitcnt vmcnt(33)
  v_mfma_f32_16x16x32_bf16 v[160:163], a[64:67], v[24:27], 0
  v_mfma_f32_16x16x32_bf16 v[164:167], a[68:71], v[24:27], 0
  v_mfma_f32_16x16x32_bf16 v[168:171], a[72:75], v[24:27], 0
  v_mfma_f32_16x16x32_bf16 v[172:175], a[76:79], v[24:27], 0
  s_waitcnt vmcnt(32)
  v_mfma_f32_16x16x32_bf16 v[176:179], a[64:67], v[28:31], 0
  v_mfma_f32_16x16x32_bf16 v[180:183], a[68:71], v[28:31], 0
  v_mfma_f32_16x16x32_bf16 v[184:187], a[72:75], v[28:31], 0
  v_mfma_f32_16x16x32_bf16 v[188:191], a[76:79], v[28:31], 0
  v_lshlrev_b32 v1, 3, v0
  s_mov_b64 exec, s[26:27]
  buffer_load_dwordx2 v[6:7], v1, s[36:39], s55 offen sc1
  s_mov_b64 exec, -1
  buffer_load_dwordx4 v[16:19], v13, s[36:39], s56 offen offset:1024 sc1
  buffer_load_dwordx4 v[20:23], v13, s[36:39], s57 offen offset:1024 sc1
  buffer_load_dwordx4 v[24:27], v13, s[36:39], s58 offen offset:1024 sc1
  buffer_load_dwordx4 v[28:31], v13, s[36:39], s59 offen offset:1024 sc1
  s_waitcnt vmcnt(36)
  v_mfma_f32_16x16x32_bf16 v[128:131], a[80:83], v[32:35], v[128:131]
  v_mfma_f32_16x16x32_bf16 v[132:135], a[84:87], v[32:35], v[132:135]
  v_mfma_f32_16x16x32_bf16 v[136:139], a[88:91], v[32:35], v[136:139]
  v_mfma_f32_16x16x32_bf16 v[140:143], a[92:95], v[32:35], v[140:143]
  s_waitcnt vmcnt(35)
  v_mfma_f32_16x16x32_bf16 v[144:147], a[80:83], v[36:39], v[144:147]
  v_mfma_f32_16x16x32_bf16 v[148:151], a[84:87], v[36:39], v[148:151]
  v_mfma_f32_16x16x32_bf16 v[152:155], a[88:91], v[36:39], v[152:155]
  v_mfma_f32_16x16x32_bf16 v[156:159], a[92:95], v[36:39], v[156:159]
  s_waitcnt vmcnt(34)
  v_mfma_f32_16x16x32_bf16 v[160:163], a[80:83], v[40:43], v[160:163]
  v_mfma_f32_16x16x32_bf16 v[164:167], a[84:87], v[40:43], v[164:167]
  v_mfma_f32_16x16x32_bf16 v[168:171], a[88:91], v[40:43], v[168:171]
  v_mfma_f32_16x16x32_bf16 v[172:175], a[92:95], v[40:43], v[172:175]
  s_waitcnt vmcnt(33)
  v_mfma_f32_16x16x32_bf16 v[176:179], a[80:83], v[44:47], v[176:179]
  v_mfma_f32_16x16x32_bf16 v[180:183], a[84:87], v[44:47], v[180:183]
  v_mfma_f32_16x16x32_bf16 v[184:187], a[88:91], v[44:47], v[184:187]
  v_mfma_f32_16x16x32_bf16 v[188:191], a[92:95], v[44:47], v[188:191]
  buffer_load_dwordx4 v[32:35], v13, s[36:39], s56 offen offset:2048 sc1
  buffer_load_dwordx4 v[36:39], v13, s[36:39], s57 offen offset:2048 sc1
  buffer_load_dwordx4 v[40:43], v13, s[36:39], s58 offen offset:2048 sc1
  buffer_load_dwordx4 v[44:47], v13, s[36:39], s59 offen offset:2048 sc1
  ds_read_b128 a[64:67], v11 offset:0
  ds_read_b128 a[68:71], v11 offset:1024
  ds_read_b128 a[72:75], v11 offset:2048
  ds_read_b128 a[76:79], v11 offset:3072
  s_waitcnt vmcnt(36)
  v_mfma_f32_16x16x32_bf16 v[128:131], a[96:99], v[48:51], v[128:131]
  v_mfma_f32_16x16x32_bf16 v[132:135], a[100:103], v[48:51], v[132:135]
  v_mfma_f32_16x16x32_bf16 v[136:139], a[104:107], v[48:51], v[136:139]
  v_mfma_f32_16x16x32_bf16 v[140:143], a[108:111], v[48:51], v[140:143]
  s_waitcnt vmcnt(35)
  v_mfma_f32_16x16x32_bf16 v[144:147], a[96:99], v[52:55], v[144:147]
  v_mfma_f32_16x16x32_bf16 v[148:151], a[100:103], v[52:55], v[148:151]
  v_mfma_f32_16x16x32_bf16 v[152:155], a[104:107], v[52:55], v[152:155]
  v_mfma_f32_16x16x32_bf16 v[156:159], a[108:111], v[52:55], v[156:159]
  s_waitcnt vmcnt(34)
  v_mfma_f32_16x16x32_bf16 v[160:163], a[96:99], v[56:59], v[160:163]
  v_mfma_f32_16x16x32_bf16 v[164:167], a[100:103], v[56:59], v[164:167]
  v_mfma_f32_16x16x32_bf16 v[168:171], a[104:107], v[56:59], v[168:171]
  v_mfma_f32_16x16x32_bf16 v[172:175], a[108:111], v[56:59], v[172:175]
  s_waitcnt vmcnt(33)
  v_mfma_f32_16x16x32_bf16 v[176:179], a[96:99], v[60:63], v[176:179]
  v_mfma_f32_16x16x32_bf16 v[180:183], a[100:103], v[60:63], v[180:183]
  v_mfma_f32_16x16x32_bf16 v[184:187], a[104:107], v[60:63], v[184:187]
  v_mfma_f32_16x16x32_bf16 v[188:191], a[108:111], v[60:63], v[188:191]
  buffer_load_dwordx4 v[48:51], v13, s[36:39], s56 offen offset:3072 sc1
  buffer_load_dwordx4 v[52:55], v13, s[36:39], s57 offen offset:3072 sc1
  buffer_load_dwordx4 v[56:59], v13, s[36:39], s58 offen offset:3072 sc1
  buffer_load_dwordx4 v[60:63], v13, s[36:39], s59 offen offset:3072 sc1
  ds_read_b128 a[80:83], v11 offset:4096
  ds_read_b128 a[84:87], v11 offset:5120
  ds_read_b128 a[88:91], v11 offset:6144
  ds_read_b128 a[92:95], v11 offset:7168
  s_waitcnt vmcnt(36)
  v_mfma_f32_16x16x32_bf16 v[128:131], a[112:115], v[64:67], v[128:131]
  v_mfma_f32_16x16x32_bf16 v[132:135], a[116:119], v[64:67], v[132:135]
  v_mfma_f32_16x16x32_bf16 v[136:139], a[120:123], v[64:67], v[136:139]
  v_mfma_f32_16x16x32_bf16 v[140:143], a[124:127], v[64:67], v[140:143]
  s_waitcnt vmcnt(35)
  v_mfma_f32_16x16x32_bf16 v[144:147], a[112:115], v[68:71], v[144:147]
  v_mfma_f32_16x16x32_bf16 v[148:151], a[116:119], v[68:71], v[148:151]
  v_mfma_f32_16x16x32_bf16 v[152:155], a[120:123], v[68:71], v[152:155]
  v_mfma_f32_16x16x32_bf16 v[156:159], a[124:127], v[68:71], v[156:159]
  s_waitcnt vmcnt(34)
  v_mfma_f32_16x16x32_bf16 v[160:163], a[112:115], v[72:75], v[160:163]
  v_mfma_f32_16x16x32_bf16 v[164:167], a[116:119], v[72:75], v[164:167]
  v_mfma_f32_16x16x32_bf16 v[168:171], a[120:123], v[72:75], v[168:171]
  v_mfma_f32_16x16x32_bf16 v[172:175], a[124:127], v[72:75], v[172:175]
  s_waitcnt vmcnt(33)
  v_mfma_f32_16x16x32_bf16 v[176:179], a[112:115], v[76:79], v[176:179]
  v_mfma_f32_16x16x32_bf16 v[180:183], a[116:119], v[76:79], v[180:183]
  v_mfma_f32_16x16x32_bf16 v[184:187], a[120:123], v[76:79], v[184:187]
  v_mfma_f32_16x16x32_bf16 v[188:191], a[124:127], v[76:79], v[188:191]
  s_waitcnt vmcnt(12)
  v_cmp_eq_u64 s[76:77], s[6:7], v[6:7]
  s_mov_b32 s78, 0
  s_and_b64 s[76:77], s[76:77], s[26:27]
  s_cmp_eq_u64 s[76:77], s[26:27]
  s_cbranch_scc0 kp2q_slow
kp2q_ok:
  s_mov_b32 s55, s66
  s_mov_b32 s26, 0xff
  buffer_load_dwordx4 v[64:67], v13, s[36:39], s60 offen offset:0 sc1
  buffer_load_dwordx4 v[68:71], v13, s[36:39], s61 offen offset:0 sc1
  buffer_load_dwordx4 v[72:75], v13, s[36:39], s62 offen offset:0 sc1
  buffer_load_dwordx4 v[76:79], v13, s[36:39], s63 offen offset:0 sc1
  v_mfma_f32_16x16x32_bf16 v[128:131], a[128:131], v[80:83], v[128:131]
  v_mfma_f32_16x16x32_bf16 v[132:135], a[132:135], v[80:83], v[132:135]
  v_mfma_f32_16x16x32_bf16 v[136:139], a[136:139], v[80:83], v[136:139]
  v_mfma_f32_16x16x32_bf16 v[140:143], a[140:143], v[80:83], v[140:143]
  v_mfma_f32_16x16x32_bf16 v[144:147], a[128:131], v[84:87], v[144:147]
  v_mfma_f32_16x16x32_bf16 v[148:151], a[132:135], v[84:87], v[148:151]
  v_mfma_f32_16x16x32_bf16 v[152:155], a[136:139], v[84:87], v[152:155]
  v_mfma_f32_16x16x32_bf16 v[156:159], a[140:143], v[84:87], v[156:159]
  v_mfma_f32_16x16x32_bf16 v[160:163], a[128:131], v[88:91], v[160:163]
  v_mfma_f32_16x16x32_bf16 v[164:167], a[132:135], v[88:91], v[164:167]
  v_mfma_f32_16x16x32_bf16 v[168:171], a[136:139], v[88:91], v[168:171]
  v_mfma_f32_16x16x32_bf16 v[172:175], a[140:143], v[88:91], v[172:175]
  v_mfma_f32_16x16x32_bf16 v[176:179], a[128:131], v[92:95], v[176:179]
  v_mfma_f32_16x16x32_bf16 v[180:183], a[132:135], v[92:95], v[180:183]
  v_mfma_f32_16x16x32_bf16 v[184:187], a[136:139], v[92:95], v[184:187]
  v_mfma_f32_16x16x32_bf16 v[188:191], a[140:143], v[92:95], v[188:191]
  buffer_load_dwordx4 v[80:83], v13, s[36:39], s60 offen offset:1024 sc1
  buffer_load_dwordx4 v[84:87], v13, s[36:39], s61 offen offset:1024 sc1
  buffer_load_dwordx4 v[88:91], v13, s[36:39], s62 offen offset:1024 sc1
  buffer_load_dwordx4 v[92:95], v13, s[36:39], s63 offen offset:1024 sc1
  v_mfma_f32_16x16x32_bf16 v[128:131], a[144:147], v[96:99], v[128:131]
  v_mfma_f32_16x16x32_bf16 v[132:135], a[148:151], v[96:99], v[132:135]
  v_mfma_f32_16x16x32_bf16 v[136:139], a[152:155], v[96:99], v[136:139]
  v_mfma_f32_16x16x32_bf16 v[140:143], a[156:159], v[96:99], v[140:143]
  v_mfma_f32_16x16x32_bf16 v[144:147], a[144:147], v[100:103], v[144:147]
  v_mfma_f32_16x16x32_bf16 v[148:151], a[148:151], v[100:103], v[148:151]
  v_mfma_f32_16x16x32_bf16 v[152:155], a[152:155], v[100:103], v[152:155]
  v_mfma_f32_16x16x32_bf16 v[156:159], a[156:159], v[100:103], v[156:159]
  v_mfma_f32_16x16x32_bf16 v[160:163], a[144:147], v[104:107], v[160:163]
  v_mfma_f32_16x16x32_bf16 v[164:167], a[148:151], v[104:107], v[164:167]
  v_mfma_f32_16x16x32_bf16 v[168:171], a[152:155], v[104:107], v[168:171]
  v_mfma_f32_16x16x32_bf16 v[172:175], a[156:159], v[104:107], v[172:175]
  v_mfma_f32_16x16x32_bf16 v[176:179], a[144:147], v[108:111], v[176:179]
  v_mfma_f32_16x16x32_bf16 v[180:183], a[148:151], v[108:111], v[180:183]
  v_mfma_f32_16x16x32_bf16 v[184:187], a[152:155], v[108:111], v[184:187]
  v_mfma_f32_16x16x32_bf16 v[188:191], a[156:159], v[108:111], v[188:191]
  buffer_load_dwordx4 v[96:99], v13, s[36:39], s60 offen offset:2048 sc1
  buffer_load_dwordx4 v[100:103], v13, s[36:39], s61 offen offset:2048 sc1
  buffer_load_dwordx4 v[104:107], v13, s[36:39], s62 offen offset:2048 sc1
  buffer_load_dwordx4 v[108:111], v13, s[36:39], s63 offen offset:2048 sc1
  v_mfma_f32_16x16x32_bf16 v[128:131], a[160:163], v[112:115], v[128:131]
  v_mfma_f32_16x16x32_bf16 v[132:135], a[164:167], v[112:115], v[132:135]
  v_mfma_f32_16x16x32_bf16 v[136:139], a[168:171], v[112:115], v[136:139]
  v_mfma_f32_16x16x32_bf16 v[140:143], a[172:175], v[112:115], v[140:143]
  v_mfma_f32_16x16x32_bf16 v[144:147], a[160:163], v[116:119], v[144:147]
  v_mfma_f32_16x16x32_bf16 v[148:151], a[164:167], v[116:119], v[148:151]
  v_mfma_f32_16x16x32_bf16 v[152:155], a[168:171], v[116:119], v[152:155]
  v_mfma_f32_16x16x32_bf16 v[156:159], a[172:175], v[116:119], v[156:159]
  v_mfma_f32_16x16x32_bf16 v[160:163], a[160:163], v[120:123], v[160:163]
  v_mfma_f32_16x16x32_bf16 v[164:167], a[164:167], v[120:123], v[164:167]
  v_mfma_f32_16x16x32_bf16 v[168:171], a[168:171], v[120:123], v[168:171]
  v_mfma_f32_16x16x32_bf16 v[172:175], a[172:175], v[120:123], v[172:175]
  v_mfma_f32_16x16x32_bf16 v[176:179], a[160:163], v[124:127], v[176:179]
  v_mfma_f32_16x16x32_bf16 v[180:183], a[164:167], v[124:127], v[180:183]
  v_mfma_f32_16x16x32_bf16 v[184:187], a[168:171], v[124:127], v[184:187]
  v_mfma_f32_16x16x32_bf16 v[188:191], a[172:175], v[124:127], v[188:191]
  buffer_load_dwordx4 v[112:115], v13, s[36:39], s60 offen offset:3072 sc1
  buffer_load_dwordx4 v[116:119], v13, s[36:39], s61 offen offset:3072 sc1
  buffer_load_dwordx4 v[120:123], v13, s[36:39], s62 offen offset:3072 sc1
  buffer_load_dwordx4 v[124:127], v13, s[36:39], s63 offen offset:3072 sc1
  v_mfma_f32_16x16x32_bf16 v[128:131], a[176:179], v[208:211], v[128:131]
  v_mfma_f32_16x16x32_bf16 v[132:135], a[180:183], v[208:211], v[132:135]
  v_mfma_f32_16x16x32_bf16 v[136:139], a[184:187], v[208:211], v[136:139]
  v_mfma_f32_16x16x32_bf16 v[140:143], a[188:191], v[208:211], v[140:143]
  v_mfma_f32_16x16x32_bf16 v[144:147], a[176:179], v[212:215], v[144:147]
  v_mfma_f32_16x16x32_bf16 v[148:151], a[180:183], v[212:215], v[148:151]
  v_mfma_f32_16x16x32_bf16 v[152:155], a[184:187], v[212:215], v[152:155]
  v_mfma_f32_16x16x32_bf16 v[156:159], a[188:191], v[212:215], v[156:159]
  v_mfma_f32_16x16x32_bf16 v[160:163], a[176:179], v[216:219], v[160:163]
  v_mfma_f32_16x16x32_bf16 v[164:167], a[180:183], v[216:219], v[164:167]
  v_mfma_f32_16x16x32_bf16 v[168:171], a[184:187], v[216:219], v[168:171]
  v_mfma_f32_16x16x32_bf16 v[172:175], a[188:191], v[216:219], v[172:175]
  v_mfma_f32_16x16x32_bf16 v[176:179], a[176:179], v[220:223], v[176:179]
  v_mfma_f32_16x16x32_bf16 v[180:183], a[180:183], v[220:223], v[180:183]
  v_mfma_f32_16x16x32_bf16 v[184:187], a[184:187], v[220:223], v[184:187]
  v_mfma_f32_16x16x32_bf16 v[188:191], a[188:191], v[220:223], v[188:191]
  v_lshlrev_b32 v1, 3, v0
  s_mov_b64 exec, s[26:27]
  buffer_load_dwordx2 v[6:7], v1, s[36:39], s55 offen sc1
  s_mov_b64 exec, -1
  s_add_u32 s56, s56, 4096
  buffer_load_dwordx4 a[176:179], v13, s[36:39], s56 offen offset:0 sc1
  s_add_u32 s57, s57, 4096
  buffer_load_dwordx4 a[180:183], v13, s[36:39], s57 offen offset:0 sc1
  s_add_u32 s58, s58, 4096
  buffer_load_dwordx4 a[184:187], v13, s[36:39], s58 offen offset:0 sc1
  s_add_u32 s59, s59, 4096
  buffer_load_dwordx4 a[188:191], v13, s[36:39], s59 offen offset:0 sc1
  v_mfma_f32_16x16x32_bf16 v[128:131], a[192:195], v[224:227], v[128:131]
  v_mfma_f32_16x16x32_bf16 v[132:135], a[196:199], v[224:227], v[132:135]
  v_mfma_f32_16x16x32_bf16 v[136:139], a[200:203], v[224:227], v[136:139]
  v_mfma_f32_16x16x32_bf16 v[140:143], a[204:207], v[224:227], v[140:143]
  v_mfma_f32_16x16x32_bf16 v[144:147], a[192:195], v[228:231], v[144:147]
  v_mfma_f32_16x16x32_bf16 v[148:151], a[196:199], v[228:231], v[148:151]
  v_mfma_f32_16x16x32_bf16 v[152:155], a[200:203], v[228:231], v[152:155]
  v_mfma_f32_16x16x32_bf16 v[156:159], a[204:207], v[228:231], v[156:159]
  v_mfma_f32_16x16x32_bf16 v[160:163], a[192:195], v[232:235], v[160:163]
  v_mfma_f32_16x16x32_bf16 v[164:167], a[196:199], v[232:235], v[164:167]
  v_mfma_f32_16x16x32_bf16 v[168:171], a[200:203], v[232:235], v[168:171]
  v_mfma_f32_16x16x32_bf16 v[172:175], a[204:207], v[232:235], v[172:175]
  v_mfma_f32_16x16x32_bf16 v[176:179], a[192:195], v[236:239], v[176:179]
  v_mfma_f32_16x16x32_bf16 v[180:183], a[196:199], v[236:239], v[180:183]
  v_mfma_f32_16x16x32_bf16 v[184:187], a[200:203], v[236:239], v[184:187]
  v_mfma_f32_16x16x32_bf16 v[188:191], a[204:207], v[236:239], v[188:191]
  buffer_load_dwordx4 a[192:195], v13, s[36:39], s56 offen offset:1024 sc1
  buffer_load_dwordx4 a[196:199], v13, s[36:39], s57 offen offset:1024 sc1
  buffer_load_dwordx4 a[200:203], v13, s[36:39], s58 offen offset:1024 sc1
  buffer_load_dwordx4 a[204:207], v13, s[36:39], s59 offen offset:1024 sc1
  s_waitcnt vmcnt(36)
  v_mfma_f32_16x16x32_bf16 v[128:131], a[208:211], v[16:19], v[128:131]
  v_mfma_f32_16x16x32_bf16 v[132:135], a[212:215], v[16:19], v[132:135]
  v_mfma_f32_16x16x32_bf16 v[136:139], a[216:219], v[16:19], v[136:139]
  v_mfma_f32_16x16x32_bf16 v[140:143], a[220:223], v[16:19], v[140:143]
  s_waitcnt vmcnt(35)
  v_mfma_f32_16x16x32_bf16 v[144:147], a[208:211], v[20:23], v[144:147]
  v_mfma_f32_16x16x32_bf16 v[148:151], a[212:215], v[20:23], v[148:151]
  v_mfma_f32_16x16x32_bf16 v[152:155], a[216:219], v[20:23], v[152:155]
  v_mfma_f32_16x16x32_bf16 v[156:159], a[220:223], v[20:23], v[156:159]
  s_waitcnt vmcnt(34)
  v_mfma_f32_16x16x32_bf16 v[160:163], a[208:211], v[24:27], v[160:163]
  v_mfma_f32_16x16x32_bf16 v[164:167], a[212:215], v[24:27], v[164:167]
  v_mfma_f32_16x16x32_bf16 v[168:171], a[216:219], v[24:27], v[168:171]
  v_mfma_f32_16x16x32_bf16 v[172:175], a[220:223], v[24:27], v[172:175]
  s_waitcnt vmcnt(33)
  v_mfma_f32_16x16x32_bf16 v[176:179], a[208:211], v[28:31], v[176:179]
  v_mfma_f32_16x16x32_bf16 v[180:183], a[212:215], v[28:31], v[180:183]
  v_mfma_f32_16x16x32_bf16 v[184:187], a[216:219], v[28:31], v[184:187]
  v_mfma_f32_16x16x32_bf16 v[188:191], a[220:223], v[28:31], v[188:191]
  s_waitcnt vmcnt(8)
  v_cmp_eq_u64 s[76:77], s[6:7], v[6:7]
  s_mov_b32 s78, 0
  s_and_b64 s[76:77], s[76:77], s[26:27]
  s_cmp_eq_u64 s[76:77], s[26:27]
  s_cbranch_scc0 kp2k_slow
kp2k_ok:
  buffer_load_dwordx4 a[96:99], v13, s[36:39], s64 offen offset:0 sc1
  buffer_load_dwordx4 a[100:103], v13, s[36:39], s64 offen offset:1024 sc1
  buffer_load_dwordx4 a[104:107], v13, s[36:39], s64 offen offset:2048 sc1
  buffer_load_dwordx4 a[108:111], v13, s[36:39], s64 offen offset:3072 sc1
  buffer_load_dwordx4 a[112:115], v13, s[36:39], s65 offen offset:0 sc1
  buffer_load_dwordx4 a[116:119], v13, s[36:39], s65 offen offset:1024 sc1
  buffer_load_dwordx4 a[120:123], v13, s[36:39], s65 offen offset:2048 sc1
  buffer_load_dwordx4 a[124:127], v13, s[36:39], s65 offen offset:3072 sc1
  v_mfma_f32_16x16x32_bf16 v[128:131], a[224:227], v[32:35], v[128:131]
  v_mfma_f32_16x16x32_bf16 v[132:135], a[228:231], v[32:35], v[132:135]
  v_mfma_f32_16x16x32_bf16 v[136:139], a[232:235], v[32:35], v[136:139]
  v_mfma_f32_16x16x32_bf16 v[140:143], a[236:239], v[32:35], v[140:143]
  v_mfma_f32_16x16x32_bf16 v[144:147], a[224:227], v[36:39], v[144:147]
  v_mfma_f32_16x16x32_bf16 v[148:151], a[228:231], v[36:39], v[148:151]
  v_mfma_f32_16x16x32_bf16 v[152:155], a[232:235], v[36:39], v[152:155]
  v_mfma_f32_16x16x32_bf16 v[156:159], a[236:239], v[36:39], v[156:159]
  v_mfma_f32_16x16x32_bf16 v[160:163], a[224:227], v[40:43], v[160:163]
  v_mfma_f32_16x16x32_bf16 v[164:167], a[228:231], v[40:43], v[164:167]
  v_mfma_f32_16x16x32_bf16 v[168:171], a[232:235], v[40:43], v[168:171]
  v_mfma_f32_16x16x32_bf16 v[172:175], a[236:239], v[40:43], v[172:175]
  v_mfma_f32_16x16x32_bf16 v[176:179], a[224:227], v[44:47], v[176:179]
  v_mfma_f32_16x16x32_bf16 v[180:183], a[228:231], v[44:47], v[180:183]
  v_mfma_f32_16x16x32_bf16 v[184:187], a[232:235], v[44:47], v[184:187]
  v_mfma_f32_16x16x32_bf16 v[188:191], a[236:239], v[44:47], v[188:191]
  v_mfma_f32_16x16x32_bf16 v[128:131], a[240:243], v[48:51], v[128:131]
  v_mfma_f32_16x16x32_bf16 v[132:135], a[244:247], v[48:51], v[132:135]
  v_mfma_f32_16x16x32_bf16 v[136:139], a[248:251], v[48:51], v[136:139]
  v_mfma_f32_16x16x32_bf16 v[140:143], a[252:255], v[48:51], v[140:143]
  v_mfma_f32_16x16x32_bf16 v[144:147], a[240:243], v[52:55], v[144:147]
  v_mfma_f32_16x16x32_bf16 v[148:151], a[244:247], v[52:55], v[148:151]
  v_mfma_f32_16x16x32_bf16 v[152:155], a[248:251], v[52:55], v[152:155]
  v_mfma_f32_16x16x32_bf16 v[156:159], a[252:255], v[52:55], v[156:159]
  v_mfma_f32_16x16x32_bf16 v[160:163], a[240:243], v[56:59], v[160:163]
  v_mfma_f32_16x16x32_bf16 v[164:167], a[244:247], v[56:59], v[164:167]
  v_mfma_f32_16x16x32_bf16 v[168:171], a[248:251], v[56:59], v[168:171]
  v_mfma_f32_16x16x32_bf16 v[172:175], a[252:255], v[56:59], v[172:175]
  v_mfma_f32_16x16x32_bf16 v[176:179], a[240:243], v[60:63], v[176:179]
  v_mfma_f32_16x16x32_bf16 v[180:183], a[244:247], v[60:63], v[180:183]
  v_mfma_f32_16x16x32_bf16 v[184:187], a[248:251], v[60:63], v[184:187]
  v_mfma_f32_16x16x32_bf16 v[188:191], a[252:255], v[60:63], v[188:191]
  s_waitcnt vmcnt(15)
  v_mfma_f32_16x16x32_bf16 v[128:131], a[0:3], a[176:179], v[128:131]
  v_lshlrev_b32 v16, 16, v248
  v_mfma_f32_16x16x32_bf16 v[132:135], a[4:7], a[176:179], v[132:135]
  v_and_b32 v20, 0xffff0000, v248
  v_mfma_f32_16x16x32_bf16 v[136:139], a[8:11], a[176:179], v[136:139]
  v_lshlrev_b32 v24, 16, v249
  v_mfma_f32_16x16x32_bf16 v[140:143], a[12:15], a[176:179], v[140:143]
  v_and_b32 v28, 0xffff0000, v249
  s_waitcnt vmcnt(14)
  v_mfma_f32_16x16x32_bf16 v[144:147], a[0:3], a[180:183], v[144:147]
  v_lshlrev_b32 v17, 16, v250
  v_mfma_f32_16x16x32_bf16 v[148:151], a[4:7], a[180:183], v[148:151]
  v_and_b32 v21, 0xffff0000, v250
  v_mfma_f32_16x16x32_bf16 v[152:155], a[8:11], a[180:183], v[152:155]
  v_lshlrev_b32 v25, 16, v251
  v_mfma_f32_16x16x32_bf16 v[156:159], a[12:15], a[180:183], v[156:159]
  v_and_b32 v29, 0xffff0000, v251
  s_waitcnt vmcnt(13)
  v_mfma_f32_16x16x32_bf16 v[160:163], a[0:3], a[184:187], v[160:163]
  v_lshlrev_b32 v18, 16, v252
  v_mfma_f32_16x16x32_bf16 v[164:167], a[4:7], a[184:187], v[164:167]
  v_and_b32 v22, 0xffff0000, v252
  v_mfma_f32_16x16x32_bf16 v[168:171], a[8:11], a[184:187], v[168:171]
  v_lshlrev_b32 v26, 16, v253
  v_mfma_f32_16x16x32_bf16 v[172:175], a[12:15], a[184:187], v[172:175]
  v_and_b32 v30, 0xffff0000, v253
  s_waitcnt vmcnt(12)
  v_mfma_f32_16x16x32_bf16 v[176:179], a[0:3], a[188:191], v[176:179]
  v_lshlrev_b32 v19, 16, v254
  v_mfma_f32_16x16x32_bf16 v[180:183], a[4:7], a[188:191], v[180:183]
  v_and_b32 v23, 0xffff0000, v254
  v_mfma_f32_16x16x32_bf16 v[184:187], a[8:11], a[188:191], v[184:187]
  v_lshlrev_b32 v27, 16, v255
  v_mfma_f32_16x16x32_bf16 v[188:191], a[12:15], a[188:191], v[188:191]
  v_and_b32 v31, 0xffff0000, v255
  s_waitcnt vmcnt(7)
  v_mfma_f32_16x16x32_bf16 v[208:211], a[96:99], v[64:67], 0
  s_waitcnt vmcnt(6)
  v_mfma_f32_16x16x32_bf16 v[212:215], a[100:103], v[64:67], 0
  v_mfma_f32_16x16x32_bf16 v[216:219], a[96:99], v[68:71], 0
  v_mfma_f32_16x16x32_bf16 v[220:223], a[100:103], v[68:71], 0
  v_mfma_f32_16x16x32_bf16 v[224:227], a[96:99], v[72:75], 0
  v_mfma_f32_16x16x32_bf16 v[228:231], a[100:103], v[72:75], 0
  v_mfma_f32_16x16x32_bf16 v[232:235], a[96:99], v[76:79], 0
  v_mfma_f32_16x16x32_bf16 v[236:239], a[100:103], v[76:79], 0
  v_mfma_f32_16x16x32_bf16 v[144:147], a[16:19], a[196:199], v[144:147]
  v_mfma_f32_16x16x32_bf16 v[148:151], a[20:23], a[196:199], v[148:151]
  v_add_f32 v215, 0x358637bd, v215
  v_rcp_f32 v215, v215
  s_nop 0
  v_pk_mul_f32 v[208:209], v[208:209], v[214:215] op_sel:[0,1] op_sel_hi:[1,1]
  v_pk_mul_f32 v[210:211], v[210:211], v[214:215] op_sel:[0,1] op_sel_hi:[1,1]
  v_mfma_f32_16x16x32_bf16 v[152:155], a[24:27], a[196:199], v[152:155]
  v_pk_mul_f32 v[212:213], v[212:213], v[214:215] op_sel:[0,1] op_sel_hi:[1,1]
  v_mul_f32 v214, v214, v215
  v_cvt_pk_bf16_f32 v64, v208, v212
  v_mfma_f32_16x16x32_bf16 v[156:159], a[28:31], a[196:199], v[156:159]
  v_cvt_pk_bf16_f32 v65, v209, v213
  v_cvt_pk_bf16_f32 v66, v210, v214
  v_cvt_pk_bf16_f32 v67, v211, 0
  v_mfma_f32_16x16x32_bf16 v[160:163], a[16:19], a[200:203], v[160:163]
  s_waitcnt vmcnt(5)
  v_mfma_f32_16x16x32_bf16 v[208:211], a[104:107], v[80:83], 0
  s_waitcnt vmcnt(4)
  v_mfma_f32_16x16x32_bf16 v[212:215], a[108:111], v[80:83], 0
  v_add_f32 v223, 0x358637bd, v223
  v_mfma_f32_16x16x32_bf16 v[164:167], a[20:23], a[200:203], v[164:167]
  v_rcp_f32 v223, v223
  s_nop 0
  v_pk_mul_f32 v[216:217], v[216:217], v[222:223] op_sel:[0,1] op_sel_hi:[1,1]
  v_pk_mul_f32 v[218:219], v[218:219], v[222:223] op_sel:[0,1] op_sel_hi:[1,1]
  v_mfma_f32_16x16x32_bf16 v[168:171], a[24:27], a[200:203], v[168:171]
  v_pk_mul_f32 v[220:221], v[220:221], v[222:223] op_sel:[0,1] op_sel_hi:[1,1]
  v_mul_f32 v222, v222, v223
  v_cvt_pk_bf16_f32 v68, v216, v220
  v_cvt_pk_bf16_f32 v69, v217, v221
  v_mfma_f32_16x16x32_bf16 v[172:175], a[28:31], a[200:203], v[172:175]
  v_cvt_pk_bf16_f32 v70, v218, v222
  v_cvt_pk_bf16_f32 v71, v219, 0
  v_mfma_f32_16x16x32_bf16 v[216:219], a[104:107], v[84:87], 0
  v_mfma_f32_16x16x32_bf16 v[176:179], a[16:19], a[204:207], v[176:179]
  v_mfma_f32_16x16x32_bf16 v[220:223], a[108:111], v[84:87], 0
  v_add_f32 v231, 0x358637bd, v231
  v_rcp_f32 v231, v231
  ds_write_b128 v8, v[144:147] offset:0
  v_mfma_f32_16x16x32_bf16 v[180:183], a[20:23], a[204:207], v[180:183]
  v_pk_mul_f32 v[224:225], v[224:225], v[230:231] op_sel:[0,1] op_sel_hi:[1,1]
  v_pk_mul_f32 v[226:227], v[226:227], v[230:231] op_sel:[0,1] op_sel_hi:[1,1]
  v_pk_mul_f32 v[228:229], v[228:229], v[230:231] op_sel:[0,1] op_sel_hi:[1,1]
  ds_write_b128 v8, v[148:151] offset:1024
  v_mfma_f32_16x16x32_bf16 v[184:187], a[24:27], a[204:207], v[184:187]
  v_mul_f32 v230, v230, v231
  v_cvt_pk_bf16_f32 v72, v224, v228
  v_cvt_pk_bf16_f32 v73, v225, v229
  ds_write_b128 v8, v[152:155] offset:2048
  v_mfma_f32_16x16x32_bf16 v[188:191], a[28:31], a[204:207], v[188:191]
  v_cvt_pk_bf16_f32 v74, v226, v230
  v_cvt_pk_bf16_f32 v75, v227, 0
  v_mfma_f32_16x16x32_bf16 v[224:227], a[104:107], v[88:91], 0
  v_mfma_f32_16x16x32_bf16 v[228:231], a[108:111], v[88:91], 0
  ds_write_b128 v8, v[156:159] offset:3072
  v_mfma_f32_16x16x32_bf16 v[128:131], a[16:19], a[192:195], v[128:131]
  v_add_f32 v239, 0x358637bd, v239
  v_rcp_f32 v239, v239
  s_nop 0
  v_pk_mul_f32 v[232:233], v[232:233], v[238:239] op_sel:[0,1] op_sel_hi:[1,1]
  ds_write_b128 v9, v[160:163] offset:0
  v_mfma_f32_16x16x32_bf16 v[132:135], a[20:23], a[192:195], v[132:135]
  v_pk_mul_f32 v[234:235], v[234:235], v[238:239] op_sel:[0,1] op_sel_hi:[1,1]
  v_pk_mul_f32 v[236:237], v[236:237], v[238:239] op_sel:[0,1] op_sel_hi:[1,1]
  v_mul_f32 v238, v238, v239
  ds_write_b128 v9, v[164:167] offset:1024
  v_mfma_f32_16x16x32_bf16 v[136:139], a[24:27], a[192:195], v[136:139]
  v_cvt_pk_bf16_f32 v76, v232, v236
  v_cvt_pk_bf16_f32 v77, v233, v237
  v_cvt_pk_bf16_f32 v78, v234, v238
  ds_write_b128 v9, v[168:171] offset:2048
  v_mfma_f32_16x16x32_bf16 v[140:143], a[28:31], a[192:195], v[140:143]
  v_cvt_pk_bf16_f32 v79, v235, 0
  v_mfma_f32_16x16x32_bf16 v[232:235], a[104:107], v[92:95], 0
  v_mfma_f32_16x16x32_bf16 v[236:239], a[108:111], v[92:95], 0
  ds_write_b128 v9, v[172:175] offset:3072
  s_waitcnt lgkmcnt(14)
  ds_write_b128 v10, v[176:179] offset:0
  ds_write_b128 v10, v[180:183] offset:1024
  s_waitcnt lgkmcnt(14)
  ds_write_b128 v10, v[184:187] offset:2048
  ds_write_b128 v10, v[188:191] offset:3072
  s_waitcnt lgkmcnt(14)
  v_pk_add_f32 v[128:129], v[128:129], v[16:17] op_sel:[0,0] op_sel_hi:[1,1]
  v_pk_add_f32 v[130:131], v[130:131], v[18:19] op_sel:[0,0] op_sel_hi:[1,1]
  v_pk_add_f32 v[132:133], v[132:133], v[20:21] op_sel:[0,0] op_sel_hi:[1,1]
  v_pk_add_f32 v[134:135], v[134:135], v[22:23] op_sel:[0,0] op_sel_hi:[1,1]
  v_pk_add_f32 v[136:137], v[136:137], v[24:25] op_sel:[0,0] op_sel_hi:[1,1]
  v_pk_add_f32 v[138:139], v[138:139], v[26:27] op_sel:[0,0] op_sel_hi:[1,1]
  v_pk_add_f32 v[140:141], v[140:141], v[28:29] op_sel:[0,0] op_sel_hi:[1,1]
  v_pk_add_f32 v[142:143], v[142:143], v[30:31] op_sel:[0,0] op_sel_hi:[1,1]
  v_mfma_f32_16x16x32_bf16 a[128:131], a[32:35], v[68:71], 0
  v_add_f32 v215, 0x358637bd, v215
  v_rcp_f32 v215, v215
  s_nop 0
  v_pk_mul_f32 v[208:209], v[208:209], v[214:215] op_sel:[0,1] op_sel_hi:[1,1]
  v_mfma_f32_16x16x32_bf16 a[132:135], a[36:39], v[68:71], 0
  v_pk_mul_f32 v[210:211], v[210:211], v[214:215] op_sel:[0,1] op_sel_hi:[1,1]
  v_pk_mul_f32 v[212:213], v[212:213], v[214:215] op_sel:[0,1] op_sel_hi:[1,1]
  v_mul_f32 v214, v214, v215
  s_waitcnt lgkmcnt(0)
  s_barrier
  v_mfma_f32_16x16x32_bf16 a[136:139], a[40:43], v[68:71], 0
  v_cvt_pk_bf16_f32 v80, v208, v212
  v_cvt_pk_bf16_f32 v81, v209, v213
  v_cvt_pk_bf16_f32 v82, v210, v214
  ds_read_b128 v[144:147], v5 offset:0
  v_mfma_f32_16x16x32_bf16 a[140:143], a[44:47], v[68:71], 0
  v_cvt_pk_bf16_f32 v83, v211, 0
  s_waitcnt vmcnt(3)
  v_mfma_f32_16x16x32_bf16 v[208:211], a[112:115], v[96:99], 0
  s_waitcnt vmcnt(2)
  v_mfma_f32_16x16x32_bf16 v[212:215], a[116:119], v[96:99], 0
  ds_read_b128 v[148:151], v5 offset:1024
  v_mfma_f32_16x16x32_bf16 a[144:147], a[32:35], v[72:75], 0
  v_add_f32 v223, 0x358637bd, v223
  v_rcp_f32 v223, v223
  s_nop 0
  v_pk_mul_f32 v[216:217], v[216:217], v[222:223] op_sel:[0,1] op_sel_hi:[1,1]
  ds_read_b128 v[152:155], v5 offset:2048
  v_mfma_f32_16x16x32_bf16 a[148:151], a[36:39], v[72:75], 0
  v_pk_mul_f32 v[218:219], v[218:219], v[222:223] op_sel:[0,1] op_sel_hi:[1,1]
  v_pk_mul_f32 v[220:221], v[220:221], v[222:223] op_sel:[0,1] op_sel_hi:[1,1]
  v_mul_f32 v222, v222, v223
  ds_read_b128 v[156:159], v5 offset:3072
  v_mfma_f32_16x16x32_bf16 a[152:155], a[40:43], v[72:75], 0
  v_cvt_pk_bf16_f32 v84, v216, v220
  v_cvt_pk_bf16_f32 v85, v217, v221
  v_cvt_pk_bf16_f32 v86, v218, v222
  ds_read_b128 v[160:163], v5 offset:4096
  v_mfma_f32_16x16x32_bf16 a[156:159], a[44:47], v[72:75], 0
  v_cvt_pk_bf16_f32 v87, v219, 0
  v_mfma_f32_16x16x32_bf16 v[216:219], a[112:115], v[100:103], 0
  v_mfma_f32_16x16x32_bf16 v[220:223], a[116:119], v[100:103], 0
  ds_read_b128 v[164:167], v5 offset:5120
  v_mfma_f32_16x16x32_bf16 a[160:163], a[32:35], v[76:79], 0
  v_add_f32 v231, 0x358637bd, v231
  v_rcp_f32 v231, v231
  s_nop 0
  v_pk_mul_f32 v[224:225], v[224:225], v[230:231] op_sel:[0,1] op_sel_hi:[1,1]
  v_mfma_f32_16x16x32_bf16 a[164:167], a[36:39], v[76:79], 0
  v_pk_mul_f32 v[226:227], v[226:227], v[230:231] op_sel:[0,1] op_sel_hi:[1,1]
  v_pk_mul_f32 v[228:229], v[228:229], v[230:231] op_sel:[0,1] op_sel_hi:[1,1]
  v_mul_f32 v230, v230, v231
  ds_read_b128 v[168:171], v5 offset:6144
  v_mfma_f32_16x16x32_bf16 a[168:171], a[40:43], v[76:79], 0
  v_cvt_pk_bf16_f32 v88, v224, v228
  v_cvt_pk_bf16_f32 v89, v225, v229
  v_cvt_pk_bf16_f32 v90, v226, v230
  ds_read_b128 v[172:175], v5 offset:7168
  v_mfma_f32_16x16x32_bf16 a[172:175], a[44:47], v[76:79], 0
  v_cvt_pk_bf16_f32 v91, v227, 0
  v_mfma_f32_16x16x32_bf16 v[224:227], a[112:115], v[104:107], 0
  v_mfma_f32_16x16x32_bf16 v[228:231], a[116:119], v[104:107], 0
  ds_read_b128 v[176:179], v5 offset:8192
  v_mfma_f32_16x16x32_bf16 v[192:195], a[32:35], v[64:67], 0
  v_add_f32 v239, 0x358637bd, v239
  v_rcp_f32 v239, v239
  s_nop 0
  v_pk_mul_f32 v[232:233], v[232:233], v[238:239] op_sel:[0,1] op_sel_hi:[1,1]
  ds_read_b128 v[180:183], v5 offset:9216
  v_mfma_f32_16x16x32_bf16 v[196:199], a[36:39], v[64:67], 0
  v_pk_mul_f32 v[234:235], v[234:235], v[238:239] op_sel:[0,1] op_sel_hi:[1,1]
  v_pk_mul_f32 v[236:237], v[236:237], v[238:239] op_sel:[0,1] op_sel_hi:[1,1]
  v_mul_f32 v238, v238, v239
  ds_read_b128 v[184:187], v5 offset:10240
  v_mfma_f32_16x16x32_bf16 v[200:203], a[40:43], v[64:67], 0
  v_cvt_pk_bf16_f32 v92, v232, v236
  v_cvt_pk_bf16_f32 v93, v233, v237
  v_cvt_pk_bf16_f32 v94, v234, v238
  ds_read_b128 v[188:191], v5 offset:11264
  v_mfma_f32_16x16x32_bf16 v[204:207], a[44:47], v[64:67], 0
  v_cvt_pk_bf16_f32 v95, v235, 0
  v_mfma_f32_16x16x32_bf16 v[232:235], a[112:115], v[108:111], 0
  v_mfma_f32_16x16x32_bf16 v[236:239], a[116:119], v[108:111], 0
  v_mfma_f32_16x16x32_bf16 a[128:131], a[48:51], v[84:87], a[128:131]
  v_add_f32 v215, 0x358637bd, v215
  v_rcp_f32 v215, v215
  s_nop 0
  v_pk_mul_f32 v[208:209], v[208:209], v[214:215] op_sel:[0,1] op_sel_hi:[1,1]
  v_mfma_f32_16x16x32_bf16 a[132:135], a[52:55], v[84:87], a[132:135]
  v_pk_mul_f32 v[210:211], v[210:211], v[214:215] op_sel:[0,1] op_sel_hi:[1,1]
  v_pk_mul_f32 v[212:213], v[212:213], v[214:215] op_sel:[0,1] op_sel_hi:[1,1]
  v_mul_f32 v214, v214, v215
  s_waitcnt lgkmcnt(11)
  v_pk_add_f32 v[128:129], v[128:129], v[144:145] op_sel:[0,0] op_sel_hi:[1,1]
  v_pk_add_f32 v[130:131], v[130:131], v[146:147] op_sel:[0,0] op_sel_hi:[1,1]
  s_waitcnt lgkmcnt(10)
  v_pk_add_f32 v[132:133], v[132:133], v[148:149] op_sel:[0,0] op_sel_hi:[1,1]
  v_mfma_f32_16x16x32_bf16 a[136:139], a[56:59], v[84:87], a[136:139]
  v_cvt_pk_bf16_f32 v96, v208, v212
  v_cvt_pk_bf16_f32 v97, v209, v213
  v_cvt_pk_bf16_f32 v98, v210, v214
  v_pk_add_f32 v[134:135], v[134:135], v[150:151] op_sel:[0,0] op_sel_hi:[1,1]
  s_waitcnt lgkmcnt(9)
  v_pk_add_f32 v[136:137], v[136:137], v[152:153] op_sel:[0,0] op_sel_hi:[1,1]
  v_pk_add_f32 v[138:139], v[138:139], v[154:155] op_sel:[0,0] op_sel_hi:[1,1]
  v_mfma_f32_16x16x32_bf16 a[140:143], a[60:63], v[84:87], a[140:143]
  v_cvt_pk_bf16_f32 v99, v211, 0
  s_waitcnt vmcnt(1)
  v_mfma_f32_16x16x32_bf16 v[208:211], a[120:123], v[112:115], 0
  s_waitcnt vmcnt(0)
  v_mfma_f32_16x16x32_bf16 v[212:215], a[124:127], v[112:115], 0
  s_waitcnt lgkmcnt(8)
  v_pk_add_f32 v[140:141], v[140:141], v[156:157] op_sel:[0,0] op_sel_hi:[1,1]
  v_pk_add_f32 v[142:143], v[142:143], v[158:159] op_sel:[0,0] op_sel_hi:[1,1]
  v_mfma_f32_16x16x32_bf16 a[144:147], a[48:51], v[88:91], a[144:147]
  v_add_f32 v223, 0x358637bd, v223
  v_rcp_f32 v223, v223
  s_nop 0
  v_pk_mul_f32 v[216:217], v[216:217], v[222:223] op_sel:[0,1] op_sel_hi:[1,1]
  s_waitcnt lgkmcnt(7)
  v_pk_add_f32 v[128:129], v[128:129], v[160:161] op_sel:[0,0] op_sel_hi:[1,1]
  v_pk_add_f32 v[130:131], v[130:131], v[162:163] op_sel:[0,0] op_sel_hi:[1,1]
  s_waitcnt lgkmcnt(6)
  v_pk_add_f32 v[132:133], v[132:133], v[164:165] op_sel:[0,0] op_sel_hi:[1,1]
  v_mfma_f32_16x16x32_bf16 a[148:151], a[52:55], v[88:91], a[148:151]
  v_pk_mul_f32 v[218:219], v[218:219], v[222:223] op_sel:[0,1] op_sel_hi:[1,1]
  v_pk_mul_f32 v[220:221], v[220:221], v[222:223] op_sel:[0,1] op_sel_hi:[1,1]
  v_mul_f32 v222, v222, v223
  v_pk_add_f32 v[134:135], v[134:135], v[166:167] op_sel:[0,0] op_sel_hi:[1,1]
  s_waitcnt lgkmcnt(5)
  v_pk_add_f32 v[136:137], v[136:137], v[168:169] op_sel:[0,0] op_sel_hi:[1,1]
  v_pk_add_f32 v[138:139], v[138:139], v[170:171] op_sel:[0,0] op_sel_hi:[1,1]
  v_mfma_f32_16x16x32_bf16 a[152:155], a[56:59], v[88:91], a[152:155]
  v_cvt_pk_bf16_f32 v100, v216, v220
  v_cvt_pk_bf16_f32 v101, v217, v221
  v_cvt_pk_bf16_f32 v102, v218, v222
  s_waitcnt lgkmcnt(4)
  v_pk_add_f32 v[140:141], v[140:141], v[172:173] op_sel:[0,0] op_sel_hi:[1,1]
  v_pk_add_f32 v[142:143], v[142:143], v[174:175] op_sel:[0,0] op_sel_hi:[1,1]
  v_mfma_f32_16x16x32_bf16 a[156:159], a[60:63], v[88:91], a[156:159]
  v_cvt_pk_bf16_f32 v103, v219, 0
  v_mfma_f32_16x16x32_bf16 v[216:219], a[120:123], v[116:119], 0
  v_mfma_f32_16x16x32_bf16 v[220:223], a[124:127], v[116:119], 0
  s_waitcnt lgkmcnt(3)
  v_pk_add_f32 v[128:129], v[128:129], v[176:177] op_sel:[0,0] op_sel_hi:[1,1]
  v_pk_add_f32 v[130:131], v[130:131], v[178:179] op_sel:[0,0] op_sel_hi:[1,1]
  s_waitcnt lgkmcnt(2)
  v_pk_add_f32 v[132:133], v[132:133], v[180:181] op_sel:[0,0] op_sel_hi:[1,1]
  v_mfma_f32_16x16x32_bf16 a[160:163], a[48:51], v[92:95], a[160:163]
  v_add_f32 v231, 0x358637bd, v231
  v_rcp_f32 v231, v231
  s_nop 0
  v_pk_mul_f32 v[224:225], v[224:225], v[230:231] op_sel:[0,1] op_sel_hi:[1,1]
  v_pk_add_f32 v[134:135], v[134:135], v[182:183] op_sel:[0,0] op_sel_hi:[1,1]
  s_waitcnt lgkmcnt(1)
  v_pk_add_f32 v[136:137], v[136:137], v[184:185] op_sel:[0,0] op_sel_hi:[1,1]
  v_pk_add_f32 v[138:139], v[138:139], v[186:187] op_sel:[0,0] op_sel_hi:[1,1]
  v_mfma_f32_16x16x32_bf16 a[164:167], a[52:55], v[92:95], a[164:167]
  v_pk_mul_f32 v[226:227], v[226:227], v[230:231] op_sel:[0,1] op_sel_hi:[1,1]
  v_pk_mul_f32 v[228:229], v[228:229], v[230:231] op_sel:[0,1] op_sel_hi:[1,1]
  v_mul_f32 v230, v230, v231
  s_waitcnt lgkmcnt(0)
  v_pk_add_f32 v[140:141], v[140:141], v[188:189] op_sel:[0,0] op_sel_hi:[1,1]
  v_pk_add_f32 v[142:143], v[142:143], v[190:191] op_sel:[0,0] op_sel_hi:[1,1]
  v_mfma_f32_16x16x32_bf16 a[168:171], a[56:59], v[92:95], a[168:171]
  v_cvt_pk_bf16_f32 v104, v224, v228
  v_cvt_pk_bf16_f32 v105, v225, v229
  v_cvt_pk_bf16_f32 v106, v226, v230
  v_mul_f32 v16, 0xbfb8aa3b, v128
  v_mul_f32 v20, 0xbfb8aa3b, v132
  v_mul_f32 v24, 0xbfb8aa3b, v136
  v_mfma_f32_16x16x32_bf16 a[172:175], a[60:63], v[92:95], a[172:175]
  v_cvt_pk_bf16_f32 v107, v227, 0
  v_mfma_f32_16x16x32_bf16 v[224:227], a[120:123], v[120:123], 0
  v_mfma_f32_16x16x32_bf16 v[228:231], a[124:127], v[120:123], 0
  v_mul_f32 v28, 0xbfb8aa3b, v140
  v_mul_f32 v17, 0xbfb8aa3b, v129
  v_mul_f32 v21, 0xbfb8aa3b, v133
  v_mfma_f32_16x16x32_bf16 v[192:195], a[48:51], v[80:83], v[192:195]
  v_add_f32 v239, 0x358637bd, v239
  v_rcp_f32 v239, v239
  s_nop 0
  v_pk_mul_f32 v[232:233], v[232:233], v[238:239] op_sel:[0,1] op_sel_hi:[1,1]
  v_mul_f32 v25, 0xbfb8aa3b, v137
  v_mul_f32 v29, 0xbfb8aa3b, v141
  v_mfma_f32_16x16x32_bf16 v[196:199], a[52:55], v[80:83], v[196:199]
  v_pk_mul_f32 v[234:235], v[234:235], v[238:239] op_sel:[0,1] op_sel_hi:[1,1]
  v_pk_mul_f32 v[236:237], v[236:237], v[238:239] op_sel:[0,1] op_sel_hi:[1,1]
  v_mul_f32 v238, v238, v239
  v_exp_f32 v16, v16
  v_exp_f32 v20, v20
  v_exp_f32 v24, v24
  v_mfma_f32_16x16x32_bf16 v[200:203], a[56:59], v[80:83], v[200:203]
  v_cvt_pk_bf16_f32 v108, v232, v236
  v_cvt_pk_bf16_f32 v109, v233, v237
  v_cvt_pk_bf16_f32 v110, v234, v238
  v_exp_f32 v28, v28
  v_exp_f32 v17, v17
  v_exp_f32 v21, v21
  v_mfma_f32_16x16x32_bf16 v[204:207], a[60:63], v[80:83], v[204:207]
  v_cvt_pk_bf16_f32 v111, v235, 0
  v_mfma_f32_16x16x32_bf16 v[232:235], a[120:123], v[124:127], 0
  v_mfma_f32_16x16x32_bf16 v[236:239], a[124:127], v[124:127], 0
  v_exp_f32 v25, v25
  v_exp_f32 v29, v29
  v_mfma_f32_16x16x32_bf16 a[128:131], a[64:67], v[100:103], a[128:131]
  v_add_f32 v215, 0x358637bd, v215
  v_rcp_f32 v215, v215
  s_nop 0
  v_pk_mul_f32 v[208:209], v[208:209], v[214:215] op_sel:[0,1] op_sel_hi:[1,1]
  v_mfma_f32_16x16x32_bf16 a[132:135], a[68:71], v[100:103], a[132:135]
  v_pk_mul_f32 v[210:211], v[210:211], v[214:215] op_sel:[0,1] op_sel_hi:[1,1]
  v_pk_mul_f32 v[212:213], v[212:213], v[214:215] op_sel:[0,1] op_sel_hi:[1,1]
  v_add_f32 v16, 1.0, v16
  v_add_f32 v20, 1.0, v20
  v_add_f32 v24, 1.0, v24
  v_mfma_f32_16x16x32_bf16 a[136:139], a[72:75], v[100:103], a[136:139]
  v_mul_f32 v214, v214, v215
  v_cvt_pk_bf16_f32 v112, v208, v212
  v_cvt_pk_bf16_f32 v113, v209, v213
  v_add_f32 v28, 1.0, v28
  v_add_f32 v17, 1.0, v17
  v_add_f32 v21, 1.0, v21
  v_mfma_f32_16x16x32_bf16 a[140:143], a[76:79], v[100:103], a[140:143]
  v_cvt_pk_bf16_f32 v114, v210, v214
  v_cvt_pk_bf16_f32 v115, v211, 0
  v_add_f32 v25, 1.0, v25
  v_add_f32 v29, 1.0, v29
  v_mfma_f32_16x16x32_bf16 a[144:147], a[64:67], v[104:107], a[144:147]
  v_add_f32 v223, 0x358637bd, v223
  v_rcp_f32 v223, v223
  s_nop 0
  v_pk_mul_f32 v[216:217], v[216:217], v[222:223] op_sel:[0,1] op_sel_hi:[1,1]
  v_rcp_f32 v16, v16
  v_rcp_f32 v20, v20
  v_rcp_f32 v24, v24
  v_mfma_f32_16x16x32_bf16 a[148:151], a[68:71], v[104:107], a[148:151]
  v_pk_mul_f32 v[218:219], v[218:219], v[222:223] op_sel:[0,1] op_sel_hi:[1,1]
  v_pk_mul_f32 v[220:221], v[220:221], v[222:223] op_sel:[0,1] op_sel_hi:[1,1]
  v_rcp_f32 v28, v28
  v_rcp_f32 v17, v17
  v_rcp_f32 v21, v21
  v_mfma_f32_16x16x32_bf16 a[152:155], a[72:75], v[104:107], a[152:155]
  v_mul_f32 v222, v222, v223
  v_cvt_pk_bf16_f32 v116, v216, v220
  v_cvt_pk_bf16_f32 v117, v217, v221
  v_rcp_f32 v25, v25
  v_rcp_f32 v29, v29
  v_mfma_f32_16x16x32_bf16 a[156:159], a[76:79], v[104:107], a[156:159]
  v_cvt_pk_bf16_f32 v118, v218, v222
  v_cvt_pk_bf16_f32 v119, v219, 0
  v_mul_f32 v128, v128, v16
  v_mul_f32 v132, v132, v20
  v_mul_f32 v136, v136, v24
  v_mfma_f32_16x16x32_bf16 a[160:163], a[64:67], v[108:111], a[160:163]
  v_add_f32 v231, 0x358637bd, v231
  v_rcp_f32 v231, v231
  s_nop 0
  v_pk_mul_f32 v[224:225], v[224:225], v[230:231] op_sel:[0,1] op_sel_hi:[1,1]
  v_mul_f32 v140, v140, v28
  v_mul_f32 v129, v129, v17
  v_mul_f32 v133, v133, v21
  v_mfma_f32_16x16x32_bf16 a[164:167], a[68:71], v[108:111], a[164:167]
  v_pk_mul_f32 v[226:227], v[226:227], v[230:231] op_sel:[0,1] op_sel_hi:[1,1]
  v_pk_mul_f32 v[228:229], v[228:229], v[230:231] op_sel:[0,1] op_sel_hi:[1,1]
  v_mul_f32 v137, v137, v25
  v_mul_f32 v141, v141, v29
  v_mfma_f32_16x16x32_bf16 a[168:171], a[72:75], v[108:111], a[168:171]
  v_mul_f32 v230, v230, v231
  v_cvt_pk_bf16_f32 v120, v224, v228
  v_cvt_pk_bf16_f32 v121, v225, v229
  v_mul_f32 v18, 0xbfb8aa3b, v130
  v_mul_f32 v22, 0xbfb8aa3b, v134
  v_mul_f32 v26, 0xbfb8aa3b, v138
  v_mfma_f32_16x16x32_bf16 a[172:175], a[76:79], v[108:111], a[172:175]
  v_cvt_pk_bf16_f32 v122, v226, v230
  v_cvt_pk_bf16_f32 v123, v227, 0
  v_mul_f32 v30, 0xbfb8aa3b, v142
  v_mul_f32 v19, 0xbfb8aa3b, v131
  v_mul_f32 v23, 0xbfb8aa3b, v135
  v_mfma_f32_16x16x32_bf16 v[192:195], a[64:67], v[96:99], v[192:195]
  v_add_f32 v239, 0x358637bd, v239
  v_rcp_f32 v239, v239
  s_nop 0
  v_pk_mul_f32 v[232:233], v[232:233], v[238:239] op_sel:[0,1] op_sel_hi:[1,1]
  v_mul_f32 v27, 0xbfb8aa3b, v139
  v_mul_f32 v31, 0xbfb8aa3b, v143
  v_mfma_f32_16x16x32_bf16 v[196:199], a[68:71], v[96:99], v[196:199]
  v_pk_mul_f32 v[234:235], v[234:235], v[238:239] op_sel:[0,1] op_sel_hi:[1,1]
  v_pk_mul_f32 v[236:237], v[236:237], v[238:239] op_sel:[0,1] op_sel_hi:[1,1]
  v_exp_f32 v18, v18
  v_exp_f32 v22, v22
  v_exp_f32 v26, v26
  v_mfma_f32_16x16x32_bf16 v[200:203], a[72:75], v[96:99], v[200:203]
  v_mul_f32 v238, v238, v239
  v_cvt_pk_bf16_f32 v124, v232, v236
  v_cvt_pk_bf16_f32 v125, v233, v237
  v_exp_f32 v30, v30
  v_exp_f32 v19, v19
  v_exp_f32 v23, v23
  v_mfma_f32_16x16x32_bf16 v[204:207], a[76:79], v[96:99], v[204:207]
  v_cvt_pk_bf16_f32 v126, v234, v238
  v_cvt_pk_bf16_f32 v127, v235, 0
  v_exp_f32 v27, v27
  v_exp_f32 v31, v31
  v_mfma_f32_16x16x32_bf16 a[128:131], a[80:83], v[116:119], a[128:131]
  v_add_f32 v18, 1.0, v18
  v_add_f32 v22, 1.0, v22
  v_mfma_f32_16x16x32_bf16 a[132:135], a[84:87], v[116:119], a[132:135]
  v_add_f32 v26, 1.0, v26
  v_add_f32 v30, 1.0, v30
  v_mfma_f32_16x16x32_bf16 a[136:139], a[88:91], v[116:119], a[136:139]
  v_add_f32 v19, 1.0, v19
  v_mfma_f32_16x16x32_bf16 a[140:143], a[92:95], v[116:119], a[140:143]
  v_add_f32 v23, 1.0, v23
  v_add_f32 v27, 1.0, v27
  v_mfma_f32_16x16x32_bf16 a[144:147], a[80:83], v[120:123], a[144:147]
  v_add_f32 v31, 1.0, v31
  v_mfma_f32_16x16x32_bf16 a[148:151], a[84:87], v[120:123], a[148:151]
  v_rcp_f32 v18, v18
  v_rcp_f32 v22, v22
  v_mfma_f32_16x16x32_bf16 a[152:155], a[88:91], v[120:123], a[152:155]
  v_rcp_f32 v26, v26
  v_rcp_f32 v30, v30
  v_mfma_f32_16x16x32_bf16 a[156:159], a[92:95], v[120:123], a[156:159]
  v_rcp_f32 v19, v19
  ds_write_b128 v8, a[128:131] offset:49152
  v_rcp_f32 v23, v23
  v_rcp_f32 v27, v27
  ds_write_b128 v8, a[132:135] offset:50176
  v_rcp_f32 v31, v31
  ds_write_b128 v8, a[136:139] offset:51200
  v_mul_f32 v130, v130, v18
  v_mul_f32 v134, v134, v22
  ds_write_b128 v8, a[140:143] offset:52224
  v_mul_f32 v138, v138, v26
  v_mul_f32 v142, v142, v30
  v_mfma_f32_16x16x32_bf16 a[160:163], a[80:83], v[124:127], a[160:163]
  v_mul_f32 v131, v131, v19
  v_mfma_f32_16x16x32_bf16 a[164:167], a[84:87], v[124:127], a[164:167]
  v_mul_f32 v135, v135, v23
  v_mul_f32 v139, v139, v27
  v_mfma_f32_16x16x32_bf16 a[168:171], a[88:91], v[124:127], a[168:171]
  v_mul_f32 v143, v143, v31
  v_mfma_f32_16x16x32_bf16 a[172:175], a[92:95], v[124:127], a[172:175]
  v_lshlrev_b32 v64, 16, v240
  v_and_b32 v68, 0xffff0000, v240
  ds_write_b128 v9, a[144:147] offset:49152
  v_lshlrev_b32 v72, 16, v241
  v_and_b32 v76, 0xffff0000, v241
  ds_write_b128 v9, a[148:151] offset:50176
  v_lshlrev_b32 v65, 16, v242
  ds_write_b128 v9, a[152:155] offset:51200
  v_and_b32 v69, 0xffff0000, v242
  v_lshlrev_b32 v73, 16, v243
  ds_write_b128 v9, a[156:159] offset:52224
  v_and_b32 v77, 0xffff0000, v243
  v_mfma_f32_16x16x32_bf16 v[192:195], a[80:83], v[112:115], v[192:195]
  v_lshlrev_b32 v66, 16, v244
  v_and_b32 v70, 0xffff0000, v244
  v_mfma_f32_16x16x32_bf16 v[196:199], a[84:87], v[112:115], v[196:199]
  v_lshlrev_b32 v74, 16, v245
  v_and_b32 v78, 0xffff0000, v245
  v_mfma_f32_16x16x32_bf16 v[200:203], a[88:91], v[112:115], v[200:203]
  v_lshlrev_b32 v67, 16, v246
  v_mfma_f32_16x16x32_bf16 v[204:207], a[92:95], v[112:115], v[204:207]
  v_and_b32 v71, 0xffff0000, v246
  v_lshlrev_b32 v75, 16, v247
  ds_write_b128 v10, a[160:163] offset:49152
  v_and_b32 v79, 0xffff0000, v247
  ds_write_b128 v10, a[164:167] offset:50176
  ds_write_b128 v10, a[168:171] offset:51200
  ds_write_b128 v10, a[172:175] offset:52224
  s_waitcnt lgkmcnt(0)
  s_barrier
  ds_read_b128 v[144:147], v5 offset:49152
  ds_read_b128 v[148:151], v5 offset:50176
  ds_read_b128 v[152:155], v5 offset:51200
  ds_read_b128 v[156:159], v5 offset:52224
  ds_read_b128 v[160:163], v5 offset:53248
  ds_read_b128 v[164:167], v5 offset:54272
  ds_read_b128 v[168:171], v5 offset:55296
  ds_read_b128 v[172:175], v5 offset:56320
  ds_read_b128 v[176:179], v5 offset:57344
  ds_read_b128 v[180:183], v5 offset:58368
  ds_read_b128 v[184:187], v5 offset:59392
  ds_read_b128 v[188:191], v5 offset:60416
  s_waitcnt lgkmcnt(11)
  v_pk_add_f32 v[192:193], v[192:193], v[144:145] op_sel:[0,0] op_sel_hi:[1,1]
  v_pk_add_f32 v[194:195], v[194:195], v[146:147] op_sel:[0,0] op_sel_hi:[1,1]
  s_waitcnt lgkmcnt(10)
  v_pk_add_f32 v[196:197], v[196:197], v[148:149] op_sel:[0,0] op_sel_hi:[1,1]
  v_pk_add_f32 v[198:199], v[198:199], v[150:151] op_sel:[0,0] op_sel_hi:[1,1]
  s_waitcnt lgkmcnt(9)
  v_pk_add_f32 v[200:201], v[200:201], v[152:153] op_sel:[0,0] op_sel_hi:[1,1]
  v_pk_add_f32 v[202:203], v[202:203], v[154:155] op_sel:[0,0] op_sel_hi:[1,1]
  s_waitcnt lgkmcnt(8)
  v_pk_add_f32 v[204:205], v[204:205], v[156:157] op_sel:[0,0] op_sel_hi:[1,1]
  v_pk_add_f32 v[206:207], v[206:207], v[158:159] op_sel:[0,0] op_sel_hi:[1,1]
  s_waitcnt lgkmcnt(7)
  v_pk_add_f32 v[192:193], v[192:193], v[160:161] op_sel:[0,0] op_sel_hi:[1,1]
  v_pk_add_f32 v[194:195], v[194:195], v[162:163] op_sel:[0,0] op_sel_hi:[1,1]
  s_waitcnt lgkmcnt(6)
  v_pk_add_f32 v[196:197], v[196:197], v[164:165] op_sel:[0,0] op_sel_hi:[1,1]
  v_pk_add_f32 v[198:199], v[198:199], v[166:167] op_sel:[0,0] op_sel_hi:[1,1]
  s_waitcnt lgkmcnt(5)
  v_pk_add_f32 v[200:201], v[200:201], v[168:169] op_sel:[0,0] op_sel_hi:[1,1]
  v_pk_add_f32 v[202:203], v[202:203], v[170:171] op_sel:[0,0] op_sel_hi:[1,1]
  s_waitcnt lgkmcnt(4)
  v_pk_add_f32 v[204:205], v[204:205], v[172:173] op_sel:[0,0] op_sel_hi:[1,1]
  v_pk_add_f32 v[206:207], v[206:207], v[174:175] op_sel:[0,0] op_sel_hi:[1,1]
  s_waitcnt lgkmcnt(3)
  v_pk_add_f32 v[192:193], v[192:193], v[176:177] op_sel:[0,0] op_sel_hi:[1,1]
  v_pk_add_f32 v[194:195], v[194:195], v[178:179] op_sel:[0,0] op_sel_hi:[1,1]
  s_waitcnt lgkmcnt(2)
  v_pk_add_f32 v[196:197], v[196:197], v[180:181] op_sel:[0,0] op_sel_hi:[1,1]
  v_pk_add_f32 v[198:199], v[198:199], v[182:183] op_sel:[0,0] op_sel_hi:[1,1]
  s_waitcnt lgkmcnt(1)
  v_pk_add_f32 v[200:201], v[200:201], v[184:185] op_sel:[0,0] op_sel_hi:[1,1]
  v_pk_add_f32 v[202:203], v[202:203], v[186:187] op_sel:[0,0] op_sel_hi:[1,1]
  s_waitcnt lgkmcnt(0)
  v_pk_add_f32 v[204:205], v[204:205], v[188:189] op_sel:[0,0] op_sel_hi:[1,1]
  v_pk_add_f32 v[206:207], v[206:207], v[190:191] op_sel:[0,0] op_sel_hi:[1,1]
  v_fma_f32 v192, v192, v128, v64
  v_fma_f32 v196, v196, v132, v68
  v_fma_f32 v200, v200, v136, v72
  v_fma_f32 v204, v204, v140, v76
  v_cvt_pk_bf16_f32 v240, v192, v196
  v_cvt_pk_bf16_f32 v241, v200, v204
  buffer_store_dwordx2 v[240:241], v2, s[32:35], 0 offen offset:0
  v_fma_f32 v193, v193, v129, v65
  v_fma_f32 v197, v197, v133, v69
  v_fma_f32 v201, v201, v137, v73
  v_fma_f32 v205, v205, v141, v77
  v_cvt_pk_bf16_f32 v242, v193, v197
  v_cvt_pk_bf16_f32 v243, v201, v205
  buffer_store_dwordx2 v[242:243], v2, s[32:35], 0 offen offset:16
  v_fma_f32 v194, v194, v130, v66
  v_fma_f32 v198, v198, v134, v70
  v_fma_f32 v202, v202, v138, v74
  v_fma_f32 v206, v206, v142, v78
  v_cvt_pk_bf16_f32 v244, v194, v198
  v_cvt_pk_bf16_f32 v245, v202, v206
  buffer_store_dwordx2 v[244:245], v2, s[32:35], 0 offen offset:32
  v_fma_f32 v195, v195, v131, v67
  v_fma_f32 v199, v199, v135, v71
  v_fma_f32 v203, v203, v139, v75
  v_fma_f32 v207, v207, v143, v79
  v_cvt_pk_bf16_f32 v246, v195, v199
  v_cvt_pk_bf16_f32 v247, v203, v207
  buffer_store_dwordx2 v[246:247], v2, s[32:35], 0 offen offset:48
  s_endpgm
k1fqn_slow:
  s_sleep 4
  s_mov_b64 exec, s[26:27]
  buffer_load_dwordx2 v[18:19], off, s[40:43], 0 sc1
  s_mov_b64 exec, -1
  s_add_u32 s78, s78, 1
  s_waitcnt vmcnt(0)
  v_cmp_ne_u32 s[76:77], 0, v18
  s_cmp_gt_u32 s78, 32768
  s_cbranch_scc1 k1fqn_ok
  s_nop 1
  s_and_b64 s[76:77], s[76:77], s[26:27]
  s_cmp_eq_u64 s[76:77], s[26:27]
  s_cbranch_scc0 k1fqn_slow
  s_branch k1fqn_ok

k1fq_slow:
  s_sleep 4
  s_mov_b64 exec, s[26:27]
  buffer_load_dwordx2 v[20:21], v30, s[36:39], s55 offen sc1
  s_mov_b64 exec, -1
  s_add_u32 s78, s78, 1
  s_waitcnt vmcnt(0)
  v_cmp_eq_u64 s[76:77], s[6:7], v[20:21]
  s_cmp_gt_u32 s78, 32768
  s_cbranch_scc1 k1fq_ok
  s_nop 1
  s_and_b64 s[76:77], s[76:77], s[26:27]
  s_cmp_eq_u64 s[76:77], s[26:27]
  s_cbranch_scc0 k1fq_slow
  s_branch k1fq_ok

k1kvn_slow:
  s_sleep 4
  s_mov_b64 exec, s[26:27]
  buffer_load_dwordx2 v[18:19], off, s[40:43], 0 sc1
  s_mov_b64 exec, -1
  s_add_u32 s78, s78, 1
  s_waitcnt vmcnt(0)
  v_cmp_ne_u32 s[76:77], 0, v18
  s_cmp_gt_u32 s78, 32768
  s_cbranch_scc1 k1kvn_ok
  s_nop 1
  s_and_b64 s[76:77], s[76:77], s[26:27]
  s_cmp_eq_u64 s[76:77], s[26:27]
  s_cbranch_scc0 k1kvn_slow
  s_branch k1kvn_ok

k1kv_slow:
  s_sleep 4
  s_mov_b64 exec, s[26:27]
  buffer_load_dwordx2 v[20:21], v30, s[36:39], s55 offen sc1
  s_mov_b64 exec, -1
  s_add_u32 s78, s78, 1
  s_waitcnt vmcnt(0)
  v_cmp_eq_u64 s[76:77], s[6:7], v[20:21]
  s_cmp_gt_u32 s78, 32768
  s_cbranch_scc1 k1kv_ok
  s_nop 1
  s_and_b64 s[76:77], s[76:77], s[26:27]
  s_cmp_eq_u64 s[76:77], s[26:27]
  s_cbranch_scc0 k1kv_slow
  s_branch k1kv_ok

k1n_slow:
  s_sleep 4
  s_mov_b64 exec, s[26:27]
  buffer_load_dwordx2 v[224:225], off, s[40:43], 0 sc1
  s_mov_b64 exec, -1
  s_add_u32 s78, s78, 1
  s_waitcnt vmcnt(0)
  v_cmp_ne_u32 s[76:77], 0, v224
  s_cmp_gt_u32 s78, 32768
  s_cbranch_scc1 k1n_ok
  s_nop 1
  s_and_b64 s[76:77], s[76:77], s[26:27]
  s_cmp_eq_u64 s[76:77], s[26:27]
  s_cbranch_scc0 k1n_slow
  s_branch k1n_ok

k1pp_slow:
  s_sleep 4
  s_mov_b64 exec, s[26:27]
  buffer_load_dwordx2 v[20:21], v30, s[36:39], s55 offen sc1
  s_mov_b64 exec, -1
  s_add_u32 s78, s78, 1
  s_waitcnt vmcnt(0)
  v_cmp_eq_u64 s[76:77], s[6:7], v[20:21]
  s_cmp_gt_u32 s78, 32768
  s_cbranch_scc1 k1pp_ok
  s_nop 1
  s_and_b64 s[76:77], s[76:77], s[26:27]
  s_cmp_eq_u64 s[76:77], s[26:27]
  s_cbranch_scc0 k1pp_slow
  s_branch k1pp_ok

kred_slow:
  s_sleep 4
  s_mov_b64 exec, s[26:27]
  buffer_load_dwordx2 v[20:21], v30, s[36:39], s55 offen sc1
  s_mov_b64 exec, -1
  s_add_u32 s78, s78, 1
  s_waitcnt vmcnt(0)
  v_cmp_eq_u64 s[76:77], s[6:7], v[20:21]
  s_cmp_gt_u32 s78, 32768
  s_cbranch_scc1 kred_ok
  s_nop 1
  s_and_b64 s[76:77], s[76:77], s[26:27]
  s_cmp_eq_u64 s[76:77], s[26:27]
  s_cbranch_scc0 kred_slow
  s_branch kred_ok

kp2_slow:
  s_sleep 2
  s_mov_b64 exec, s[26:27]
  buffer_load_dwordx2 v[6:7], v1, s[36:39], s55 offen sc1
  s_mov_b64 exec, -1
  s_add_u32 s78, s78, 1
  s_waitcnt vmcnt(0)
  v_cmp_eq_u64 s[76:77], s[6:7], v[6:7]
  s_cmp_gt_u32 s78, 32768
  s_cbranch_scc1 kp2_ok
  s_nop 1
  s_and_b64 s[76:77], s[76:77], s[26:27]
  s_cmp_eq_u64 s[76:77], s[26:27]
  s_cbranch_scc0 kp2_slow
  s_branch kp2_ok

kp2q_slow:
  s_sleep 2
  s_mov_b64 exec, s[26:27]
  buffer_load_dwordx2 v[6:7], v1, s[36:39], s55 offen sc1
  s_mov_b64 exec, -1
  s_add_u32 s78, s78, 1
  s_waitcnt vmcnt(0)
  v_cmp_eq_u64 s[76:77], s[6:7], v[6:7]
  s_cmp_gt_u32 s78, 32768
  s_cbranch_scc1 kp2q_ok
  s_nop 1
  s_and_b64 s[76:77], s[76:77], s[26:27]
  s_cmp_eq_u64 s[76:77], s[26:27]
  s_cbranch_scc0 kp2q_slow
  s_branch kp2q_ok

kp2k_slow:
  s_sleep 2
  s_mov_b64 exec, s[26:27]
  buffer_load_dwordx2 v[6:7], v1, s[36:39], s55 offen sc1
  s_mov_b64 exec, -1
  s_add_u32 s78, s78, 1
  s_waitcnt vmcnt(0)
  v_cmp_eq_u64 s[76:77], s[6:7], v[6:7]
  s_cmp_gt_u32 s78, 32768
  s_cbranch_scc1 kp2k_ok
  s_nop 1
  s_and_b64 s[76:77], s[76:77], s[26:27]
  s_cmp_eq_u64 s[76:77], s[26:27]
  s_cbranch_scc0 kp2k_slow
  s_branch kp2k_ok

k_end:
.section .rodata,"a"
.p2align 6
.amdhsa_kernel recurrent_scan__linear_attn_block__dense_activation_squared_relu__prompt_kernel
  .amdhsa_next_free_vgpr 512
  .amdhsa_next_free_sgpr 102
  .amdhsa_accum_offset 256
  .amdhsa_group_segment_fixed_size 0
  .amdhsa_kernarg_size 88
  .amdhsa_user_sgpr_count 2
  .amdhsa_user_sgpr_kernarg_segment_ptr 1
  .amdhsa_system_sgpr_workgroup_id_x 1
.end_amdhsa_kernel
```
